```python
import torch

def _softmax(x, axis=-1):
    return torch.softmax(x, dim=axis)
def _gelu(x):
    return torch.nn.functional.gelu(x, approximate="tanh")
def _silu(x):
    return torch.nn.functional.silu(x)
def _sigmoid(x):
    return torch.sigmoid(x)
def _layernorm(x, axis=-1, eps=1e-5):
    m = x.mean(dim=axis, keepdim=True)
    v = x.var(dim=axis, keepdim=True, unbiased=False)
    return (x - m) / torch.sqrt(v + eps)
def _scatter_add(tgt, idx, src, axis=0):
    return tgt.clone().index_add_(axis, idx, src)
def _segment_sum(src, seg, n):
    out = torch.zeros((n,) + src.shape[1:], dtype=src.dtype)
    return out.index_add_(0, seg, src)
def _pad(x, pw):
    flat = tuple(v for pair in reversed(pw) for v in pair)
    return torch.nn.functional.pad(x, flat)

kernel_name = 'parallel_sum__linear_kernel_hedgehog__mixer_token_mlp__prompt'

def setup_inputs():

    _w = (lambda a: (lambda t: t.to(torch.bfloat16) if t.is_floating_point() else t)(torch.as_tensor(a)))
    def _A_setup():
        B, S, D, H = 1, 2048, 576, 32
        Dh = D // H
        return {
            "x": _w((lambda *s: torch.randn(*s, dtype=torch.bfloat16) * 0.05)(B, S, D)),
            "wqkv": _w((lambda *s: torch.randn(*s, dtype=torch.bfloat16) * 0.2)(D, 3 * D)),
            "w_phi": _w((lambda *s: torch.randn(*s, dtype=torch.bfloat16) * 0.2)(H, Dh, Dh) * (Dh ** -0.5)),
            "wo": _w((lambda *s: torch.randn(*s, dtype=torch.bfloat16) * 0.05)(D, D)),
        }
    _A_in = _A_setup()

    def _B_setup():
        B, S, D, F = 1, 2048, 576, 4608
        return {
            "x": _w((lambda *s: torch.randn(*s, dtype=torch.bfloat16) * 0.05)(B, S, D)),
            "w1": _w((lambda *s: torch.randn(*s, dtype=torch.bfloat16) * 0.8)(S, F) * (S ** -0.5)),
            "b1": _w((lambda *s: torch.randn(*s, dtype=torch.bfloat16) * 12.8)(F) * 0.02),
            "w2": _w((lambda *s: torch.randn(*s, dtype=torch.bfloat16) * 0.1)(F, S) * (F ** -0.5)),
            "b2": _w((lambda *s: torch.randn(*s, dtype=torch.bfloat16) * 1.6)(S) * 0.02),
        }
    _B_in = _B_setup()

    return {
        "A_x": _A_in["x"],
        "A_wqkv": _A_in["wqkv"],
        "A_w_phi": _A_in["w_phi"],
        "A_wo": _A_in["wo"],
        "B_x": _B_in["x"],
        "B_w1": _B_in["w1"],
        "B_b1": _B_in["b1"],
        "B_w2": _B_in["w2"],
        "B_b2": _B_in["b2"],
    }

def reference(A_x, A_wqkv, A_w_phi, A_wo, B_x, B_w1, B_b1, B_w2, B_b2):
    def _A_ref(x, wqkv, w_phi, wo):
        B, S, D = x.shape
        H = 32; Dh = D // H
        qkv = (lambda x, *d: x.permute(*d))((x @ wqkv).reshape(B, S, 3, H, Dh), 2, 0, 3, 1, 4)
        q, k, v = qkv[0], qkv[1], qkv[2]
        pq = torch.einsum("bhsd,hdf->bhsf", q, w_phi)
        pk = torch.einsum("bhsd,hdf->bhsf", k, w_phi)
        phi_q = torch.concatenate([_softmax(pq, axis=-1), _softmax(-pq, axis=-1)], axis=-1)
        phi_k = torch.concatenate([_softmax(pk, axis=-1), _softmax(-pk, axis=-1)], axis=-1)
        kv = torch.einsum("bhsf,bhsd->bhfd", phi_k, v)
        z  = torch.einsum("bhsf->bhf", phi_k)
        num = torch.einsum("bhqf,bhfd->bhqd", phi_q, kv)
        den = torch.einsum("bhqf,bhf->bhq", phi_q, z)[..., None] + 1e-6
        o = num / den
        return (lambda x, *d: x.permute(*d))(o, 0, 2, 1, 3).reshape(B, S, D) @ wo

    def _B_ref(x, w1, b1, w2, b2):
        B, S, D = x.shape
        h = _layernorm(x, axis=-1)
        u = torch.einsum("bsd,sf->bdf", h, w1) + b1
        u = _gelu(u)
        y = torch.einsum("bdf,fs->bds", u, w2) + b2
        return (lambda x, *d: x.permute(*d))(y, 0, 2, 1)

    x = A_x
    xn = _layernorm(x, axis=-1)
    return x + _A_ref(xn, A_wqkv, A_w_phi, A_wo) + _B_ref(xn, B_w1, B_b1, B_w2, B_b2)
```

```asm
; @launch grid=(256,1,1) block=(512,1,1) lds=163840
.amdgcn_target "amdgcn-amd-amdhsa--gfx950"
.text
.globl parallel_sum__linear_kernel_hedgehog__mixer_token_mlp__prompt_kernel
.p2align 8
.type parallel_sum__linear_kernel_hedgehog__mixer_token_mlp__prompt_kernel,@function
parallel_sum__linear_kernel_hedgehog__mixer_token_mlp__prompt_kernel:
    s_load_dwordx2 s[8:9], s[0:1], 0
    s_load_dwordx2 s[44:45], s[0:1], 88
    s_cmp_ge_u32 s2, 256
    s_cbranch_scc1 L_end
    v_readfirstlane_b32 s4, v0
    s_lshr_b32 s6, s2, 3
    v_and_b32 v0, 63, v0
    s_cmp_lg_u32 s4, 0
    s_cbranch_scc1 L_nopf
    s_getpc_b64 s[50:51]
L_pc0:
    s_mul_i32 s48, s6, 2176
    s_min_u32 s48, s48, L_code_end-L_pc0-6148
    v_min_u32 v254, 48, v0
    v_lshrrev_b32 v253, 5, v0
    v_lshlrev_b32 v254, 7, v254
    v_mad_u32_u24 v254, v253, s48, v254
    global_load_dword v255, v254, s[50:51]
L_nopf:
    s_lshr_b32 s4, s4, 6
    s_and_b32 s5, s2, 7
    s_lshl_b32 s53, s5, 5
    s_add_u32 s53, s53, s6
    s_lshl_b32 s3, s53, 3
    s_add_u32 s3, s3, s4
    s_mul_i32 s3, s3, 1152
    s_mov_b32 s10, 2359296
    s_mov_b32 s11, 0x20000
    v_lshlrev_b32 v1, 3, v0
    v_lshlrev_b32 v7, 1, v0
    s_waitcnt lgkmcnt(0)
    buffer_load_dwordx2 v[2:3], v1, s[8:11], s3 offen
    buffer_load_dwordx2 v[4:5], v1, s[8:11], s3 offen offset:512
    buffer_load_ushort v6, v7, s[8:11], s3 offen offset:1024
    s_load_dwordx2 s[24:25], s[0:1], 40
    s_load_dwordx2 s[12:13], s[0:1], 8
    s_load_dwordx2 s[16:17], s[0:1], 16
    s_load_dwordx2 s[20:21], s[0:1], 24
    s_load_dwordx2 s[28:29], s[0:1], 48
    s_load_dwordx2 s[32:33], s[0:1], 56
    s_load_dwordx2 s[36:37], s[0:1], 64
    s_load_dwordx2 s[40:41], s[0:1], 72
    s_mov_b32 s46, 268435456
    s_mov_b32 s47, 0x20000
    s_mov_b32 s26, 18874368
    s_mov_b32 s27, 0x20000
    s_mov_b32 s14, 1990656
    s_mov_b32 s15, 0x20000
    s_mov_b32 s18, 20736
    s_mov_b32 s19, 0x20000
    s_mov_b32 s22, 663552
    s_mov_b32 s23, 0x20000
    s_mov_b32 s30, 9216
    s_mov_b32 s31, 0x20000
    s_mov_b32 s34, 18874368
    s_mov_b32 s35, 0x20000
    s_mov_b32 s38, 4096
    s_mov_b32 s39, 0x20000
    s_mov_b32 s42, 2359296
    s_mov_b32 s43, 0x20000
    s_waitcnt lgkmcnt(0)
    s_load_dword s7, s[44:45], 0
    s_getpc_b64 s[50:51]
L_pc1:
    s_lshl_b32 s3, s5, 3
    s_add_u32 s3, s3, order_table-L_pc1
    s_load_dwordx2 s[100:101], s[50:51], s3
    s_mul_i32 s3, s4, 1216
    s_add_u32 s3, s3, 153600
    v_add_u32 v8, s3, v1
    v_add_u32 v9, s3, v7
    s_lshl_b32 s3, s4, 2
    s_add_u32 s3, s3, 163328
    v_mov_b32 v25, s3
    v_mov_b32 v24, 0x3727c5ac
    v_mov_b32 v26, 0xbae38e39
    v_mov_b32 v27, 0x3ae38e39
    v_bfe_u32 v60, v0, 2, 2
    v_lshrrev_b32 v61, 4, v0
    v_and_b32 v62, 3, v0
    v_mul_u32_u24 v60, 1216, v60
    v_lshlrev_b32 v61, 5, v61
    v_lshlrev_b32 v62, 3, v62
    v_add3_u32 v60, v60, v61, v62
    v_add_u32 v60, 153600, v60
    v_and_b32 v61, 7, v0
    v_lshlrev_b32 v61, 2, v61
    v_add_u32 v62, 163328, v61
    v_lshlrev_b32 v63, 4, v0
    v_lshlrev_b32 v64, 9, v0
    s_mul_i32 s56, s53, 9216
    s_add_u32 s56, s56, 1048576
    s_add_u32 s57, s56, 4096
    s_add_u32 s58, s56, 8192
    s_lshl_b32 s59, s53, 5
    s_add_u32 s59, s59, 393216
    s_lshr_b32 s60, s6, 3
    s_lshl_b32 s60, s60, 7
    s_and_b32 s48, s6, 7
    s_lshl_b32 s48, s48, 2
    s_add_u32 s60, s60, s48
    s_lshl_b32 s48, s5, 14
    s_add_u32 s60, s60, s48
    s_add_u32 s60, s60, 524288
    s_cmp_eq_u32 s4, 7
    s_cbranch_scc1 L_t0
    s_waitcnt vmcnt(0)
    s_branch L_t0c
L_t0:
    v_mul_u32_u24 v80, 174763, v0
    v_lshrrev_b32 v80, 20, v80
    v_mul_u32_u24 v82, 6, v80
    v_sub_u32 v81, v0, v82
    v_min_u32 v80, 8, v80
    v_mul_u32_u24 v80, 3456, v80
    v_lshrrev_b32 v82, 1, v81
    v_mul_u32_u24 v82, 1152, v82
    v_and_b32 v81, 1, v81
    v_mul_u32_u24 v81, 140, v81
    v_add3_u32 v80, v80, v81, v82
    s_mul_i32 s3, s6, 9
    s_add_u32 s3, s3, 0
    s_min_u32 s3, s3, 567
    s_mul_i32 s3, s3, 3456
    s_mul_i32 s48, s5, 144
    s_add_u32 s3, s3, s48
    buffer_load_dword v255, v80, s[12:15], s3 offen
    v_mul_u32_u24 v248, 116509, v0
    v_lshrrev_b32 v248, 20, v248
    v_mul_u32_u24 v250, 9, v248
    v_sub_u32 v249, v0, v250
    v_min_u32 v248, 6, v248
    v_mul_u32_u24 v248, 9216, v248
    v_lshl_add_u32 v248, v249, 7, v248
    s_mul_i32 s3, s6, 7
    s_add_u32 s3, s3, 0
    s_and_b32 s48, s5, 7
    s_lshl_b32 s48, s48, 8
    s_add_u32 s3, s3, s48
    s_and_b32 s3, s3, 2047
    s_min_u32 s3, s3, 2041
    s_mul_i32 s3, s3, 9216
    s_mul_i32 s48, s5, 1152
    s_add_u32 s3, s3, s48
    buffer_load_dword v255, v248, s[24:27], s3 offen
    s_waitcnt vmcnt(2)
L_t0c:
    v_lshlrev_b32 v10, 16, v2
    v_and_b32 v11, 0xffff0000, v2
    v_lshlrev_b32 v12, 16, v3
    v_and_b32 v13, 0xffff0000, v3
    v_lshlrev_b32 v14, 16, v4
    v_and_b32 v15, 0xffff0000, v4
    v_lshlrev_b32 v16, 16, v5
    v_and_b32 v17, 0xffff0000, v5
    v_lshlrev_b32 v18, 16, v6
    v_pk_add_f32 v[20:21], v[10:11], v[12:13]
    v_pk_add_f32 v[22:23], v[14:15], v[16:17]
    v_pk_add_f32 v[20:21], v[20:21], v[22:23]
    v_add_f32 v20, v20, v18
    v_add_f32 v20, v20, v21
    s_nop 1
    v_add_f32_dpp v20, v20, v20 row_shr:1 row_mask:0xf bank_mask:0xf bound_ctrl:1
    s_nop 1
    v_add_f32_dpp v20, v20, v20 row_shr:2 row_mask:0xf bank_mask:0xf bound_ctrl:1
    s_nop 1
    v_add_f32_dpp v20, v20, v20 row_shr:4 row_mask:0xf bank_mask:0xf bound_ctrl:1
    s_nop 1
    v_add_f32_dpp v20, v20, v20 row_shr:8 row_mask:0xf bank_mask:0xf bound_ctrl:1
    s_nop 1
    v_add_f32_dpp v20, v20, v20 row_bcast:15 row_mask:0xa bank_mask:0xf
    s_nop 1
    v_add_f32_dpp v20, v20, v20 row_bcast:31 row_mask:0xc bank_mask:0xf
    s_nop 0
    v_readlane_b32 s48, v20, 63
    s_nop 1
    v_mul_f32 v20, s48, v26
    v_pk_add_f32 v[10:11], v[10:11], v[20:21] op_sel_hi:[1,0]
    v_pk_add_f32 v[12:13], v[12:13], v[20:21] op_sel_hi:[1,0]
    v_pk_add_f32 v[14:15], v[14:15], v[20:21] op_sel_hi:[1,0]
    v_pk_add_f32 v[16:17], v[16:17], v[20:21] op_sel_hi:[1,0]
    v_add_f32 v18, v18, v20
    v_pk_mul_f32 v[20:21], v[10:11], v[10:11]
    v_pk_mul_f32 v[22:23], v[12:13], v[12:13]
    v_pk_fma_f32 v[20:21], v[14:15], v[14:15], v[20:21]
    v_pk_fma_f32 v[22:23], v[16:17], v[16:17], v[22:23]
    v_pk_add_f32 v[20:21], v[20:21], v[22:23]
    v_fmac_f32 v20, v18, v18
    v_add_f32 v20, v20, v21
    s_nop 1
    v_add_f32_dpp v20, v20, v20 row_shr:1 row_mask:0xf bank_mask:0xf bound_ctrl:1
    s_nop 1
    v_add_f32_dpp v20, v20, v20 row_shr:2 row_mask:0xf bank_mask:0xf bound_ctrl:1
    s_nop 1
    v_add_f32_dpp v20, v20, v20 row_shr:4 row_mask:0xf bank_mask:0xf bound_ctrl:1
    s_nop 1
    v_add_f32_dpp v20, v20, v20 row_shr:8 row_mask:0xf bank_mask:0xf bound_ctrl:1
    s_nop 1
    v_add_f32_dpp v20, v20, v20 row_bcast:15 row_mask:0xa bank_mask:0xf
    s_nop 1
    v_add_f32_dpp v20, v20, v20 row_bcast:31 row_mask:0xc bank_mask:0xf
    s_nop 0
    v_readlane_b32 s48, v20, 63
    s_nop 1
    v_mul_f32 v20, s48, v27
    v_add_f32 v21, v20, v24
    v_rsq_f32 v21, v21
    s_nop 0
    v_mul_f32 v22, v21, v21
    v_fma_f32 v22, v22, v20, v24
    v_rsq_f32 v23, v22
    s_nop 0
    v_mul_f32 v20, v21, v23
    v_mul_f32 v22, v22, v23
    v_pk_mul_f32 v[10:11], v[10:11], v[20:21] op_sel_hi:[1,0]
    v_pk_mul_f32 v[12:13], v[12:13], v[20:21] op_sel_hi:[1,0]
    v_pk_mul_f32 v[14:15], v[14:15], v[20:21] op_sel_hi:[1,0]
    v_pk_mul_f32 v[16:17], v[16:17], v[20:21] op_sel_hi:[1,0]
    v_mul_f32 v18, v18, v20
    v_cvt_pk_bf16_f32 v2, v10, v11
    v_cvt_pk_bf16_f32 v3, v12, v13
    v_cvt_pk_bf16_f32 v4, v14, v15
    v_cvt_pk_bf16_f32 v5, v16, v17
    v_cvt_pk_bf16_f32 v6, v18, v18
    ds_write_b64 v8, v[2:3]
    ds_write_b64 v8, v[4:5] offset:512
    ds_write_b16 v9, v6 offset:1024
    ds_write_b32 v25, v22
    s_waitcnt lgkmcnt(0)
    s_barrier
    s_mul_i32 s7, s7, 0x9E3779B1
    s_add_u32 s7, s7, 0x7F4A7C15
    s_mov_b32 s0, s7
    s_mov_b32 s1, s7
    s_cmp_lg_u32 s4, 0
    s_cbranch_scc1 L_ln_done
    ds_read_b64_tr_b16 v[12:13], v60 offset:0
    ds_read_b64_tr_b16 v[14:15], v60 offset:4864
    ds_read_b64_tr_b16 v[16:17], v60 offset:128
    ds_read_b64_tr_b16 v[18:19], v60 offset:4992
    ds_read_b64_tr_b16 v[20:21], v60 offset:256
    ds_read_b64_tr_b16 v[22:23], v60 offset:5120
    ds_read_b64_tr_b16 v[24:25], v60 offset:384
    ds_read_b64_tr_b16 v[26:27], v60 offset:5248
    ds_read_b64_tr_b16 v[28:29], v60 offset:512
    ds_read_b64_tr_b16 v[30:31], v60 offset:5376
    s_waitcnt lgkmcnt(8)
    buffer_store_dwordx4 v[12:15], v63, s[44:47], s56 offen offset:0 sc1
    ds_read_b64_tr_b16 v[32:33], v60 offset:640
    ds_read_b64_tr_b16 v[34:35], v60 offset:5504
    s_waitcnt lgkmcnt(8)
    buffer_store_dwordx4 v[16:19], v63, s[44:47], s56 offen offset:1024 sc1
    ds_read_b64_tr_b16 v[36:37], v60 offset:768
    ds_read_b64_tr_b16 v[38:39], v60 offset:5632
    s_waitcnt lgkmcnt(8)
    buffer_store_dwordx4 v[20:23], v63, s[44:47], s56 offen offset:2048 sc1
    ds_read_b64_tr_b16 v[40:41], v60 offset:896
    ds_read_b64_tr_b16 v[42:43], v60 offset:5760
    s_waitcnt lgkmcnt(8)
    buffer_store_dwordx4 v[24:27], v63, s[44:47], s56 offen offset:3072 sc1
    ds_read_b64_tr_b16 v[44:45], v60 offset:1024
    ds_read_b64_tr_b16 v[46:47], v60 offset:5888
    s_waitcnt lgkmcnt(8)
    buffer_store_dwordx4 v[28:31], v63, s[44:47], s57 offen offset:0 sc1
    ds_read_b32 v5, v62
    s_waitcnt lgkmcnt(0)
    buffer_store_dwordx4 v[32:35], v63, s[44:47], s57 offen offset:1024 sc1
    buffer_store_dwordx4 v[36:39], v63, s[44:47], s57 offen offset:2048 sc1
    buffer_store_dwordx4 v[40:43], v63, s[44:47], s57 offen offset:3072 sc1
    buffer_store_dwordx4 v[44:47], v63, s[44:47], s58 offen offset:0 sc1
    s_mov_b64 exec, 0xff
    buffer_store_dword v5, v61, s[44:47], s59 offen sc1
    s_mov_b64 exec, -1
    s_waitcnt vmcnt(0)
    v_mov_b32 v2, s7
    s_mov_b32 exec_lo, 0xffffffff
    s_mov_b32 exec_hi, 0
    buffer_store_dword v2, v64, s[44:47], s60 offen sc1
    s_mov_b64 exec, -1
L_ln_done:
    s_cmp_ge_u32 s6, 24
    s_cbranch_scc1 L_att
    s_cmp_ge_u32 s4, 4
    s_cbranch_scc1 L_aux
    s_barrier
    s_and_b32 s54, s6, 3
    s_and_b32 s3, s6, 28
    s_and_b32 s55, s6, 16
    s_add_u32 s3, s3, s55
    s_lshr_b64 s[48:49], s[100:101], s3
    s_and_b32 s55, s48, 15
    s_lshr_b32 s3, s5, 1
    s_mul_i32 s3, s3, 12
    s_add_u32 s55, s55, s3
    v_lshrrev_b32 v9, 4, v0
    v_lshlrev_b32 v10, 3, v9
    s_mul_i32 s3, s55, 192
    buffer_load_dwordx2 v[80:81], v10, s[28:31], s3 offen offset:0
    buffer_load_dwordx2 v[82:83], v10, s[28:31], s3 offen offset:32
    buffer_load_dwordx2 v[84:85], v10, s[28:31], s3 offen offset:64
    buffer_load_dwordx2 v[86:87], v10, s[28:31], s3 offen offset:96
    buffer_load_dwordx2 v[88:89], v10, s[28:31], s3 offen offset:128
    buffer_load_dwordx2 v[90:91], v10, s[28:31], s3 offen offset:160
    v_bfe_u32 v11, v0, 2, 2
    v_lshl_add_u32 v11, v9, 3, v11
    v_mul_u32_u24 v11, 192, v11
    v_and_b32 v12, 3, v0
    v_lshl_add_u32 v11, v12, 3, v11
    v_add_u32 v11, 18432, v11
    v_and_b32 v12, 1, v9
    v_lshlrev_b32 v12, 5, v12
    v_add_u32 v5, v11, v12
    v_sub_u32 v6, v11, v12
    v_add_u32 v6, 32, v6
    v_mul_u32_u24 v11, 2304, v9
    v_and_b32 v12, 15, v0
    v_lshl_add_u32 v11, v12, 4, v11
    v_mov_b32 v7, v11
    s_lshr_b32 s58, s5, 1
    s_mul_i32 s60, s6, 43
    s_lshr_b32 s60, s60, 7
    s_mul_i32 s3, s60, 3
    s_sub_u32 s59, s6, s3
    s_and_b32 s3, s5, 1
    s_lshl_b32 s3, s3, 3
    s_add_u32 s60, s60, s3
    s_mul_i32 s3, s4, 3072
    s_add_u32 s3, s3, 147968
    v_lshl_add_u32 v13, v0, 4, s3
    s_and_b32 s3, s4, 1
    s_lshl_b32 s3, s3, 2
    s_add_u32 s3, s3, s58
    s_lshl_b32 s3, s3, 4
    s_lshl_b32 s48, s60, 7
    s_add_u32 s61, s3, s48
    s_lshr_b32 s3, s4, 1
    s_lshl_b32 s48, s59, 1
    s_add_u32 s3, s3, s48
    s_mul_i32 s3, s3, 192
    s_mul_i32 s62, s61, 1152
    s_add_u32 s62, s62, s3
    s_lshl_b32 s61, s61, 1
    v_and_b32 v190, 15, v0
    v_lshrrev_b32 v191, 4, v0
    v_bfe_u32 v192, v0, 2, 2
    v_and_b32 v193, 3, v0
    v_mul_u32_u24 v15, 1152, v190
    v_lshl_add_u32 v15, v191, 4, v15
    v_lshlrev_b32 v12, 1, v190
    v_mul_u32_u24 v14, 9216, v191
    v_lshl_add_u32 v14, v190, 4, v14
    s_mul_i32 s96, s55, 110592
    s_mul_i32 s3, s54, 2304
    s_add_u32 s96, s96, s3
    s_lshl_b32 s3, s4, 9
    s_add_u32 s96, s96, s3
    s_add_u32 s96, s96, 4194304
    s_add_u32 s97, s96, 36864
    s_add_u32 s98, s96, 73728
    s_mul_i32 s53, s58, 24576
    s_and_b32 s3, s5, 1
    s_lshl_b32 s3, s3, 7
    s_add_u32 s53, s53, s3
    s_and_b32 s3, s6, 28
    s_add_u32 s53, s53, s3
    s_add_u32 s53, s53, 655360
    v_sub_u32 v194, s54, v191
    v_lshl_add_u32 v195, v194, 4, v190
    v_lshlrev_b32 v195, 9, v195
    v_lshl_add_u32 v195, v191, 8, v195
    v_cmp_gt_u32 vcc, 3, v194
    v_mov_b32 v196, 2147418112
    s_nop 0
    v_cndmask_b32 v11, v196, v195, vcc
    s_mul_i32 s56, s60, 3
    s_add_u32 s56, s56, s59
    s_lshl_b32 s3, s56, 4
    s_add_u32 s3, s3, s4
    s_lshl_b32 s3, s3, 7
    s_add_u32 s99, s3, 786432
    s_lshl_b32 s3, s58, 9
    s_add_u32 s52, s3, s99
    s_add_u32 s50, s44, s52
    s_addc_u32 s51, s45, 0
    s_load_dword s52, s[50:51], 0 glc
    v_mov_b32 v76, 0xbdd2d3e8
    v_mov_b32 v78, 0xc0135761
    v_mov_b32 v77, 0xbdd2d3e8
    v_mov_b32 v79, 0xc0135761
    v_mul_u32_u24 v176, 3136, v191
    v_lshl_add_u32 v176, v192, 7, v176
    v_lshl_add_u32 v176, v193, 4, v176
    s_lshr_b32 s3, s4, 1
    s_mul_i32 s3, s3, 1536
    v_add_u32 v176, s3, v176
    v_lshl_add_u32 v194, v191, 2, v192
    v_lshlrev_b32 v195, 8, v194
    v_lshl_add_u32 v195, v193, 3, v195
    v_add_u32 v195, 61440, v195
    v_and_b32 v196, 7, v194
    s_add_u32 s3, s58, 0
    s_and_b32 s3, s3, 3
    s_and_b32 s48, s4, 1
    s_lshl_b32 s48, s48, 2
    s_add_u32 s3, s3, s48
    v_xor_b32 v197, s3, v196
    v_lshl_add_u32 v177, v197, 5, v195
    s_add_u32 s3, s58, 1
    s_and_b32 s3, s3, 3
    s_and_b32 s48, s4, 1
    s_lshl_b32 s48, s48, 2
    s_add_u32 s3, s3, s48
    v_xor_b32 v197, s3, v196
    v_lshl_add_u32 v178, v197, 5, v195
    s_add_u32 s3, s58, 2
    s_and_b32 s3, s3, 3
    s_and_b32 s48, s4, 1
    s_lshl_b32 s48, s48, 2
    s_add_u32 s3, s3, s48
    v_xor_b32 v197, s3, v196
    v_lshl_add_u32 v179, v197, 5, v195
    s_add_u32 s3, s58, 3
    s_and_b32 s3, s3, 3
    s_and_b32 s48, s4, 1
    s_lshl_b32 s48, s48, 2
    s_add_u32 s3, s3, s48
    v_xor_b32 v197, s3, v196
    v_lshl_add_u32 v180, v197, 5, v195
    s_and_b32 s3, s4, 1
    s_mul_i32 s3, s3, 4864
    s_add_u32 s3, s3, 50176
    v_lshrrev_b32 v195, 1, v193
    v_mul_u32_u24 v195, 2432, v195
    v_lshl_add_u32 v195, v194, 4, v195
    v_and_b32 v196, 1, v193
    v_lshlrev_b32 v196, 3, v196
    v_add3_u32 v184, v195, v196, s3
    v_mul_u32_u24 v195, 384, v194
    v_lshl_add_u32 v195, v193, 4, v195
    v_bfe_u32 v196, v194, 1, 1
    s_lshr_b32 s3, s4, 1
    s_mul_i32 s3, s3, 3
    s_add_u32 s3, s3, 0
    v_xor_b32 v197, s3, v196
    v_lshl_add_u32 v181, v197, 6, v195
    s_lshr_b32 s3, s4, 1
    s_mul_i32 s3, s3, 3
    s_add_u32 s3, s3, 1
    v_xor_b32 v197, s3, v196
    v_lshl_add_u32 v182, v197, 6, v195
    s_lshr_b32 s3, s4, 1
    s_mul_i32 s3, s3, 3
    s_add_u32 s3, s3, 2
    v_xor_b32 v197, s3, v196
    v_lshl_add_u32 v183, v197, 6, v195
    v_mov_b32 v190, 160256
    v_mov_b32 v191, 0
    ds_write_b32 v190, v191
    ds_write_b32 v190, v191 offset:4
    s_barrier
    s_waitcnt vmcnt(0) lgkmcnt(0)
    v_lshlrev_b32 v16, 16, v80
    v_and_b32 v17, 0xffff0000, v80
    v_lshlrev_b32 v18, 16, v81
    v_and_b32 v19, 0xffff0000, v81
    v_lshlrev_b32 v20, 16, v82
    v_and_b32 v21, 0xffff0000, v82
    v_lshlrev_b32 v22, 16, v83
    v_and_b32 v23, 0xffff0000, v83
    v_lshlrev_b32 v24, 16, v84
    v_and_b32 v25, 0xffff0000, v84
    v_lshlrev_b32 v26, 16, v85
    v_and_b32 v27, 0xffff0000, v85
    v_lshlrev_b32 v28, 16, v86
    v_and_b32 v29, 0xffff0000, v86
    v_lshlrev_b32 v30, 16, v87
    v_and_b32 v31, 0xffff0000, v87
    v_lshlrev_b32 v32, 16, v88
    v_and_b32 v33, 0xffff0000, v88
    v_lshlrev_b32 v34, 16, v89
    v_and_b32 v35, 0xffff0000, v89
    v_lshlrev_b32 v36, 16, v90
    v_and_b32 v37, 0xffff0000, v90
    v_lshlrev_b32 v38, 16, v91
    v_and_b32 v39, 0xffff0000, v91
    v_mov_b32 v40, v16
    v_mov_b32 v41, v17
    v_mov_b32 v42, v18
    v_mov_b32 v43, v19
    v_mov_b32 v44, v20
    v_mov_b32 v45, v21
    v_mov_b32 v46, v22
    v_mov_b32 v47, v23
    v_mov_b32 v48, v24
    v_mov_b32 v49, v25
    v_mov_b32 v50, v26
    v_mov_b32 v51, v27
    v_mov_b32 v52, v28
    v_mov_b32 v53, v29
    v_mov_b32 v54, v30
    v_mov_b32 v55, v31
    v_mov_b32 v56, v32
    v_mov_b32 v57, v33
    v_mov_b32 v58, v34
    v_mov_b32 v59, v35
    v_mov_b32 v60, v36
    v_mov_b32 v61, v37
    v_mov_b32 v62, v38
    v_mov_b32 v63, v39
    s_cmp_lg_u32 s4, 0
    s_cbranch_scc1 L_g1_w1
    v_mov_b32 v64, v16
    v_mov_b32 v65, v17
    v_mov_b32 v66, v18
    v_mov_b32 v67, v19
    v_mov_b32 v68, v20
    v_mov_b32 v69, v21
    v_mov_b32 v70, v22
    v_mov_b32 v71, v23
    v_mov_b32 v72, v24
    v_mov_b32 v73, v25
    v_mov_b32 v74, v26
    v_mov_b32 v75, v27
    v_mov_b32 v1, v5
    v_mov_b32 v2, v6
    v_mov_b32 v3, v7
    s_mov_b32 s56, 30720
    s_mov_b32 s57, 15
    s_barrier
    ds_read_b128 v[104:107], v3 offset:0
    ds_read_b64_tr_b16 v[80:81], v1 offset:0
    ds_read_b64_tr_b16 v[82:83], v1 offset:768
    ds_read_b128 v[108:111], v3 offset:256
    ds_read_b64_tr_b16 v[84:85], v2 offset:0
    ds_read_b64_tr_b16 v[86:87], v2 offset:768
    ds_read_b64_tr_b16 v[88:89], v1 offset:64
    ds_read_b64_tr_b16 v[90:91], v1 offset:832
    ds_read_b64_tr_b16 v[92:93], v2 offset:64
    ds_read_b64_tr_b16 v[94:95], v2 offset:832
    ds_read_b64_tr_b16 v[96:97], v1 offset:128
    ds_read_b64_tr_b16 v[98:99], v1 offset:896
    ds_read_b64_tr_b16 v[100:101], v2 offset:128
    ds_read_b64_tr_b16 v[102:103], v2 offset:896
    ds_read_b128 v[112:115], v3 offset:2048
g1_1:
    s_waitcnt lgkmcnt(11)
    v_mfma_f32_16x16x32_bf16 v[16:19], v[80:83], v[104:107], v[16:19]
    ds_read_b128 v[144:147], v3 offset:9216
    v_add_u32 v4, s56, v5
    v_mfma_f32_16x16x32_bf16 v[40:43], v[80:83], v[108:111], v[40:43]
    ds_read_b64_tr_b16 v[120:121], v1 offset:6144
    s_waitcnt lgkmcnt(9)
    v_mfma_f32_16x16x32_bf16 v[44:47], v[84:87], v[108:111], v[44:47]
    ds_read_b64_tr_b16 v[122:123], v1 offset:6912
    v_add_u32 v8, s56, v6
    v_mfma_f32_16x16x32_bf16 v[20:23], v[84:87], v[104:107], v[20:23]
    ds_read_b128 v[148:151], v3 offset:9472
    v_add_u32 v9, s56, v7
    v_mfma_f32_16x16x32_bf16 v[24:27], v[88:91], v[104:107], v[24:27]
    ds_read_b64_tr_b16 v[124:125], v2 offset:6144
    v_mfma_f32_16x16x32_bf16 v[48:51], v[88:91], v[108:111], v[48:51]
    ds_read_b64_tr_b16 v[126:127], v2 offset:6912
    s_waitcnt lgkmcnt(9)
    v_mfma_f32_16x16x32_bf16 v[52:55], v[92:95], v[108:111], v[52:55]
    ds_read_b64_tr_b16 v[128:129], v1 offset:6208
    v_mfma_f32_16x16x32_bf16 v[28:31], v[92:95], v[104:107], v[28:31]
    ds_read_b64_tr_b16 v[130:131], v1 offset:6976
    v_mfma_f32_16x16x32_bf16 v[32:35], v[96:99], v[104:107], v[32:35]
    ds_read_b64_tr_b16 v[132:133], v2 offset:6208
    v_mfma_f32_16x16x32_bf16 v[56:59], v[96:99], v[108:111], v[56:59]
    ds_read_b64_tr_b16 v[134:135], v2 offset:6976
    s_waitcnt lgkmcnt(10)
    v_mfma_f32_16x16x32_bf16 v[60:63], v[100:103], v[108:111], v[60:63]
    ds_read_b64_tr_b16 v[136:137], v1 offset:6272
    v_mfma_f32_16x16x32_bf16 v[36:39], v[100:103], v[104:107], v[36:39]
    ds_read_b64_tr_b16 v[138:139], v1 offset:7040
    v_mfma_f32_16x16x32_bf16 v[64:67], v[80:83], v[112:115], v[64:67]
    ds_read_b64_tr_b16 v[140:141], v2 offset:6272
    v_mfma_f32_16x16x32_bf16 v[68:71], v[84:87], v[112:115], v[68:71]
    ds_read_b64_tr_b16 v[142:143], v2 offset:7040
    v_mfma_f32_16x16x32_bf16 v[72:75], v[88:91], v[112:115], v[72:75]
    s_waitcnt lgkmcnt(10)
    s_barrier
    v_mfma_f32_16x16x32_bf16 v[16:19], v[120:123], v[144:147], v[16:19]
    ds_read_b128 v[104:107], v9 offset:0
    ds_read_b64_tr_b16 v[80:81], v4 offset:0
    v_mfma_f32_16x16x32_bf16 v[40:43], v[120:123], v[148:151], v[40:43]
    ds_read_b64_tr_b16 v[82:83], v4 offset:768
    s_waitcnt lgkmcnt(9)
    v_mfma_f32_16x16x32_bf16 v[44:47], v[124:127], v[148:151], v[44:47]
    ds_read_b128 v[108:111], v9 offset:256
    ds_read_b64_tr_b16 v[84:85], v8 offset:0
    v_mfma_f32_16x16x32_bf16 v[20:23], v[124:127], v[144:147], v[20:23]
    ds_read_b64_tr_b16 v[86:87], v8 offset:768
    ds_read_b64_tr_b16 v[88:89], v4 offset:64
    v_mfma_f32_16x16x32_bf16 v[24:27], v[128:131], v[144:147], v[24:27]
    ds_read_b64_tr_b16 v[90:91], v4 offset:832
    s_add_u32 s56, s56, 30720
    v_mfma_f32_16x16x32_bf16 v[48:51], v[128:131], v[148:151], v[48:51]
    ds_read_b64_tr_b16 v[92:93], v8 offset:64
    s_waitcnt lgkmcnt(11)
    v_mfma_f32_16x16x32_bf16 v[52:55], v[132:135], v[148:151], v[52:55]
    ds_read_b64_tr_b16 v[94:95], v8 offset:832
    s_cmp_eq_u32 s56, 153600
    v_mfma_f32_16x16x32_bf16 v[28:31], v[132:135], v[144:147], v[28:31]
    ds_read_b64_tr_b16 v[96:97], v4 offset:128
    s_cselect_b32 s56, 0, s56
    v_mfma_f32_16x16x32_bf16 v[32:35], v[136:139], v[144:147], v[32:35]
    ds_read_b64_tr_b16 v[98:99], v4 offset:896
    v_mfma_f32_16x16x32_bf16 v[56:59], v[136:139], v[148:151], v[56:59]
    ds_read_b64_tr_b16 v[100:101], v8 offset:128
    s_waitcnt lgkmcnt(13)
    v_mfma_f32_16x16x32_bf16 v[60:63], v[140:143], v[148:151], v[60:63]
    ds_read_b64_tr_b16 v[102:103], v8 offset:896
    v_mfma_f32_16x16x32_bf16 v[36:39], v[140:143], v[144:147], v[36:39]
    ds_read_b128 v[112:115], v9 offset:2048
    s_waitcnt lgkmcnt(11)
    v_mfma_f32_16x16x32_bf16 v[16:19], v[80:83], v[104:107], v[16:19]
    ds_read_b128 v[144:147], v9 offset:9216
    v_add_u32 v1, s56, v5
    v_mfma_f32_16x16x32_bf16 v[40:43], v[80:83], v[108:111], v[40:43]
    ds_read_b64_tr_b16 v[120:121], v4 offset:6144
    s_waitcnt lgkmcnt(9)
    v_mfma_f32_16x16x32_bf16 v[44:47], v[84:87], v[108:111], v[44:47]
    ds_read_b64_tr_b16 v[122:123], v4 offset:6912
    v_add_u32 v2, s56, v6
    v_mfma_f32_16x16x32_bf16 v[20:23], v[84:87], v[104:107], v[20:23]
    ds_read_b128 v[148:151], v9 offset:9472
    v_add_u32 v3, s56, v7
    v_mfma_f32_16x16x32_bf16 v[24:27], v[88:91], v[104:107], v[24:27]
    ds_read_b64_tr_b16 v[124:125], v8 offset:6144
    v_mfma_f32_16x16x32_bf16 v[48:51], v[88:91], v[108:111], v[48:51]
    ds_read_b64_tr_b16 v[126:127], v8 offset:6912
    s_waitcnt lgkmcnt(9)
    v_mfma_f32_16x16x32_bf16 v[52:55], v[92:95], v[108:111], v[52:55]
    ds_read_b64_tr_b16 v[128:129], v4 offset:6208
    v_mfma_f32_16x16x32_bf16 v[28:31], v[92:95], v[104:107], v[28:31]
    ds_read_b64_tr_b16 v[130:131], v4 offset:6976
    v_mfma_f32_16x16x32_bf16 v[32:35], v[96:99], v[104:107], v[32:35]
    ds_read_b64_tr_b16 v[132:133], v8 offset:6208
    v_mfma_f32_16x16x32_bf16 v[56:59], v[96:99], v[108:111], v[56:59]
    ds_read_b64_tr_b16 v[134:135], v8 offset:6976
    s_waitcnt lgkmcnt(10)
    v_mfma_f32_16x16x32_bf16 v[60:63], v[100:103], v[108:111], v[60:63]
    ds_read_b64_tr_b16 v[136:137], v4 offset:6272
    v_mfma_f32_16x16x32_bf16 v[36:39], v[100:103], v[104:107], v[36:39]
    ds_read_b64_tr_b16 v[138:139], v4 offset:7040
    v_mfma_f32_16x16x32_bf16 v[64:67], v[80:83], v[112:115], v[64:67]
    ds_read_b64_tr_b16 v[140:141], v8 offset:6272
    v_mfma_f32_16x16x32_bf16 v[68:71], v[84:87], v[112:115], v[68:71]
    ds_read_b64_tr_b16 v[142:143], v8 offset:7040
    v_mfma_f32_16x16x32_bf16 v[72:75], v[88:91], v[112:115], v[72:75]
    s_waitcnt lgkmcnt(10)
    s_barrier
    v_mfma_f32_16x16x32_bf16 v[16:19], v[120:123], v[144:147], v[16:19]
    ds_read_b128 v[104:107], v3 offset:0
    ds_read_b64_tr_b16 v[80:81], v1 offset:0
    v_mfma_f32_16x16x32_bf16 v[40:43], v[120:123], v[148:151], v[40:43]
    ds_read_b64_tr_b16 v[82:83], v1 offset:768
    s_waitcnt lgkmcnt(9)
    v_mfma_f32_16x16x32_bf16 v[44:47], v[124:127], v[148:151], v[44:47]
    ds_read_b128 v[108:111], v3 offset:256
    ds_read_b64_tr_b16 v[84:85], v2 offset:0
    v_mfma_f32_16x16x32_bf16 v[20:23], v[124:127], v[144:147], v[20:23]
    ds_read_b64_tr_b16 v[86:87], v2 offset:768
    ds_read_b64_tr_b16 v[88:89], v1 offset:64
    v_mfma_f32_16x16x32_bf16 v[24:27], v[128:131], v[144:147], v[24:27]
    ds_read_b64_tr_b16 v[90:91], v1 offset:832
    ds_read_b64_tr_b16 v[92:93], v2 offset:64
    v_mfma_f32_16x16x32_bf16 v[48:51], v[128:131], v[148:151], v[48:51]
    ds_read_b64_tr_b16 v[94:95], v2 offset:832
    s_waitcnt lgkmcnt(12)
    v_mfma_f32_16x16x32_bf16 v[52:55], v[132:135], v[148:151], v[52:55]
    ds_read_b64_tr_b16 v[96:97], v1 offset:128
    s_add_u32 s56, s56, 30720
    v_mfma_f32_16x16x32_bf16 v[28:31], v[132:135], v[144:147], v[28:31]
    ds_read_b64_tr_b16 v[98:99], v1 offset:896
    s_cmp_eq_u32 s56, 153600
    v_mfma_f32_16x16x32_bf16 v[32:35], v[136:139], v[144:147], v[32:35]
    ds_read_b64_tr_b16 v[100:101], v2 offset:128
    s_cselect_b32 s56, 0, s56
    v_mfma_f32_16x16x32_bf16 v[56:59], v[136:139], v[148:151], v[56:59]
    ds_read_b64_tr_b16 v[102:103], v2 offset:896
    s_waitcnt lgkmcnt(14)
    v_mfma_f32_16x16x32_bf16 v[60:63], v[140:143], v[148:151], v[60:63]
    ds_read_b128 v[112:115], v3 offset:2048
    s_sub_u32 s57, s57, 1
    v_mfma_f32_16x16x32_bf16 v[36:39], v[140:143], v[144:147], v[36:39]
    s_cmp_lg_u32 s57, 0
    s_cbranch_scc1 g1_1
    s_waitcnt lgkmcnt(11)
    v_mfma_f32_16x16x32_bf16 v[16:19], v[80:83], v[104:107], v[16:19]
    ds_read_b128 v[144:147], v3 offset:9216
    v_add_u32 v4, s56, v5
    v_mfma_f32_16x16x32_bf16 v[40:43], v[80:83], v[108:111], v[40:43]
    ds_read_b64_tr_b16 v[120:121], v1 offset:6144
    s_waitcnt lgkmcnt(9)
    v_mfma_f32_16x16x32_bf16 v[44:47], v[84:87], v[108:111], v[44:47]
    ds_read_b64_tr_b16 v[122:123], v1 offset:6912
    v_add_u32 v8, s56, v6
    v_mfma_f32_16x16x32_bf16 v[20:23], v[84:87], v[104:107], v[20:23]
    ds_read_b128 v[148:151], v3 offset:9472
    v_add_u32 v9, s56, v7
    v_mfma_f32_16x16x32_bf16 v[24:27], v[88:91], v[104:107], v[24:27]
    ds_read_b64_tr_b16 v[124:125], v2 offset:6144
    v_mfma_f32_16x16x32_bf16 v[48:51], v[88:91], v[108:111], v[48:51]
    ds_read_b64_tr_b16 v[126:127], v2 offset:6912
    s_waitcnt lgkmcnt(9)
    v_mfma_f32_16x16x32_bf16 v[52:55], v[92:95], v[108:111], v[52:55]
    ds_read_b64_tr_b16 v[128:129], v1 offset:6208
    v_mfma_f32_16x16x32_bf16 v[28:31], v[92:95], v[104:107], v[28:31]
    ds_read_b64_tr_b16 v[130:131], v1 offset:6976
    v_mfma_f32_16x16x32_bf16 v[32:35], v[96:99], v[104:107], v[32:35]
    ds_read_b64_tr_b16 v[132:133], v2 offset:6208
    v_mfma_f32_16x16x32_bf16 v[56:59], v[96:99], v[108:111], v[56:59]
    ds_read_b64_tr_b16 v[134:135], v2 offset:6976
    s_waitcnt lgkmcnt(10)
    v_mfma_f32_16x16x32_bf16 v[60:63], v[100:103], v[108:111], v[60:63]
    ds_read_b64_tr_b16 v[136:137], v1 offset:6272
    v_mfma_f32_16x16x32_bf16 v[36:39], v[100:103], v[104:107], v[36:39]
    ds_read_b64_tr_b16 v[138:139], v1 offset:7040
    v_mfma_f32_16x16x32_bf16 v[64:67], v[80:83], v[112:115], v[64:67]
    ds_read_b64_tr_b16 v[140:141], v2 offset:6272
    v_mfma_f32_16x16x32_bf16 v[68:71], v[84:87], v[112:115], v[68:71]
    ds_read_b64_tr_b16 v[142:143], v2 offset:7040
    v_mfma_f32_16x16x32_bf16 v[72:75], v[88:91], v[112:115], v[72:75]
    s_waitcnt lgkmcnt(10)
    s_barrier
    v_mfma_f32_16x16x32_bf16 v[16:19], v[120:123], v[144:147], v[16:19]
    ds_read_b128 v[104:107], v9 offset:0
    ds_read_b64_tr_b16 v[80:81], v4 offset:0
    v_mfma_f32_16x16x32_bf16 v[40:43], v[120:123], v[148:151], v[40:43]
    ds_read_b64_tr_b16 v[82:83], v4 offset:768
    s_waitcnt lgkmcnt(9)
    v_mfma_f32_16x16x32_bf16 v[44:47], v[124:127], v[148:151], v[44:47]
    ds_read_b128 v[108:111], v9 offset:256
    ds_read_b64_tr_b16 v[84:85], v8 offset:0
    v_mfma_f32_16x16x32_bf16 v[20:23], v[124:127], v[144:147], v[20:23]
    ds_read_b64_tr_b16 v[86:87], v8 offset:768
    ds_read_b64_tr_b16 v[88:89], v4 offset:64
    v_mfma_f32_16x16x32_bf16 v[24:27], v[128:131], v[144:147], v[24:27]
    ds_read_b64_tr_b16 v[90:91], v4 offset:832
    ds_read_b64_tr_b16 v[92:93], v8 offset:64
    v_mfma_f32_16x16x32_bf16 v[48:51], v[128:131], v[148:151], v[48:51]
    ds_read_b64_tr_b16 v[94:95], v8 offset:832
    s_waitcnt lgkmcnt(12)
    v_mfma_f32_16x16x32_bf16 v[52:55], v[132:135], v[148:151], v[52:55]
    ds_read_b64_tr_b16 v[96:97], v4 offset:128
    s_add_u32 s56, s56, 30720
    v_mfma_f32_16x16x32_bf16 v[28:31], v[132:135], v[144:147], v[28:31]
    ds_read_b64_tr_b16 v[98:99], v4 offset:896
    s_cmp_eq_u32 s56, 153600
    v_mfma_f32_16x16x32_bf16 v[32:35], v[136:139], v[144:147], v[32:35]
    ds_read_b64_tr_b16 v[100:101], v8 offset:128
    s_cselect_b32 s56, 0, s56
    v_mfma_f32_16x16x32_bf16 v[56:59], v[136:139], v[148:151], v[56:59]
    ds_read_b64_tr_b16 v[102:103], v8 offset:896
    s_waitcnt lgkmcnt(14)
    v_mfma_f32_16x16x32_bf16 v[60:63], v[140:143], v[148:151], v[60:63]
    ds_read_b128 v[112:115], v9 offset:2048
    buffer_load_dwordx4 v[160:163], v15, s[8:11], s62 offen offset:0
    v_mfma_f32_16x16x32_bf16 v[36:39], v[140:143], v[144:147], v[36:39]
    buffer_load_dwordx4 v[164:167], v15, s[8:11], s62 offen offset:64
    buffer_load_dwordx4 v[168:171], v15, s[8:11], s62 offen offset:128
    buffer_load_ushort v172, v12, s[36:39], s61 offen
    s_waitcnt lgkmcnt(11)
    v_mfma_f32_16x16x32_bf16 v[16:19], v[80:83], v[104:107], v[16:19]
    ds_read_b128 v[144:147], v9 offset:9216
    v_mfma_f32_16x16x32_bf16 v[40:43], v[80:83], v[108:111], v[40:43]
    ds_read_b64_tr_b16 v[120:121], v4 offset:6144
    s_waitcnt lgkmcnt(9)
    v_mfma_f32_16x16x32_bf16 v[44:47], v[84:87], v[108:111], v[44:47]
    ds_read_b64_tr_b16 v[122:123], v4 offset:6912
    v_mfma_f32_16x16x32_bf16 v[20:23], v[84:87], v[104:107], v[20:23]
    ds_read_b128 v[148:151], v9 offset:9472
    v_mfma_f32_16x16x32_bf16 v[24:27], v[88:91], v[104:107], v[24:27]
    ds_read_b64_tr_b16 v[124:125], v8 offset:6144
    v_mfma_f32_16x16x32_bf16 v[48:51], v[88:91], v[108:111], v[48:51]
    ds_read_b64_tr_b16 v[126:127], v8 offset:6912
    s_waitcnt lgkmcnt(9)
    v_mfma_f32_16x16x32_bf16 v[52:55], v[92:95], v[108:111], v[52:55]
    ds_read_b64_tr_b16 v[128:129], v4 offset:6208
    v_mfma_f32_16x16x32_bf16 v[28:31], v[92:95], v[104:107], v[28:31]
    ds_read_b64_tr_b16 v[130:131], v4 offset:6976
    v_mfma_f32_16x16x32_bf16 v[32:35], v[96:99], v[104:107], v[32:35]
    ds_read_b64_tr_b16 v[132:133], v8 offset:6208
    v_mfma_f32_16x16x32_bf16 v[56:59], v[96:99], v[108:111], v[56:59]
    ds_read_b64_tr_b16 v[134:135], v8 offset:6976
    s_waitcnt lgkmcnt(10)
    v_mfma_f32_16x16x32_bf16 v[60:63], v[100:103], v[108:111], v[60:63]
    ds_read_b64_tr_b16 v[136:137], v4 offset:6272
    v_mfma_f32_16x16x32_bf16 v[36:39], v[100:103], v[104:107], v[36:39]
    ds_read_b64_tr_b16 v[138:139], v4 offset:7040
    v_mfma_f32_16x16x32_bf16 v[64:67], v[80:83], v[112:115], v[64:67]
    ds_read_b64_tr_b16 v[140:141], v8 offset:6272
    v_mfma_f32_16x16x32_bf16 v[68:71], v[84:87], v[112:115], v[68:71]
    ds_read_b64_tr_b16 v[142:143], v8 offset:7040
    v_mfma_f32_16x16x32_bf16 v[72:75], v[88:91], v[112:115], v[72:75]
    s_waitcnt lgkmcnt(0)
    v_mfma_f32_16x16x32_bf16 v[16:19], v[120:123], v[144:147], v[16:19]
    v_mfma_f32_16x16x32_bf16 v[40:43], v[120:123], v[148:151], v[40:43]
    v_mfma_f32_16x16x32_bf16 v[44:47], v[124:127], v[148:151], v[44:47]
    v_mfma_f32_16x16x32_bf16 v[20:23], v[124:127], v[144:147], v[20:23]
    v_mfma_f32_16x16x32_bf16 v[24:27], v[128:131], v[144:147], v[24:27]
    v_mfma_f32_16x16x32_bf16 v[48:51], v[128:131], v[148:151], v[48:51]
    v_mfma_f32_16x16x32_bf16 v[52:55], v[132:135], v[148:151], v[52:55]
    v_mfma_f32_16x16x32_bf16 v[28:31], v[132:135], v[144:147], v[28:31]
    v_mfma_f32_16x16x32_bf16 v[32:35], v[136:139], v[144:147], v[32:35]
    v_mfma_f32_16x16x32_bf16 v[56:59], v[136:139], v[148:151], v[56:59]
    v_mfma_f32_16x16x32_bf16 v[60:63], v[140:143], v[148:151], v[60:63]
    v_mfma_f32_16x16x32_bf16 v[36:39], v[140:143], v[144:147], v[36:39]
    s_branch L_g1_done
L_g1_w1:
    s_cmp_lg_u32 s4, 1
    s_cbranch_scc1 L_g1_w2
    v_mov_b32 v64, 0
    v_mov_b32 v65, 0
    v_mov_b32 v66, 0
    v_mov_b32 v67, 0
    v_mov_b32 v68, 0
    v_mov_b32 v69, 0
    v_mov_b32 v70, 0
    v_mov_b32 v71, 0
    v_mov_b32 v72, 0
    v_mov_b32 v73, 0
    v_mov_b32 v74, 0
    v_mov_b32 v75, 0
    v_mov_b32 v1, v5
    v_mov_b32 v2, v6
    v_mov_b32 v3, v7
    s_mov_b32 s56, 30720
    s_mov_b32 s57, 15
    s_barrier
    ds_read_b128 v[104:107], v3 offset:512
    ds_read_b64_tr_b16 v[80:81], v1 offset:0
    ds_read_b64_tr_b16 v[82:83], v1 offset:768
    ds_read_b128 v[108:111], v3 offset:768
    ds_read_b64_tr_b16 v[84:85], v2 offset:0
    ds_read_b64_tr_b16 v[86:87], v2 offset:768
    ds_read_b64_tr_b16 v[88:89], v1 offset:64
    ds_read_b64_tr_b16 v[90:91], v1 offset:832
    ds_read_b64_tr_b16 v[92:93], v2 offset:64
    ds_read_b64_tr_b16 v[94:95], v2 offset:832
    ds_read_b64_tr_b16 v[96:97], v1 offset:128
    ds_read_b64_tr_b16 v[98:99], v1 offset:896
    ds_read_b64_tr_b16 v[100:101], v2 offset:128
    ds_read_b64_tr_b16 v[102:103], v2 offset:896
g1_2:
    s_waitcnt lgkmcnt(10)
    v_mfma_f32_16x16x32_bf16 v[16:19], v[80:83], v[104:107], v[16:19]
    ds_read_b128 v[144:147], v3 offset:9728
    ds_read_b64_tr_b16 v[120:121], v1 offset:6144
    v_mfma_f32_16x16x32_bf16 v[40:43], v[80:83], v[108:111], v[40:43]
    ds_read_b64_tr_b16 v[122:123], v1 offset:6912
    s_waitcnt lgkmcnt(9)
    v_mfma_f32_16x16x32_bf16 v[44:47], v[84:87], v[108:111], v[44:47]
    ds_read_b128 v[148:151], v3 offset:9984
    ds_read_b64_tr_b16 v[124:125], v2 offset:6144
    v_mfma_f32_16x16x32_bf16 v[20:23], v[84:87], v[104:107], v[20:23]
    ds_read_b64_tr_b16 v[126:127], v2 offset:6912
    ds_read_b64_tr_b16 v[128:129], v1 offset:6208
    v_mfma_f32_16x16x32_bf16 v[24:27], v[88:91], v[104:107], v[24:27]
    ds_read_b64_tr_b16 v[130:131], v1 offset:6976
    ds_read_b64_tr_b16 v[132:133], v2 offset:6208
    v_mfma_f32_16x16x32_bf16 v[48:51], v[88:91], v[108:111], v[48:51]
    ds_read_b64_tr_b16 v[134:135], v2 offset:6976
    s_waitcnt lgkmcnt(12)
    v_mfma_f32_16x16x32_bf16 v[52:55], v[92:95], v[108:111], v[52:55]
    ds_read_b64_tr_b16 v[136:137], v1 offset:6272
    v_add_u32 v4, s56, v5
    v_mfma_f32_16x16x32_bf16 v[28:31], v[92:95], v[104:107], v[28:31]
    ds_read_b64_tr_b16 v[138:139], v1 offset:7040
    v_add_u32 v8, s56, v6
    v_mfma_f32_16x16x32_bf16 v[32:35], v[96:99], v[104:107], v[32:35]
    ds_read_b64_tr_b16 v[140:141], v2 offset:6272
    v_add_u32 v9, s56, v7
    v_mfma_f32_16x16x32_bf16 v[56:59], v[96:99], v[108:111], v[56:59]
    ds_read_b64_tr_b16 v[142:143], v2 offset:7040
    s_waitcnt lgkmcnt(14)
    v_mfma_f32_16x16x32_bf16 v[60:63], v[100:103], v[108:111], v[60:63]
    ds_read_b128 v[152:155], v3 offset:11264
    v_mfma_f32_16x16x32_bf16 v[36:39], v[100:103], v[104:107], v[36:39]
    s_waitcnt lgkmcnt(11)
    s_barrier
    v_mfma_f32_16x16x32_bf16 v[16:19], v[120:123], v[144:147], v[16:19]
    ds_read_b128 v[104:107], v9 offset:512
    s_add_u32 s56, s56, 30720
    v_mfma_f32_16x16x32_bf16 v[40:43], v[120:123], v[148:151], v[40:43]
    ds_read_b64_tr_b16 v[80:81], v4 offset:0
    s_waitcnt lgkmcnt(9)
    v_mfma_f32_16x16x32_bf16 v[44:47], v[124:127], v[148:151], v[44:47]
    ds_read_b64_tr_b16 v[82:83], v4 offset:768
    s_cmp_eq_u32 s56, 153600
    v_mfma_f32_16x16x32_bf16 v[20:23], v[124:127], v[144:147], v[20:23]
    ds_read_b128 v[108:111], v9 offset:768
    s_cselect_b32 s56, 0, s56
    v_mfma_f32_16x16x32_bf16 v[24:27], v[128:131], v[144:147], v[24:27]
    ds_read_b64_tr_b16 v[84:85], v8 offset:0
    v_mfma_f32_16x16x32_bf16 v[48:51], v[128:131], v[148:151], v[48:51]
    ds_read_b64_tr_b16 v[86:87], v8 offset:768
    s_waitcnt lgkmcnt(9)
    v_mfma_f32_16x16x32_bf16 v[52:55], v[132:135], v[148:151], v[52:55]
    ds_read_b64_tr_b16 v[88:89], v4 offset:64
    v_mfma_f32_16x16x32_bf16 v[28:31], v[132:135], v[144:147], v[28:31]
    ds_read_b64_tr_b16 v[90:91], v4 offset:832
    v_mfma_f32_16x16x32_bf16 v[32:35], v[136:139], v[144:147], v[32:35]
    ds_read_b64_tr_b16 v[92:93], v8 offset:64
    v_mfma_f32_16x16x32_bf16 v[56:59], v[136:139], v[148:151], v[56:59]
    ds_read_b64_tr_b16 v[94:95], v8 offset:832
    s_waitcnt lgkmcnt(10)
    v_mfma_f32_16x16x32_bf16 v[60:63], v[140:143], v[148:151], v[60:63]
    ds_read_b64_tr_b16 v[96:97], v4 offset:128
    v_mfma_f32_16x16x32_bf16 v[36:39], v[140:143], v[144:147], v[36:39]
    ds_read_b64_tr_b16 v[98:99], v4 offset:896
    v_mfma_f32_16x16x32_bf16 v[64:67], v[120:123], v[152:155], v[64:67]
    ds_read_b64_tr_b16 v[100:101], v8 offset:128
    v_mfma_f32_16x16x32_bf16 v[68:71], v[124:127], v[152:155], v[68:71]
    ds_read_b64_tr_b16 v[102:103], v8 offset:896
    v_mfma_f32_16x16x32_bf16 v[72:75], v[128:131], v[152:155], v[72:75]
    s_waitcnt lgkmcnt(10)
    v_mfma_f32_16x16x32_bf16 v[16:19], v[80:83], v[104:107], v[16:19]
    ds_read_b128 v[144:147], v9 offset:9728
    ds_read_b64_tr_b16 v[120:121], v4 offset:6144
    v_mfma_f32_16x16x32_bf16 v[40:43], v[80:83], v[108:111], v[40:43]
    ds_read_b64_tr_b16 v[122:123], v4 offset:6912
    s_waitcnt lgkmcnt(9)
    v_mfma_f32_16x16x32_bf16 v[44:47], v[84:87], v[108:111], v[44:47]
    ds_read_b128 v[148:151], v9 offset:9984
    ds_read_b64_tr_b16 v[124:125], v8 offset:6144
    v_mfma_f32_16x16x32_bf16 v[20:23], v[84:87], v[104:107], v[20:23]
    ds_read_b64_tr_b16 v[126:127], v8 offset:6912
    ds_read_b64_tr_b16 v[128:129], v4 offset:6208
    v_mfma_f32_16x16x32_bf16 v[24:27], v[88:91], v[104:107], v[24:27]
    ds_read_b64_tr_b16 v[130:131], v4 offset:6976
    ds_read_b64_tr_b16 v[132:133], v8 offset:6208
    v_mfma_f32_16x16x32_bf16 v[48:51], v[88:91], v[108:111], v[48:51]
    ds_read_b64_tr_b16 v[134:135], v8 offset:6976
    s_waitcnt lgkmcnt(12)
    v_mfma_f32_16x16x32_bf16 v[52:55], v[92:95], v[108:111], v[52:55]
    ds_read_b64_tr_b16 v[136:137], v4 offset:6272
    v_add_u32 v1, s56, v5
    v_mfma_f32_16x16x32_bf16 v[28:31], v[92:95], v[104:107], v[28:31]
    ds_read_b64_tr_b16 v[138:139], v4 offset:7040
    v_add_u32 v2, s56, v6
    v_mfma_f32_16x16x32_bf16 v[32:35], v[96:99], v[104:107], v[32:35]
    ds_read_b64_tr_b16 v[140:141], v8 offset:6272
    v_add_u32 v3, s56, v7
    v_mfma_f32_16x16x32_bf16 v[56:59], v[96:99], v[108:111], v[56:59]
    ds_read_b64_tr_b16 v[142:143], v8 offset:7040
    s_waitcnt lgkmcnt(14)
    v_mfma_f32_16x16x32_bf16 v[60:63], v[100:103], v[108:111], v[60:63]
    ds_read_b128 v[152:155], v9 offset:11264
    v_mfma_f32_16x16x32_bf16 v[36:39], v[100:103], v[104:107], v[36:39]
    s_waitcnt lgkmcnt(11)
    s_barrier
    v_mfma_f32_16x16x32_bf16 v[16:19], v[120:123], v[144:147], v[16:19]
    ds_read_b128 v[104:107], v3 offset:512
    s_add_u32 s56, s56, 30720
    v_mfma_f32_16x16x32_bf16 v[40:43], v[120:123], v[148:151], v[40:43]
    ds_read_b64_tr_b16 v[80:81], v1 offset:0
    s_waitcnt lgkmcnt(9)
    v_mfma_f32_16x16x32_bf16 v[44:47], v[124:127], v[148:151], v[44:47]
    ds_read_b64_tr_b16 v[82:83], v1 offset:768
    s_cmp_eq_u32 s56, 153600
    v_mfma_f32_16x16x32_bf16 v[20:23], v[124:127], v[144:147], v[20:23]
    ds_read_b128 v[108:111], v3 offset:768
    s_cselect_b32 s56, 0, s56
    v_mfma_f32_16x16x32_bf16 v[24:27], v[128:131], v[144:147], v[24:27]
    ds_read_b64_tr_b16 v[84:85], v2 offset:0
    s_sub_u32 s57, s57, 1
    v_mfma_f32_16x16x32_bf16 v[48:51], v[128:131], v[148:151], v[48:51]
    ds_read_b64_tr_b16 v[86:87], v2 offset:768
    s_waitcnt lgkmcnt(9)
    v_mfma_f32_16x16x32_bf16 v[52:55], v[132:135], v[148:151], v[52:55]
    ds_read_b64_tr_b16 v[88:89], v1 offset:64
    s_cmp_lg_u32 s57, 0
    v_mfma_f32_16x16x32_bf16 v[28:31], v[132:135], v[144:147], v[28:31]
    ds_read_b64_tr_b16 v[90:91], v1 offset:832
    v_mfma_f32_16x16x32_bf16 v[32:35], v[136:139], v[144:147], v[32:35]
    ds_read_b64_tr_b16 v[92:93], v2 offset:64
    v_mfma_f32_16x16x32_bf16 v[56:59], v[136:139], v[148:151], v[56:59]
    ds_read_b64_tr_b16 v[94:95], v2 offset:832
    s_waitcnt lgkmcnt(10)
    v_mfma_f32_16x16x32_bf16 v[60:63], v[140:143], v[148:151], v[60:63]
    ds_read_b64_tr_b16 v[96:97], v1 offset:128
    v_mfma_f32_16x16x32_bf16 v[36:39], v[140:143], v[144:147], v[36:39]
    ds_read_b64_tr_b16 v[98:99], v1 offset:896
    v_mfma_f32_16x16x32_bf16 v[64:67], v[120:123], v[152:155], v[64:67]
    ds_read_b64_tr_b16 v[100:101], v2 offset:128
    v_mfma_f32_16x16x32_bf16 v[68:71], v[124:127], v[152:155], v[68:71]
    ds_read_b64_tr_b16 v[102:103], v2 offset:896
    v_mfma_f32_16x16x32_bf16 v[72:75], v[128:131], v[152:155], v[72:75]
    s_cbranch_scc1 g1_2
    s_waitcnt lgkmcnt(10)
    v_mfma_f32_16x16x32_bf16 v[16:19], v[80:83], v[104:107], v[16:19]
    ds_read_b128 v[144:147], v3 offset:9728
    ds_read_b64_tr_b16 v[120:121], v1 offset:6144
    v_mfma_f32_16x16x32_bf16 v[40:43], v[80:83], v[108:111], v[40:43]
    ds_read_b64_tr_b16 v[122:123], v1 offset:6912
    s_waitcnt lgkmcnt(9)
    v_mfma_f32_16x16x32_bf16 v[44:47], v[84:87], v[108:111], v[44:47]
    ds_read_b128 v[148:151], v3 offset:9984
    ds_read_b64_tr_b16 v[124:125], v2 offset:6144
    v_mfma_f32_16x16x32_bf16 v[20:23], v[84:87], v[104:107], v[20:23]
    ds_read_b64_tr_b16 v[126:127], v2 offset:6912
    ds_read_b64_tr_b16 v[128:129], v1 offset:6208
    v_mfma_f32_16x16x32_bf16 v[24:27], v[88:91], v[104:107], v[24:27]
    ds_read_b64_tr_b16 v[130:131], v1 offset:6976
    ds_read_b64_tr_b16 v[132:133], v2 offset:6208
    v_mfma_f32_16x16x32_bf16 v[48:51], v[88:91], v[108:111], v[48:51]
    ds_read_b64_tr_b16 v[134:135], v2 offset:6976
    s_waitcnt lgkmcnt(12)
    v_mfma_f32_16x16x32_bf16 v[52:55], v[92:95], v[108:111], v[52:55]
    ds_read_b64_tr_b16 v[136:137], v1 offset:6272
    v_add_u32 v4, s56, v5
    v_mfma_f32_16x16x32_bf16 v[28:31], v[92:95], v[104:107], v[28:31]
    ds_read_b64_tr_b16 v[138:139], v1 offset:7040
    v_add_u32 v8, s56, v6
    v_mfma_f32_16x16x32_bf16 v[32:35], v[96:99], v[104:107], v[32:35]
    ds_read_b64_tr_b16 v[140:141], v2 offset:6272
    v_add_u32 v9, s56, v7
    v_mfma_f32_16x16x32_bf16 v[56:59], v[96:99], v[108:111], v[56:59]
    ds_read_b64_tr_b16 v[142:143], v2 offset:7040
    s_waitcnt lgkmcnt(14)
    v_mfma_f32_16x16x32_bf16 v[60:63], v[100:103], v[108:111], v[60:63]
    ds_read_b128 v[152:155], v3 offset:11264
    v_mfma_f32_16x16x32_bf16 v[36:39], v[100:103], v[104:107], v[36:39]
    s_waitcnt lgkmcnt(11)
    s_barrier
    v_mfma_f32_16x16x32_bf16 v[16:19], v[120:123], v[144:147], v[16:19]
    ds_read_b128 v[104:107], v9 offset:512
    s_add_u32 s56, s56, 30720
    v_mfma_f32_16x16x32_bf16 v[40:43], v[120:123], v[148:151], v[40:43]
    ds_read_b64_tr_b16 v[80:81], v4 offset:0
    s_waitcnt lgkmcnt(9)
    v_mfma_f32_16x16x32_bf16 v[44:47], v[124:127], v[148:151], v[44:47]
    ds_read_b64_tr_b16 v[82:83], v4 offset:768
    s_cmp_eq_u32 s56, 153600
    v_mfma_f32_16x16x32_bf16 v[20:23], v[124:127], v[144:147], v[20:23]
    ds_read_b128 v[108:111], v9 offset:768
    s_cselect_b32 s56, 0, s56
    v_mfma_f32_16x16x32_bf16 v[24:27], v[128:131], v[144:147], v[24:27]
    ds_read_b64_tr_b16 v[84:85], v8 offset:0
    buffer_load_dwordx4 v[160:163], v15, s[8:11], s62 offen offset:0
    v_mfma_f32_16x16x32_bf16 v[48:51], v[128:131], v[148:151], v[48:51]
    ds_read_b64_tr_b16 v[86:87], v8 offset:768
    s_waitcnt lgkmcnt(9)
    v_mfma_f32_16x16x32_bf16 v[52:55], v[132:135], v[148:151], v[52:55]
    ds_read_b64_tr_b16 v[88:89], v4 offset:64
    buffer_load_dwordx4 v[164:167], v15, s[8:11], s62 offen offset:64
    v_mfma_f32_16x16x32_bf16 v[28:31], v[132:135], v[144:147], v[28:31]
    ds_read_b64_tr_b16 v[90:91], v4 offset:832
    buffer_load_dwordx4 v[168:171], v15, s[8:11], s62 offen offset:128
    v_mfma_f32_16x16x32_bf16 v[32:35], v[136:139], v[144:147], v[32:35]
    ds_read_b64_tr_b16 v[92:93], v8 offset:64
    buffer_load_ushort v172, v12, s[36:39], s61 offen
    v_mfma_f32_16x16x32_bf16 v[56:59], v[136:139], v[148:151], v[56:59]
    ds_read_b64_tr_b16 v[94:95], v8 offset:832
    s_waitcnt lgkmcnt(10)
    v_mfma_f32_16x16x32_bf16 v[60:63], v[140:143], v[148:151], v[60:63]
    ds_read_b64_tr_b16 v[96:97], v4 offset:128
    v_mfma_f32_16x16x32_bf16 v[36:39], v[140:143], v[144:147], v[36:39]
    ds_read_b64_tr_b16 v[98:99], v4 offset:896
    v_mfma_f32_16x16x32_bf16 v[64:67], v[120:123], v[152:155], v[64:67]
    ds_read_b64_tr_b16 v[100:101], v8 offset:128
    v_mfma_f32_16x16x32_bf16 v[68:71], v[124:127], v[152:155], v[68:71]
    ds_read_b64_tr_b16 v[102:103], v8 offset:896
    v_mfma_f32_16x16x32_bf16 v[72:75], v[128:131], v[152:155], v[72:75]
    s_waitcnt lgkmcnt(10)
    v_mfma_f32_16x16x32_bf16 v[16:19], v[80:83], v[104:107], v[16:19]
    ds_read_b128 v[144:147], v9 offset:9728
    ds_read_b64_tr_b16 v[120:121], v4 offset:6144
    v_mfma_f32_16x16x32_bf16 v[40:43], v[80:83], v[108:111], v[40:43]
    ds_read_b64_tr_b16 v[122:123], v4 offset:6912
    s_waitcnt lgkmcnt(9)
    v_mfma_f32_16x16x32_bf16 v[44:47], v[84:87], v[108:111], v[44:47]
    ds_read_b128 v[148:151], v9 offset:9984
    ds_read_b64_tr_b16 v[124:125], v8 offset:6144
    v_mfma_f32_16x16x32_bf16 v[20:23], v[84:87], v[104:107], v[20:23]
    ds_read_b64_tr_b16 v[126:127], v8 offset:6912
    ds_read_b64_tr_b16 v[128:129], v4 offset:6208
    v_mfma_f32_16x16x32_bf16 v[24:27], v[88:91], v[104:107], v[24:27]
    ds_read_b64_tr_b16 v[130:131], v4 offset:6976
    ds_read_b64_tr_b16 v[132:133], v8 offset:6208
    v_mfma_f32_16x16x32_bf16 v[48:51], v[88:91], v[108:111], v[48:51]
    ds_read_b64_tr_b16 v[134:135], v8 offset:6976
    s_waitcnt lgkmcnt(12)
    v_mfma_f32_16x16x32_bf16 v[52:55], v[92:95], v[108:111], v[52:55]
    ds_read_b64_tr_b16 v[136:137], v4 offset:6272
    v_mfma_f32_16x16x32_bf16 v[28:31], v[92:95], v[104:107], v[28:31]
    ds_read_b64_tr_b16 v[138:139], v4 offset:7040
    v_mfma_f32_16x16x32_bf16 v[32:35], v[96:99], v[104:107], v[32:35]
    ds_read_b64_tr_b16 v[140:141], v8 offset:6272
    v_mfma_f32_16x16x32_bf16 v[56:59], v[96:99], v[108:111], v[56:59]
    ds_read_b64_tr_b16 v[142:143], v8 offset:7040
    s_waitcnt lgkmcnt(14)
    v_mfma_f32_16x16x32_bf16 v[60:63], v[100:103], v[108:111], v[60:63]
    ds_read_b128 v[152:155], v9 offset:11264
    v_mfma_f32_16x16x32_bf16 v[36:39], v[100:103], v[104:107], v[36:39]
    s_waitcnt lgkmcnt(0)
    v_mfma_f32_16x16x32_bf16 v[64:67], v[120:123], v[152:155], v[64:67]
    v_mfma_f32_16x16x32_bf16 v[68:71], v[124:127], v[152:155], v[68:71]
    v_mfma_f32_16x16x32_bf16 v[72:75], v[128:131], v[152:155], v[72:75]
    v_mfma_f32_16x16x32_bf16 v[16:19], v[120:123], v[144:147], v[16:19]
    v_mfma_f32_16x16x32_bf16 v[40:43], v[120:123], v[148:151], v[40:43]
    v_mfma_f32_16x16x32_bf16 v[44:47], v[124:127], v[148:151], v[44:47]
    v_mfma_f32_16x16x32_bf16 v[20:23], v[124:127], v[144:147], v[20:23]
    v_mfma_f32_16x16x32_bf16 v[24:27], v[128:131], v[144:147], v[24:27]
    v_mfma_f32_16x16x32_bf16 v[48:51], v[128:131], v[148:151], v[48:51]
    v_mfma_f32_16x16x32_bf16 v[52:55], v[132:135], v[148:151], v[52:55]
    v_mfma_f32_16x16x32_bf16 v[28:31], v[132:135], v[144:147], v[28:31]
    v_mfma_f32_16x16x32_bf16 v[32:35], v[136:139], v[144:147], v[32:35]
    v_mfma_f32_16x16x32_bf16 v[56:59], v[136:139], v[148:151], v[56:59]
    v_mfma_f32_16x16x32_bf16 v[60:63], v[140:143], v[148:151], v[60:63]
    v_mfma_f32_16x16x32_bf16 v[36:39], v[140:143], v[144:147], v[36:39]
    s_branch L_g1_done
L_g1_w2:
    s_cmp_lg_u32 s4, 2
    s_cbranch_scc1 L_g1_w3
    v_mov_b32 v64, v28
    v_mov_b32 v65, v29
    v_mov_b32 v66, v30
    v_mov_b32 v67, v31
    v_mov_b32 v68, v32
    v_mov_b32 v69, v33
    v_mov_b32 v70, v34
    v_mov_b32 v71, v35
    v_mov_b32 v72, v36
    v_mov_b32 v73, v37
    v_mov_b32 v74, v38
    v_mov_b32 v75, v39
    v_mov_b32 v1, v5
    v_mov_b32 v2, v6
    v_mov_b32 v3, v7
    s_mov_b32 s56, 30720
    s_mov_b32 s57, 15
    s_barrier
    ds_read_b128 v[104:107], v3 offset:1024
    ds_read_b64_tr_b16 v[80:81], v1 offset:0
    ds_read_b64_tr_b16 v[82:83], v1 offset:768
    ds_read_b128 v[108:111], v3 offset:1280
    ds_read_b64_tr_b16 v[84:85], v2 offset:0
    ds_read_b64_tr_b16 v[86:87], v2 offset:768
    ds_read_b64_tr_b16 v[88:89], v1 offset:64
    ds_read_b64_tr_b16 v[90:91], v1 offset:832
    ds_read_b64_tr_b16 v[92:93], v2 offset:64
    ds_read_b64_tr_b16 v[94:95], v2 offset:832
    ds_read_b64_tr_b16 v[96:97], v1 offset:128
    ds_read_b64_tr_b16 v[98:99], v1 offset:896
    ds_read_b64_tr_b16 v[100:101], v2 offset:128
    ds_read_b64_tr_b16 v[102:103], v2 offset:896
    ds_read_b128 v[112:115], v3 offset:2048
g1_3:
    s_waitcnt lgkmcnt(11)
    v_mfma_f32_16x16x32_bf16 v[16:19], v[80:83], v[104:107], v[16:19]
    ds_read_b128 v[144:147], v3 offset:10240
    v_add_u32 v4, s56, v5
    v_mfma_f32_16x16x32_bf16 v[40:43], v[80:83], v[108:111], v[40:43]
    ds_read_b64_tr_b16 v[120:121], v1 offset:6144
    s_waitcnt lgkmcnt(9)
    v_mfma_f32_16x16x32_bf16 v[44:47], v[84:87], v[108:111], v[44:47]
    ds_read_b64_tr_b16 v[122:123], v1 offset:6912
    v_add_u32 v8, s56, v6
    v_mfma_f32_16x16x32_bf16 v[20:23], v[84:87], v[104:107], v[20:23]
    ds_read_b128 v[148:151], v3 offset:10496
    v_add_u32 v9, s56, v7
    v_mfma_f32_16x16x32_bf16 v[24:27], v[88:91], v[104:107], v[24:27]
    ds_read_b64_tr_b16 v[124:125], v2 offset:6144
    v_mfma_f32_16x16x32_bf16 v[48:51], v[88:91], v[108:111], v[48:51]
    ds_read_b64_tr_b16 v[126:127], v2 offset:6912
    s_waitcnt lgkmcnt(9)
    v_mfma_f32_16x16x32_bf16 v[52:55], v[92:95], v[108:111], v[52:55]
    ds_read_b64_tr_b16 v[128:129], v1 offset:6208
    v_mfma_f32_16x16x32_bf16 v[28:31], v[92:95], v[104:107], v[28:31]
    ds_read_b64_tr_b16 v[130:131], v1 offset:6976
    v_mfma_f32_16x16x32_bf16 v[32:35], v[96:99], v[104:107], v[32:35]
    ds_read_b64_tr_b16 v[132:133], v2 offset:6208
    v_mfma_f32_16x16x32_bf16 v[56:59], v[96:99], v[108:111], v[56:59]
    ds_read_b64_tr_b16 v[134:135], v2 offset:6976
    s_waitcnt lgkmcnt(10)
    v_mfma_f32_16x16x32_bf16 v[60:63], v[100:103], v[108:111], v[60:63]
    ds_read_b64_tr_b16 v[136:137], v1 offset:6272
    v_mfma_f32_16x16x32_bf16 v[36:39], v[100:103], v[104:107], v[36:39]
    ds_read_b64_tr_b16 v[138:139], v1 offset:7040
    v_mfma_f32_16x16x32_bf16 v[64:67], v[92:95], v[112:115], v[64:67]
    ds_read_b64_tr_b16 v[140:141], v2 offset:6272
    v_mfma_f32_16x16x32_bf16 v[68:71], v[96:99], v[112:115], v[68:71]
    ds_read_b64_tr_b16 v[142:143], v2 offset:7040
    v_mfma_f32_16x16x32_bf16 v[72:75], v[100:103], v[112:115], v[72:75]
    s_waitcnt lgkmcnt(10)
    s_barrier
    v_mfma_f32_16x16x32_bf16 v[16:19], v[120:123], v[144:147], v[16:19]
    ds_read_b128 v[104:107], v9 offset:1024
    ds_read_b64_tr_b16 v[80:81], v4 offset:0
    v_mfma_f32_16x16x32_bf16 v[40:43], v[120:123], v[148:151], v[40:43]
    ds_read_b64_tr_b16 v[82:83], v4 offset:768
    s_waitcnt lgkmcnt(9)
    v_mfma_f32_16x16x32_bf16 v[44:47], v[124:127], v[148:151], v[44:47]
    ds_read_b128 v[108:111], v9 offset:1280
    ds_read_b64_tr_b16 v[84:85], v8 offset:0
    v_mfma_f32_16x16x32_bf16 v[20:23], v[124:127], v[144:147], v[20:23]
    ds_read_b64_tr_b16 v[86:87], v8 offset:768
    ds_read_b64_tr_b16 v[88:89], v4 offset:64
    v_mfma_f32_16x16x32_bf16 v[24:27], v[128:131], v[144:147], v[24:27]
    ds_read_b64_tr_b16 v[90:91], v4 offset:832
    s_add_u32 s56, s56, 30720
    v_mfma_f32_16x16x32_bf16 v[48:51], v[128:131], v[148:151], v[48:51]
    ds_read_b64_tr_b16 v[92:93], v8 offset:64
    s_waitcnt lgkmcnt(11)
    v_mfma_f32_16x16x32_bf16 v[52:55], v[132:135], v[148:151], v[52:55]
    ds_read_b64_tr_b16 v[94:95], v8 offset:832
    s_cmp_eq_u32 s56, 153600
    v_mfma_f32_16x16x32_bf16 v[28:31], v[132:135], v[144:147], v[28:31]
    ds_read_b64_tr_b16 v[96:97], v4 offset:128
    s_cselect_b32 s56, 0, s56
    v_mfma_f32_16x16x32_bf16 v[32:35], v[136:139], v[144:147], v[32:35]
    ds_read_b64_tr_b16 v[98:99], v4 offset:896
    v_mfma_f32_16x16x32_bf16 v[56:59], v[136:139], v[148:151], v[56:59]
    ds_read_b64_tr_b16 v[100:101], v8 offset:128
    s_waitcnt lgkmcnt(13)
    v_mfma_f32_16x16x32_bf16 v[60:63], v[140:143], v[148:151], v[60:63]
    ds_read_b64_tr_b16 v[102:103], v8 offset:896
    v_mfma_f32_16x16x32_bf16 v[36:39], v[140:143], v[144:147], v[36:39]
    ds_read_b128 v[112:115], v9 offset:2048
    s_waitcnt lgkmcnt(11)
    v_mfma_f32_16x16x32_bf16 v[16:19], v[80:83], v[104:107], v[16:19]
    ds_read_b128 v[144:147], v9 offset:10240
    v_add_u32 v1, s56, v5
    v_mfma_f32_16x16x32_bf16 v[40:43], v[80:83], v[108:111], v[40:43]
    ds_read_b64_tr_b16 v[120:121], v4 offset:6144
    s_waitcnt lgkmcnt(9)
    v_mfma_f32_16x16x32_bf16 v[44:47], v[84:87], v[108:111], v[44:47]
    ds_read_b64_tr_b16 v[122:123], v4 offset:6912
    v_add_u32 v2, s56, v6
    v_mfma_f32_16x16x32_bf16 v[20:23], v[84:87], v[104:107], v[20:23]
    ds_read_b128 v[148:151], v9 offset:10496
    v_add_u32 v3, s56, v7
    v_mfma_f32_16x16x32_bf16 v[24:27], v[88:91], v[104:107], v[24:27]
    ds_read_b64_tr_b16 v[124:125], v8 offset:6144
    v_mfma_f32_16x16x32_bf16 v[48:51], v[88:91], v[108:111], v[48:51]
    ds_read_b64_tr_b16 v[126:127], v8 offset:6912
    s_waitcnt lgkmcnt(9)
    v_mfma_f32_16x16x32_bf16 v[52:55], v[92:95], v[108:111], v[52:55]
    ds_read_b64_tr_b16 v[128:129], v4 offset:6208
    v_mfma_f32_16x16x32_bf16 v[28:31], v[92:95], v[104:107], v[28:31]
    ds_read_b64_tr_b16 v[130:131], v4 offset:6976
    v_mfma_f32_16x16x32_bf16 v[32:35], v[96:99], v[104:107], v[32:35]
    ds_read_b64_tr_b16 v[132:133], v8 offset:6208
    v_mfma_f32_16x16x32_bf16 v[56:59], v[96:99], v[108:111], v[56:59]
    ds_read_b64_tr_b16 v[134:135], v8 offset:6976
    s_waitcnt lgkmcnt(10)
    v_mfma_f32_16x16x32_bf16 v[60:63], v[100:103], v[108:111], v[60:63]
    ds_read_b64_tr_b16 v[136:137], v4 offset:6272
    v_mfma_f32_16x16x32_bf16 v[36:39], v[100:103], v[104:107], v[36:39]
    ds_read_b64_tr_b16 v[138:139], v4 offset:7040
    v_mfma_f32_16x16x32_bf16 v[64:67], v[92:95], v[112:115], v[64:67]
    ds_read_b64_tr_b16 v[140:141], v8 offset:6272
    v_mfma_f32_16x16x32_bf16 v[68:71], v[96:99], v[112:115], v[68:71]
    ds_read_b64_tr_b16 v[142:143], v8 offset:7040
    v_mfma_f32_16x16x32_bf16 v[72:75], v[100:103], v[112:115], v[72:75]
    s_waitcnt lgkmcnt(10)
    s_barrier
    v_mfma_f32_16x16x32_bf16 v[16:19], v[120:123], v[144:147], v[16:19]
    ds_read_b128 v[104:107], v3 offset:1024
    ds_read_b64_tr_b16 v[80:81], v1 offset:0
    v_mfma_f32_16x16x32_bf16 v[40:43], v[120:123], v[148:151], v[40:43]
    ds_read_b64_tr_b16 v[82:83], v1 offset:768
    s_waitcnt lgkmcnt(9)
    v_mfma_f32_16x16x32_bf16 v[44:47], v[124:127], v[148:151], v[44:47]
    ds_read_b128 v[108:111], v3 offset:1280
    ds_read_b64_tr_b16 v[84:85], v2 offset:0
    v_mfma_f32_16x16x32_bf16 v[20:23], v[124:127], v[144:147], v[20:23]
    ds_read_b64_tr_b16 v[86:87], v2 offset:768
    ds_read_b64_tr_b16 v[88:89], v1 offset:64
    v_mfma_f32_16x16x32_bf16 v[24:27], v[128:131], v[144:147], v[24:27]
    ds_read_b64_tr_b16 v[90:91], v1 offset:832
    ds_read_b64_tr_b16 v[92:93], v2 offset:64
    v_mfma_f32_16x16x32_bf16 v[48:51], v[128:131], v[148:151], v[48:51]
    ds_read_b64_tr_b16 v[94:95], v2 offset:832
    s_waitcnt lgkmcnt(12)
    v_mfma_f32_16x16x32_bf16 v[52:55], v[132:135], v[148:151], v[52:55]
    ds_read_b64_tr_b16 v[96:97], v1 offset:128
    s_add_u32 s56, s56, 30720
    v_mfma_f32_16x16x32_bf16 v[28:31], v[132:135], v[144:147], v[28:31]
    ds_read_b64_tr_b16 v[98:99], v1 offset:896
    s_cmp_eq_u32 s56, 153600
    v_mfma_f32_16x16x32_bf16 v[32:35], v[136:139], v[144:147], v[32:35]
    ds_read_b64_tr_b16 v[100:101], v2 offset:128
    s_cselect_b32 s56, 0, s56
    v_mfma_f32_16x16x32_bf16 v[56:59], v[136:139], v[148:151], v[56:59]
    ds_read_b64_tr_b16 v[102:103], v2 offset:896
    s_waitcnt lgkmcnt(14)
    v_mfma_f32_16x16x32_bf16 v[60:63], v[140:143], v[148:151], v[60:63]
    ds_read_b128 v[112:115], v3 offset:2048
    s_sub_u32 s57, s57, 1
    v_mfma_f32_16x16x32_bf16 v[36:39], v[140:143], v[144:147], v[36:39]
    s_cmp_lg_u32 s57, 0
    s_cbranch_scc1 g1_3
    s_waitcnt lgkmcnt(11)
    v_mfma_f32_16x16x32_bf16 v[16:19], v[80:83], v[104:107], v[16:19]
    ds_read_b128 v[144:147], v3 offset:10240
    v_add_u32 v4, s56, v5
    v_mfma_f32_16x16x32_bf16 v[40:43], v[80:83], v[108:111], v[40:43]
    ds_read_b64_tr_b16 v[120:121], v1 offset:6144
    s_waitcnt lgkmcnt(9)
    v_mfma_f32_16x16x32_bf16 v[44:47], v[84:87], v[108:111], v[44:47]
    ds_read_b64_tr_b16 v[122:123], v1 offset:6912
    v_add_u32 v8, s56, v6
    v_mfma_f32_16x16x32_bf16 v[20:23], v[84:87], v[104:107], v[20:23]
    ds_read_b128 v[148:151], v3 offset:10496
    v_add_u32 v9, s56, v7
    v_mfma_f32_16x16x32_bf16 v[24:27], v[88:91], v[104:107], v[24:27]
    ds_read_b64_tr_b16 v[124:125], v2 offset:6144
    v_mfma_f32_16x16x32_bf16 v[48:51], v[88:91], v[108:111], v[48:51]
    ds_read_b64_tr_b16 v[126:127], v2 offset:6912
    s_waitcnt lgkmcnt(9)
    v_mfma_f32_16x16x32_bf16 v[52:55], v[92:95], v[108:111], v[52:55]
    ds_read_b64_tr_b16 v[128:129], v1 offset:6208
    v_mfma_f32_16x16x32_bf16 v[28:31], v[92:95], v[104:107], v[28:31]
    ds_read_b64_tr_b16 v[130:131], v1 offset:6976
    v_mfma_f32_16x16x32_bf16 v[32:35], v[96:99], v[104:107], v[32:35]
    ds_read_b64_tr_b16 v[132:133], v2 offset:6208
    v_mfma_f32_16x16x32_bf16 v[56:59], v[96:99], v[108:111], v[56:59]
    ds_read_b64_tr_b16 v[134:135], v2 offset:6976
    s_waitcnt lgkmcnt(10)
    v_mfma_f32_16x16x32_bf16 v[60:63], v[100:103], v[108:111], v[60:63]
    ds_read_b64_tr_b16 v[136:137], v1 offset:6272
    v_mfma_f32_16x16x32_bf16 v[36:39], v[100:103], v[104:107], v[36:39]
    ds_read_b64_tr_b16 v[138:139], v1 offset:7040
    v_mfma_f32_16x16x32_bf16 v[64:67], v[92:95], v[112:115], v[64:67]
    ds_read_b64_tr_b16 v[140:141], v2 offset:6272
    v_mfma_f32_16x16x32_bf16 v[68:71], v[96:99], v[112:115], v[68:71]
    ds_read_b64_tr_b16 v[142:143], v2 offset:7040
    v_mfma_f32_16x16x32_bf16 v[72:75], v[100:103], v[112:115], v[72:75]
    s_waitcnt lgkmcnt(10)
    s_barrier
    v_mfma_f32_16x16x32_bf16 v[16:19], v[120:123], v[144:147], v[16:19]
    ds_read_b128 v[104:107], v9 offset:1024
    ds_read_b64_tr_b16 v[80:81], v4 offset:0
    v_mfma_f32_16x16x32_bf16 v[40:43], v[120:123], v[148:151], v[40:43]
    ds_read_b64_tr_b16 v[82:83], v4 offset:768
    s_waitcnt lgkmcnt(9)
    v_mfma_f32_16x16x32_bf16 v[44:47], v[124:127], v[148:151], v[44:47]
    ds_read_b128 v[108:111], v9 offset:1280
    ds_read_b64_tr_b16 v[84:85], v8 offset:0
    v_mfma_f32_16x16x32_bf16 v[20:23], v[124:127], v[144:147], v[20:23]
    ds_read_b64_tr_b16 v[86:87], v8 offset:768
    ds_read_b64_tr_b16 v[88:89], v4 offset:64
    v_mfma_f32_16x16x32_bf16 v[24:27], v[128:131], v[144:147], v[24:27]
    ds_read_b64_tr_b16 v[90:91], v4 offset:832
    ds_read_b64_tr_b16 v[92:93], v8 offset:64
    v_mfma_f32_16x16x32_bf16 v[48:51], v[128:131], v[148:151], v[48:51]
    ds_read_b64_tr_b16 v[94:95], v8 offset:832
    s_waitcnt lgkmcnt(12)
    v_mfma_f32_16x16x32_bf16 v[52:55], v[132:135], v[148:151], v[52:55]
    ds_read_b64_tr_b16 v[96:97], v4 offset:128
    s_add_u32 s56, s56, 30720
    v_mfma_f32_16x16x32_bf16 v[28:31], v[132:135], v[144:147], v[28:31]
    ds_read_b64_tr_b16 v[98:99], v4 offset:896
    s_cmp_eq_u32 s56, 153600
    v_mfma_f32_16x16x32_bf16 v[32:35], v[136:139], v[144:147], v[32:35]
    ds_read_b64_tr_b16 v[100:101], v8 offset:128
    s_cselect_b32 s56, 0, s56
    v_mfma_f32_16x16x32_bf16 v[56:59], v[136:139], v[148:151], v[56:59]
    ds_read_b64_tr_b16 v[102:103], v8 offset:896
    s_waitcnt lgkmcnt(14)
    v_mfma_f32_16x16x32_bf16 v[60:63], v[140:143], v[148:151], v[60:63]
    ds_read_b128 v[112:115], v9 offset:2048
    buffer_load_dwordx4 v[160:163], v15, s[8:11], s62 offen offset:0
    v_mfma_f32_16x16x32_bf16 v[36:39], v[140:143], v[144:147], v[36:39]
    buffer_load_dwordx4 v[164:167], v15, s[8:11], s62 offen offset:64
    buffer_load_dwordx4 v[168:171], v15, s[8:11], s62 offen offset:128
    buffer_load_ushort v172, v12, s[36:39], s61 offen
    s_waitcnt lgkmcnt(11)
    v_mfma_f32_16x16x32_bf16 v[16:19], v[80:83], v[104:107], v[16:19]
    ds_read_b128 v[144:147], v9 offset:10240
    v_mfma_f32_16x16x32_bf16 v[40:43], v[80:83], v[108:111], v[40:43]
    ds_read_b64_tr_b16 v[120:121], v4 offset:6144
    s_waitcnt lgkmcnt(9)
    v_mfma_f32_16x16x32_bf16 v[44:47], v[84:87], v[108:111], v[44:47]
    ds_read_b64_tr_b16 v[122:123], v4 offset:6912
    v_mfma_f32_16x16x32_bf16 v[20:23], v[84:87], v[104:107], v[20:23]
    ds_read_b128 v[148:151], v9 offset:10496
    v_mfma_f32_16x16x32_bf16 v[24:27], v[88:91], v[104:107], v[24:27]
    ds_read_b64_tr_b16 v[124:125], v8 offset:6144
    v_mfma_f32_16x16x32_bf16 v[48:51], v[88:91], v[108:111], v[48:51]
    ds_read_b64_tr_b16 v[126:127], v8 offset:6912
    s_waitcnt lgkmcnt(9)
    v_mfma_f32_16x16x32_bf16 v[52:55], v[92:95], v[108:111], v[52:55]
    ds_read_b64_tr_b16 v[128:129], v4 offset:6208
    v_mfma_f32_16x16x32_bf16 v[28:31], v[92:95], v[104:107], v[28:31]
    ds_read_b64_tr_b16 v[130:131], v4 offset:6976
    v_mfma_f32_16x16x32_bf16 v[32:35], v[96:99], v[104:107], v[32:35]
    ds_read_b64_tr_b16 v[132:133], v8 offset:6208
    v_mfma_f32_16x16x32_bf16 v[56:59], v[96:99], v[108:111], v[56:59]
    ds_read_b64_tr_b16 v[134:135], v8 offset:6976
    s_waitcnt lgkmcnt(10)
    v_mfma_f32_16x16x32_bf16 v[60:63], v[100:103], v[108:111], v[60:63]
    ds_read_b64_tr_b16 v[136:137], v4 offset:6272
    v_mfma_f32_16x16x32_bf16 v[36:39], v[100:103], v[104:107], v[36:39]
    ds_read_b64_tr_b16 v[138:139], v4 offset:7040
    v_mfma_f32_16x16x32_bf16 v[64:67], v[92:95], v[112:115], v[64:67]
    ds_read_b64_tr_b16 v[140:141], v8 offset:6272
    v_mfma_f32_16x16x32_bf16 v[68:71], v[96:99], v[112:115], v[68:71]
    ds_read_b64_tr_b16 v[142:143], v8 offset:7040
    v_mfma_f32_16x16x32_bf16 v[72:75], v[100:103], v[112:115], v[72:75]
    s_waitcnt lgkmcnt(0)
    v_mfma_f32_16x16x32_bf16 v[16:19], v[120:123], v[144:147], v[16:19]
    v_mfma_f32_16x16x32_bf16 v[40:43], v[120:123], v[148:151], v[40:43]
    v_mfma_f32_16x16x32_bf16 v[44:47], v[124:127], v[148:151], v[44:47]
    v_mfma_f32_16x16x32_bf16 v[20:23], v[124:127], v[144:147], v[20:23]
    v_mfma_f32_16x16x32_bf16 v[24:27], v[128:131], v[144:147], v[24:27]
    v_mfma_f32_16x16x32_bf16 v[48:51], v[128:131], v[148:151], v[48:51]
    v_mfma_f32_16x16x32_bf16 v[52:55], v[132:135], v[148:151], v[52:55]
    v_mfma_f32_16x16x32_bf16 v[28:31], v[132:135], v[144:147], v[28:31]
    v_mfma_f32_16x16x32_bf16 v[32:35], v[136:139], v[144:147], v[32:35]
    v_mfma_f32_16x16x32_bf16 v[56:59], v[136:139], v[148:151], v[56:59]
    v_mfma_f32_16x16x32_bf16 v[60:63], v[140:143], v[148:151], v[60:63]
    v_mfma_f32_16x16x32_bf16 v[36:39], v[140:143], v[144:147], v[36:39]
    s_branch L_g1_done
L_g1_w3:
    v_mov_b32 v64, 0
    v_mov_b32 v65, 0
    v_mov_b32 v66, 0
    v_mov_b32 v67, 0
    v_mov_b32 v68, 0
    v_mov_b32 v69, 0
    v_mov_b32 v70, 0
    v_mov_b32 v71, 0
    v_mov_b32 v72, 0
    v_mov_b32 v73, 0
    v_mov_b32 v74, 0
    v_mov_b32 v75, 0
    v_mov_b32 v1, v5
    v_mov_b32 v2, v6
    v_mov_b32 v3, v7
    s_mov_b32 s56, 30720
    s_mov_b32 s57, 15
    s_barrier
    ds_read_b128 v[104:107], v3 offset:1536
    ds_read_b64_tr_b16 v[80:81], v1 offset:0
    ds_read_b64_tr_b16 v[82:83], v1 offset:768
    ds_read_b128 v[108:111], v3 offset:1792
    ds_read_b64_tr_b16 v[84:85], v2 offset:0
    ds_read_b64_tr_b16 v[86:87], v2 offset:768
    ds_read_b64_tr_b16 v[88:89], v1 offset:64
    ds_read_b64_tr_b16 v[90:91], v1 offset:832
    ds_read_b64_tr_b16 v[92:93], v2 offset:64
    ds_read_b64_tr_b16 v[94:95], v2 offset:832
    ds_read_b64_tr_b16 v[96:97], v1 offset:128
    ds_read_b64_tr_b16 v[98:99], v1 offset:896
    ds_read_b64_tr_b16 v[100:101], v2 offset:128
    ds_read_b64_tr_b16 v[102:103], v2 offset:896
g1_4:
    s_waitcnt lgkmcnt(10)
    v_mfma_f32_16x16x32_bf16 v[16:19], v[80:83], v[104:107], v[16:19]
    ds_read_b128 v[144:147], v3 offset:10752
    ds_read_b64_tr_b16 v[120:121], v1 offset:6144
    v_mfma_f32_16x16x32_bf16 v[40:43], v[80:83], v[108:111], v[40:43]
    ds_read_b64_tr_b16 v[122:123], v1 offset:6912
    s_waitcnt lgkmcnt(9)
    v_mfma_f32_16x16x32_bf16 v[44:47], v[84:87], v[108:111], v[44:47]
    ds_read_b128 v[148:151], v3 offset:11008
    ds_read_b64_tr_b16 v[124:125], v2 offset:6144
    v_mfma_f32_16x16x32_bf16 v[20:23], v[84:87], v[104:107], v[20:23]
    ds_read_b64_tr_b16 v[126:127], v2 offset:6912
    ds_read_b64_tr_b16 v[128:129], v1 offset:6208
    v_mfma_f32_16x16x32_bf16 v[24:27], v[88:91], v[104:107], v[24:27]
    ds_read_b64_tr_b16 v[130:131], v1 offset:6976
    ds_read_b64_tr_b16 v[132:133], v2 offset:6208
    v_mfma_f32_16x16x32_bf16 v[48:51], v[88:91], v[108:111], v[48:51]
    ds_read_b64_tr_b16 v[134:135], v2 offset:6976
    s_waitcnt lgkmcnt(12)
    v_mfma_f32_16x16x32_bf16 v[52:55], v[92:95], v[108:111], v[52:55]
    ds_read_b64_tr_b16 v[136:137], v1 offset:6272
    v_add_u32 v4, s56, v5
    v_mfma_f32_16x16x32_bf16 v[28:31], v[92:95], v[104:107], v[28:31]
    ds_read_b64_tr_b16 v[138:139], v1 offset:7040
    v_add_u32 v8, s56, v6
    v_mfma_f32_16x16x32_bf16 v[32:35], v[96:99], v[104:107], v[32:35]
    ds_read_b64_tr_b16 v[140:141], v2 offset:6272
    v_add_u32 v9, s56, v7
    v_mfma_f32_16x16x32_bf16 v[56:59], v[96:99], v[108:111], v[56:59]
    ds_read_b64_tr_b16 v[142:143], v2 offset:7040
    s_waitcnt lgkmcnt(14)
    v_mfma_f32_16x16x32_bf16 v[60:63], v[100:103], v[108:111], v[60:63]
    ds_read_b128 v[152:155], v3 offset:11264
    v_mfma_f32_16x16x32_bf16 v[36:39], v[100:103], v[104:107], v[36:39]
    s_waitcnt lgkmcnt(11)
    s_barrier
    v_mfma_f32_16x16x32_bf16 v[16:19], v[120:123], v[144:147], v[16:19]
    ds_read_b128 v[104:107], v9 offset:1536
    s_add_u32 s56, s56, 30720
    v_mfma_f32_16x16x32_bf16 v[40:43], v[120:123], v[148:151], v[40:43]
    ds_read_b64_tr_b16 v[80:81], v4 offset:0
    s_waitcnt lgkmcnt(9)
    v_mfma_f32_16x16x32_bf16 v[44:47], v[124:127], v[148:151], v[44:47]
    ds_read_b64_tr_b16 v[82:83], v4 offset:768
    s_cmp_eq_u32 s56, 153600
    v_mfma_f32_16x16x32_bf16 v[20:23], v[124:127], v[144:147], v[20:23]
    ds_read_b128 v[108:111], v9 offset:1792
    s_cselect_b32 s56, 0, s56
    v_mfma_f32_16x16x32_bf16 v[24:27], v[128:131], v[144:147], v[24:27]
    ds_read_b64_tr_b16 v[84:85], v8 offset:0
    v_mfma_f32_16x16x32_bf16 v[48:51], v[128:131], v[148:151], v[48:51]
    ds_read_b64_tr_b16 v[86:87], v8 offset:768
    s_waitcnt lgkmcnt(9)
    v_mfma_f32_16x16x32_bf16 v[52:55], v[132:135], v[148:151], v[52:55]
    ds_read_b64_tr_b16 v[88:89], v4 offset:64
    v_mfma_f32_16x16x32_bf16 v[28:31], v[132:135], v[144:147], v[28:31]
    ds_read_b64_tr_b16 v[90:91], v4 offset:832
    v_mfma_f32_16x16x32_bf16 v[32:35], v[136:139], v[144:147], v[32:35]
    ds_read_b64_tr_b16 v[92:93], v8 offset:64
    v_mfma_f32_16x16x32_bf16 v[56:59], v[136:139], v[148:151], v[56:59]
    ds_read_b64_tr_b16 v[94:95], v8 offset:832
    s_waitcnt lgkmcnt(10)
    v_mfma_f32_16x16x32_bf16 v[60:63], v[140:143], v[148:151], v[60:63]
    ds_read_b64_tr_b16 v[96:97], v4 offset:128
    v_mfma_f32_16x16x32_bf16 v[36:39], v[140:143], v[144:147], v[36:39]
    ds_read_b64_tr_b16 v[98:99], v4 offset:896
    v_mfma_f32_16x16x32_bf16 v[64:67], v[132:135], v[152:155], v[64:67]
    ds_read_b64_tr_b16 v[100:101], v8 offset:128
    v_mfma_f32_16x16x32_bf16 v[68:71], v[136:139], v[152:155], v[68:71]
    ds_read_b64_tr_b16 v[102:103], v8 offset:896
    v_mfma_f32_16x16x32_bf16 v[72:75], v[140:143], v[152:155], v[72:75]
    s_waitcnt lgkmcnt(10)
    v_mfma_f32_16x16x32_bf16 v[16:19], v[80:83], v[104:107], v[16:19]
    ds_read_b128 v[144:147], v9 offset:10752
    ds_read_b64_tr_b16 v[120:121], v4 offset:6144
    v_mfma_f32_16x16x32_bf16 v[40:43], v[80:83], v[108:111], v[40:43]
    ds_read_b64_tr_b16 v[122:123], v4 offset:6912
    s_waitcnt lgkmcnt(9)
    v_mfma_f32_16x16x32_bf16 v[44:47], v[84:87], v[108:111], v[44:47]
    ds_read_b128 v[148:151], v9 offset:11008
    ds_read_b64_tr_b16 v[124:125], v8 offset:6144
    v_mfma_f32_16x16x32_bf16 v[20:23], v[84:87], v[104:107], v[20:23]
    ds_read_b64_tr_b16 v[126:127], v8 offset:6912
    ds_read_b64_tr_b16 v[128:129], v4 offset:6208
    v_mfma_f32_16x16x32_bf16 v[24:27], v[88:91], v[104:107], v[24:27]
    ds_read_b64_tr_b16 v[130:131], v4 offset:6976
    ds_read_b64_tr_b16 v[132:133], v8 offset:6208
    v_mfma_f32_16x16x32_bf16 v[48:51], v[88:91], v[108:111], v[48:51]
    ds_read_b64_tr_b16 v[134:135], v8 offset:6976
    s_waitcnt lgkmcnt(12)
    v_mfma_f32_16x16x32_bf16 v[52:55], v[92:95], v[108:111], v[52:55]
    ds_read_b64_tr_b16 v[136:137], v4 offset:6272
    v_add_u32 v1, s56, v5
    v_mfma_f32_16x16x32_bf16 v[28:31], v[92:95], v[104:107], v[28:31]
    ds_read_b64_tr_b16 v[138:139], v4 offset:7040
    v_add_u32 v2, s56, v6
    v_mfma_f32_16x16x32_bf16 v[32:35], v[96:99], v[104:107], v[32:35]
    ds_read_b64_tr_b16 v[140:141], v8 offset:6272
    v_add_u32 v3, s56, v7
    v_mfma_f32_16x16x32_bf16 v[56:59], v[96:99], v[108:111], v[56:59]
    ds_read_b64_tr_b16 v[142:143], v8 offset:7040
    s_waitcnt lgkmcnt(14)
    v_mfma_f32_16x16x32_bf16 v[60:63], v[100:103], v[108:111], v[60:63]
    ds_read_b128 v[152:155], v9 offset:11264
    v_mfma_f32_16x16x32_bf16 v[36:39], v[100:103], v[104:107], v[36:39]
    s_waitcnt lgkmcnt(11)
    s_barrier
    v_mfma_f32_16x16x32_bf16 v[16:19], v[120:123], v[144:147], v[16:19]
    ds_read_b128 v[104:107], v3 offset:1536
    s_add_u32 s56, s56, 30720
    v_mfma_f32_16x16x32_bf16 v[40:43], v[120:123], v[148:151], v[40:43]
    ds_read_b64_tr_b16 v[80:81], v1 offset:0
    s_waitcnt lgkmcnt(9)
    v_mfma_f32_16x16x32_bf16 v[44:47], v[124:127], v[148:151], v[44:47]
    ds_read_b64_tr_b16 v[82:83], v1 offset:768
    s_cmp_eq_u32 s56, 153600
    v_mfma_f32_16x16x32_bf16 v[20:23], v[124:127], v[144:147], v[20:23]
    ds_read_b128 v[108:111], v3 offset:1792
    s_cselect_b32 s56, 0, s56
    v_mfma_f32_16x16x32_bf16 v[24:27], v[128:131], v[144:147], v[24:27]
    ds_read_b64_tr_b16 v[84:85], v2 offset:0
    s_sub_u32 s57, s57, 1
    v_mfma_f32_16x16x32_bf16 v[48:51], v[128:131], v[148:151], v[48:51]
    ds_read_b64_tr_b16 v[86:87], v2 offset:768
    s_waitcnt lgkmcnt(9)
    v_mfma_f32_16x16x32_bf16 v[52:55], v[132:135], v[148:151], v[52:55]
    ds_read_b64_tr_b16 v[88:89], v1 offset:64
    s_cmp_lg_u32 s57, 0
    v_mfma_f32_16x16x32_bf16 v[28:31], v[132:135], v[144:147], v[28:31]
    ds_read_b64_tr_b16 v[90:91], v1 offset:832
    v_mfma_f32_16x16x32_bf16 v[32:35], v[136:139], v[144:147], v[32:35]
    ds_read_b64_tr_b16 v[92:93], v2 offset:64
    v_mfma_f32_16x16x32_bf16 v[56:59], v[136:139], v[148:151], v[56:59]
    ds_read_b64_tr_b16 v[94:95], v2 offset:832
    s_waitcnt lgkmcnt(10)
    v_mfma_f32_16x16x32_bf16 v[60:63], v[140:143], v[148:151], v[60:63]
    ds_read_b64_tr_b16 v[96:97], v1 offset:128
    v_mfma_f32_16x16x32_bf16 v[36:39], v[140:143], v[144:147], v[36:39]
    ds_read_b64_tr_b16 v[98:99], v1 offset:896
    v_mfma_f32_16x16x32_bf16 v[64:67], v[132:135], v[152:155], v[64:67]
    ds_read_b64_tr_b16 v[100:101], v2 offset:128
    v_mfma_f32_16x16x32_bf16 v[68:71], v[136:139], v[152:155], v[68:71]
    ds_read_b64_tr_b16 v[102:103], v2 offset:896
    v_mfma_f32_16x16x32_bf16 v[72:75], v[140:143], v[152:155], v[72:75]
    s_cbranch_scc1 g1_4
    s_waitcnt lgkmcnt(10)
    v_mfma_f32_16x16x32_bf16 v[16:19], v[80:83], v[104:107], v[16:19]
    ds_read_b128 v[144:147], v3 offset:10752
    ds_read_b64_tr_b16 v[120:121], v1 offset:6144
    v_mfma_f32_16x16x32_bf16 v[40:43], v[80:83], v[108:111], v[40:43]
    ds_read_b64_tr_b16 v[122:123], v1 offset:6912
    s_waitcnt lgkmcnt(9)
    v_mfma_f32_16x16x32_bf16 v[44:47], v[84:87], v[108:111], v[44:47]
    ds_read_b128 v[148:151], v3 offset:11008
    ds_read_b64_tr_b16 v[124:125], v2 offset:6144
    v_mfma_f32_16x16x32_bf16 v[20:23], v[84:87], v[104:107], v[20:23]
    ds_read_b64_tr_b16 v[126:127], v2 offset:6912
    ds_read_b64_tr_b16 v[128:129], v1 offset:6208
    v_mfma_f32_16x16x32_bf16 v[24:27], v[88:91], v[104:107], v[24:27]
    ds_read_b64_tr_b16 v[130:131], v1 offset:6976
    ds_read_b64_tr_b16 v[132:133], v2 offset:6208
    v_mfma_f32_16x16x32_bf16 v[48:51], v[88:91], v[108:111], v[48:51]
    ds_read_b64_tr_b16 v[134:135], v2 offset:6976
    s_waitcnt lgkmcnt(12)
    v_mfma_f32_16x16x32_bf16 v[52:55], v[92:95], v[108:111], v[52:55]
    ds_read_b64_tr_b16 v[136:137], v1 offset:6272
    v_add_u32 v4, s56, v5
    v_mfma_f32_16x16x32_bf16 v[28:31], v[92:95], v[104:107], v[28:31]
    ds_read_b64_tr_b16 v[138:139], v1 offset:7040
    v_add_u32 v8, s56, v6
    v_mfma_f32_16x16x32_bf16 v[32:35], v[96:99], v[104:107], v[32:35]
    ds_read_b64_tr_b16 v[140:141], v2 offset:6272
    v_add_u32 v9, s56, v7
    v_mfma_f32_16x16x32_bf16 v[56:59], v[96:99], v[108:111], v[56:59]
    ds_read_b64_tr_b16 v[142:143], v2 offset:7040
    s_waitcnt lgkmcnt(14)
    v_mfma_f32_16x16x32_bf16 v[60:63], v[100:103], v[108:111], v[60:63]
    ds_read_b128 v[152:155], v3 offset:11264
    v_mfma_f32_16x16x32_bf16 v[36:39], v[100:103], v[104:107], v[36:39]
    s_waitcnt lgkmcnt(11)
    s_barrier
    v_mfma_f32_16x16x32_bf16 v[16:19], v[120:123], v[144:147], v[16:19]
    ds_read_b128 v[104:107], v9 offset:1536
    s_add_u32 s56, s56, 30720
    v_mfma_f32_16x16x32_bf16 v[40:43], v[120:123], v[148:151], v[40:43]
    ds_read_b64_tr_b16 v[80:81], v4 offset:0
    s_waitcnt lgkmcnt(9)
    v_mfma_f32_16x16x32_bf16 v[44:47], v[124:127], v[148:151], v[44:47]
    ds_read_b64_tr_b16 v[82:83], v4 offset:768
    s_cmp_eq_u32 s56, 153600
    v_mfma_f32_16x16x32_bf16 v[20:23], v[124:127], v[144:147], v[20:23]
    ds_read_b128 v[108:111], v9 offset:1792
    s_cselect_b32 s56, 0, s56
    v_mfma_f32_16x16x32_bf16 v[24:27], v[128:131], v[144:147], v[24:27]
    ds_read_b64_tr_b16 v[84:85], v8 offset:0
    buffer_load_dwordx4 v[160:163], v15, s[8:11], s62 offen offset:0
    v_mfma_f32_16x16x32_bf16 v[48:51], v[128:131], v[148:151], v[48:51]
    ds_read_b64_tr_b16 v[86:87], v8 offset:768
    s_waitcnt lgkmcnt(9)
    v_mfma_f32_16x16x32_bf16 v[52:55], v[132:135], v[148:151], v[52:55]
    ds_read_b64_tr_b16 v[88:89], v4 offset:64
    buffer_load_dwordx4 v[164:167], v15, s[8:11], s62 offen offset:64
    v_mfma_f32_16x16x32_bf16 v[28:31], v[132:135], v[144:147], v[28:31]
    ds_read_b64_tr_b16 v[90:91], v4 offset:832
    buffer_load_dwordx4 v[168:171], v15, s[8:11], s62 offen offset:128
    v_mfma_f32_16x16x32_bf16 v[32:35], v[136:139], v[144:147], v[32:35]
    ds_read_b64_tr_b16 v[92:93], v8 offset:64
    buffer_load_ushort v172, v12, s[36:39], s61 offen
    v_mfma_f32_16x16x32_bf16 v[56:59], v[136:139], v[148:151], v[56:59]
    ds_read_b64_tr_b16 v[94:95], v8 offset:832
    s_waitcnt lgkmcnt(10)
    v_mfma_f32_16x16x32_bf16 v[60:63], v[140:143], v[148:151], v[60:63]
    ds_read_b64_tr_b16 v[96:97], v4 offset:128
    v_mfma_f32_16x16x32_bf16 v[36:39], v[140:143], v[144:147], v[36:39]
    ds_read_b64_tr_b16 v[98:99], v4 offset:896
    v_mfma_f32_16x16x32_bf16 v[64:67], v[132:135], v[152:155], v[64:67]
    ds_read_b64_tr_b16 v[100:101], v8 offset:128
    v_mfma_f32_16x16x32_bf16 v[68:71], v[136:139], v[152:155], v[68:71]
    ds_read_b64_tr_b16 v[102:103], v8 offset:896
    v_mfma_f32_16x16x32_bf16 v[72:75], v[140:143], v[152:155], v[72:75]
    s_waitcnt lgkmcnt(10)
    v_mfma_f32_16x16x32_bf16 v[16:19], v[80:83], v[104:107], v[16:19]
    ds_read_b128 v[144:147], v9 offset:10752
    ds_read_b64_tr_b16 v[120:121], v4 offset:6144
    v_mfma_f32_16x16x32_bf16 v[40:43], v[80:83], v[108:111], v[40:43]
    ds_read_b64_tr_b16 v[122:123], v4 offset:6912
    s_waitcnt lgkmcnt(9)
    v_mfma_f32_16x16x32_bf16 v[44:47], v[84:87], v[108:111], v[44:47]
    ds_read_b128 v[148:151], v9 offset:11008
    ds_read_b64_tr_b16 v[124:125], v8 offset:6144
    v_mfma_f32_16x16x32_bf16 v[20:23], v[84:87], v[104:107], v[20:23]
    ds_read_b64_tr_b16 v[126:127], v8 offset:6912
    ds_read_b64_tr_b16 v[128:129], v4 offset:6208
    v_mfma_f32_16x16x32_bf16 v[24:27], v[88:91], v[104:107], v[24:27]
    ds_read_b64_tr_b16 v[130:131], v4 offset:6976
    ds_read_b64_tr_b16 v[132:133], v8 offset:6208
    v_mfma_f32_16x16x32_bf16 v[48:51], v[88:91], v[108:111], v[48:51]
    ds_read_b64_tr_b16 v[134:135], v8 offset:6976
    s_waitcnt lgkmcnt(12)
    v_mfma_f32_16x16x32_bf16 v[52:55], v[92:95], v[108:111], v[52:55]
    ds_read_b64_tr_b16 v[136:137], v4 offset:6272
    v_mfma_f32_16x16x32_bf16 v[28:31], v[92:95], v[104:107], v[28:31]
    ds_read_b64_tr_b16 v[138:139], v4 offset:7040
    v_mfma_f32_16x16x32_bf16 v[32:35], v[96:99], v[104:107], v[32:35]
    ds_read_b64_tr_b16 v[140:141], v8 offset:6272
    v_mfma_f32_16x16x32_bf16 v[56:59], v[96:99], v[108:111], v[56:59]
    ds_read_b64_tr_b16 v[142:143], v8 offset:7040
    s_waitcnt lgkmcnt(14)
    v_mfma_f32_16x16x32_bf16 v[60:63], v[100:103], v[108:111], v[60:63]
    ds_read_b128 v[152:155], v9 offset:11264
    v_mfma_f32_16x16x32_bf16 v[36:39], v[100:103], v[104:107], v[36:39]
    s_waitcnt lgkmcnt(0)
    v_mfma_f32_16x16x32_bf16 v[64:67], v[132:135], v[152:155], v[64:67]
    v_mfma_f32_16x16x32_bf16 v[68:71], v[136:139], v[152:155], v[68:71]
    v_mfma_f32_16x16x32_bf16 v[72:75], v[140:143], v[152:155], v[72:75]
    v_mfma_f32_16x16x32_bf16 v[16:19], v[120:123], v[144:147], v[16:19]
    v_mfma_f32_16x16x32_bf16 v[40:43], v[120:123], v[148:151], v[40:43]
    v_mfma_f32_16x16x32_bf16 v[44:47], v[124:127], v[148:151], v[44:47]
    v_mfma_f32_16x16x32_bf16 v[20:23], v[124:127], v[144:147], v[20:23]
    v_mfma_f32_16x16x32_bf16 v[24:27], v[128:131], v[144:147], v[24:27]
    v_mfma_f32_16x16x32_bf16 v[48:51], v[128:131], v[148:151], v[48:51]
    v_mfma_f32_16x16x32_bf16 v[52:55], v[132:135], v[148:151], v[52:55]
    v_mfma_f32_16x16x32_bf16 v[28:31], v[132:135], v[144:147], v[28:31]
    v_mfma_f32_16x16x32_bf16 v[32:35], v[136:139], v[144:147], v[32:35]
    v_mfma_f32_16x16x32_bf16 v[56:59], v[136:139], v[148:151], v[56:59]
    v_mfma_f32_16x16x32_bf16 v[60:63], v[140:143], v[148:151], v[60:63]
    v_mfma_f32_16x16x32_bf16 v[36:39], v[140:143], v[144:147], v[36:39]
L_g1_done:
    ds_write_b128 v13, v[64:67] offset:0
    ds_write_b128 v13, v[68:71] offset:1024
    ds_write_b128 v13, v[72:75] offset:2048
    s_waitcnt lgkmcnt(0)
    s_barrier
.p2align 3
    v_pk_mul_f32 v[120:121], v[16:17], v[16:17]
    v_pk_mul_f32 v[122:123], v[18:19], v[18:19]
    v_pk_mul_f32 v[124:125], v[20:21], v[20:21]
    v_pk_mul_f32 v[126:127], v[22:23], v[22:23]
    v_pk_fma_f32 v[120:121], v[120:121], v[76:77], v[78:79]
    v_pk_fma_f32 v[122:123], v[122:123], v[76:77], v[78:79]
    v_pk_fma_f32 v[124:125], v[124:125], v[76:77], v[78:79]
    v_pk_fma_f32 v[126:127], v[126:127], v[76:77], v[78:79]
    v_pk_mul_f32 v[120:121], v[120:121], v[16:17]
    v_pk_mul_f32 v[122:123], v[122:123], v[18:19]
    v_pk_mul_f32 v[124:125], v[124:125], v[20:21]
    v_pk_mul_f32 v[126:127], v[126:127], v[22:23]
    v_exp_f32 v120, v120
    v_exp_f32 v121, v121
    v_exp_f32 v122, v122
    v_exp_f32 v123, v123
    v_exp_f32 v124, v124
    v_exp_f32 v125, v125
    v_exp_f32 v126, v126
    v_exp_f32 v127, v127
    v_pk_add_f32 v[120:121], v[120:121], 1.0 op_sel_hi:[1,0]
    v_pk_add_f32 v[122:123], v[122:123], 1.0 op_sel_hi:[1,0]
    v_pk_add_f32 v[124:125], v[124:125], 1.0 op_sel_hi:[1,0]
    v_pk_add_f32 v[126:127], v[126:127], 1.0 op_sel_hi:[1,0]
    v_rcp_f32 v120, v120
    v_rcp_f32 v121, v121
    v_rcp_f32 v122, v122
    v_rcp_f32 v123, v123
    v_rcp_f32 v124, v124
    v_rcp_f32 v125, v125
    v_rcp_f32 v126, v126
    v_rcp_f32 v127, v127
    v_pk_mul_f32 v[120:121], v[120:121], v[16:17]
    v_pk_mul_f32 v[122:123], v[122:123], v[18:19]
    v_pk_mul_f32 v[124:125], v[124:125], v[20:21]
    v_pk_mul_f32 v[126:127], v[126:127], v[22:23]
    v_cvt_pk_bf16_f32 v80, v120, v121
    v_cvt_pk_bf16_f32 v81, v122, v123
    v_cvt_pk_bf16_f32 v82, v124, v125
    v_cvt_pk_bf16_f32 v83, v126, v127
    buffer_store_dwordx4 v[80:83], v14, s[44:47], s96 offen offset:0 sc1
    v_pk_mul_f32 v[120:121], v[24:25], v[24:25]
    v_pk_mul_f32 v[122:123], v[26:27], v[26:27]
    v_pk_mul_f32 v[124:125], v[28:29], v[28:29]
    v_pk_mul_f32 v[126:127], v[30:31], v[30:31]
    v_pk_fma_f32 v[120:121], v[120:121], v[76:77], v[78:79]
    v_pk_fma_f32 v[122:123], v[122:123], v[76:77], v[78:79]
    v_pk_fma_f32 v[124:125], v[124:125], v[76:77], v[78:79]
    v_pk_fma_f32 v[126:127], v[126:127], v[76:77], v[78:79]
    v_pk_mul_f32 v[120:121], v[120:121], v[24:25]
    v_pk_mul_f32 v[122:123], v[122:123], v[26:27]
    v_pk_mul_f32 v[124:125], v[124:125], v[28:29]
    v_pk_mul_f32 v[126:127], v[126:127], v[30:31]
    v_exp_f32 v120, v120
    v_exp_f32 v121, v121
    v_exp_f32 v122, v122
    v_exp_f32 v123, v123
    v_exp_f32 v124, v124
    v_exp_f32 v125, v125
    v_exp_f32 v126, v126
    v_exp_f32 v127, v127
    v_pk_add_f32 v[120:121], v[120:121], 1.0 op_sel_hi:[1,0]
    v_pk_add_f32 v[122:123], v[122:123], 1.0 op_sel_hi:[1,0]
    v_pk_add_f32 v[124:125], v[124:125], 1.0 op_sel_hi:[1,0]
    v_pk_add_f32 v[126:127], v[126:127], 1.0 op_sel_hi:[1,0]
    v_rcp_f32 v120, v120
    v_rcp_f32 v121, v121
    v_rcp_f32 v122, v122
    v_rcp_f32 v123, v123
    v_rcp_f32 v124, v124
    v_rcp_f32 v125, v125
    v_rcp_f32 v126, v126
    v_rcp_f32 v127, v127
    v_pk_mul_f32 v[120:121], v[120:121], v[24:25]
    v_pk_mul_f32 v[122:123], v[122:123], v[26:27]
    v_pk_mul_f32 v[124:125], v[124:125], v[28:29]
    v_pk_mul_f32 v[126:127], v[126:127], v[30:31]
    v_cvt_pk_bf16_f32 v84, v120, v121
    v_cvt_pk_bf16_f32 v85, v122, v123
    v_cvt_pk_bf16_f32 v86, v124, v125
    v_cvt_pk_bf16_f32 v87, v126, v127
    buffer_store_dwordx4 v[84:87], v14, s[44:47], s97 offen offset:0 sc1
    v_pk_mul_f32 v[120:121], v[32:33], v[32:33]
    v_pk_mul_f32 v[122:123], v[34:35], v[34:35]
    v_pk_mul_f32 v[124:125], v[36:37], v[36:37]
    v_pk_mul_f32 v[126:127], v[38:39], v[38:39]
    v_pk_fma_f32 v[120:121], v[120:121], v[76:77], v[78:79]
    v_pk_fma_f32 v[122:123], v[122:123], v[76:77], v[78:79]
    v_pk_fma_f32 v[124:125], v[124:125], v[76:77], v[78:79]
    v_pk_fma_f32 v[126:127], v[126:127], v[76:77], v[78:79]
    v_pk_mul_f32 v[120:121], v[120:121], v[32:33]
    v_pk_mul_f32 v[122:123], v[122:123], v[34:35]
    v_pk_mul_f32 v[124:125], v[124:125], v[36:37]
    v_pk_mul_f32 v[126:127], v[126:127], v[38:39]
    v_exp_f32 v120, v120
    v_exp_f32 v121, v121
    v_exp_f32 v122, v122
    v_exp_f32 v123, v123
    v_exp_f32 v124, v124
    v_exp_f32 v125, v125
    v_exp_f32 v126, v126
    v_exp_f32 v127, v127
    v_pk_add_f32 v[120:121], v[120:121], 1.0 op_sel_hi:[1,0]
    v_pk_add_f32 v[122:123], v[122:123], 1.0 op_sel_hi:[1,0]
    v_pk_add_f32 v[124:125], v[124:125], 1.0 op_sel_hi:[1,0]
    v_pk_add_f32 v[126:127], v[126:127], 1.0 op_sel_hi:[1,0]
    v_rcp_f32 v120, v120
    v_rcp_f32 v121, v121
    v_rcp_f32 v122, v122
    v_rcp_f32 v123, v123
    v_rcp_f32 v124, v124
    v_rcp_f32 v125, v125
    v_rcp_f32 v126, v126
    v_rcp_f32 v127, v127
    v_pk_mul_f32 v[120:121], v[120:121], v[32:33]
    v_pk_mul_f32 v[122:123], v[122:123], v[34:35]
    v_pk_mul_f32 v[124:125], v[124:125], v[36:37]
    v_pk_mul_f32 v[126:127], v[126:127], v[38:39]
    v_cvt_pk_bf16_f32 v88, v120, v121
    v_cvt_pk_bf16_f32 v89, v122, v123
    v_cvt_pk_bf16_f32 v90, v124, v125
    v_cvt_pk_bf16_f32 v91, v126, v127
    buffer_store_dwordx4 v[88:91], v14, s[44:47], s98 offen offset:0 sc1
    v_pk_mul_f32 v[120:121], v[40:41], v[40:41]
    v_pk_mul_f32 v[122:123], v[42:43], v[42:43]
    v_pk_mul_f32 v[124:125], v[44:45], v[44:45]
    v_pk_mul_f32 v[126:127], v[46:47], v[46:47]
    v_pk_fma_f32 v[120:121], v[120:121], v[76:77], v[78:79]
    v_pk_fma_f32 v[122:123], v[122:123], v[76:77], v[78:79]
    v_pk_fma_f32 v[124:125], v[124:125], v[76:77], v[78:79]
    v_pk_fma_f32 v[126:127], v[126:127], v[76:77], v[78:79]
    v_pk_mul_f32 v[120:121], v[120:121], v[40:41]
    v_pk_mul_f32 v[122:123], v[122:123], v[42:43]
    v_pk_mul_f32 v[124:125], v[124:125], v[44:45]
    v_pk_mul_f32 v[126:127], v[126:127], v[46:47]
    v_exp_f32 v120, v120
    v_exp_f32 v121, v121
    v_exp_f32 v122, v122
    v_exp_f32 v123, v123
    v_exp_f32 v124, v124
    v_exp_f32 v125, v125
    v_exp_f32 v126, v126
    v_exp_f32 v127, v127
    v_pk_add_f32 v[120:121], v[120:121], 1.0 op_sel_hi:[1,0]
    v_pk_add_f32 v[122:123], v[122:123], 1.0 op_sel_hi:[1,0]
    v_pk_add_f32 v[124:125], v[124:125], 1.0 op_sel_hi:[1,0]
    v_pk_add_f32 v[126:127], v[126:127], 1.0 op_sel_hi:[1,0]
    v_rcp_f32 v120, v120
    v_rcp_f32 v121, v121
    v_rcp_f32 v122, v122
    v_rcp_f32 v123, v123
    v_rcp_f32 v124, v124
    v_rcp_f32 v125, v125
    v_rcp_f32 v126, v126
    v_rcp_f32 v127, v127
    v_pk_mul_f32 v[120:121], v[120:121], v[40:41]
    v_pk_mul_f32 v[122:123], v[122:123], v[42:43]
    v_pk_mul_f32 v[124:125], v[124:125], v[44:45]
    v_pk_mul_f32 v[126:127], v[126:127], v[46:47]
    v_cvt_pk_bf16_f32 v92, v120, v121
    v_cvt_pk_bf16_f32 v93, v122, v123
    v_cvt_pk_bf16_f32 v94, v124, v125
    v_cvt_pk_bf16_f32 v95, v126, v127
    buffer_store_dwordx4 v[92:95], v14, s[44:47], s96 offen offset:256 sc1
    v_pk_mul_f32 v[120:121], v[48:49], v[48:49]
    v_pk_mul_f32 v[122:123], v[50:51], v[50:51]
    v_pk_mul_f32 v[124:125], v[52:53], v[52:53]
    v_pk_mul_f32 v[126:127], v[54:55], v[54:55]
    v_pk_fma_f32 v[120:121], v[120:121], v[76:77], v[78:79]
    v_pk_fma_f32 v[122:123], v[122:123], v[76:77], v[78:79]
    v_pk_fma_f32 v[124:125], v[124:125], v[76:77], v[78:79]
    v_pk_fma_f32 v[126:127], v[126:127], v[76:77], v[78:79]
    v_pk_mul_f32 v[120:121], v[120:121], v[48:49]
    v_pk_mul_f32 v[122:123], v[122:123], v[50:51]
    v_pk_mul_f32 v[124:125], v[124:125], v[52:53]
    v_pk_mul_f32 v[126:127], v[126:127], v[54:55]
    v_exp_f32 v120, v120
    v_exp_f32 v121, v121
    v_exp_f32 v122, v122
    v_exp_f32 v123, v123
    v_exp_f32 v124, v124
    v_exp_f32 v125, v125
    v_exp_f32 v126, v126
    v_exp_f32 v127, v127
    v_pk_add_f32 v[120:121], v[120:121], 1.0 op_sel_hi:[1,0]
    v_pk_add_f32 v[122:123], v[122:123], 1.0 op_sel_hi:[1,0]
    v_pk_add_f32 v[124:125], v[124:125], 1.0 op_sel_hi:[1,0]
    v_pk_add_f32 v[126:127], v[126:127], 1.0 op_sel_hi:[1,0]
    v_rcp_f32 v120, v120
    v_rcp_f32 v121, v121
    v_rcp_f32 v122, v122
    v_rcp_f32 v123, v123
    v_rcp_f32 v124, v124
    v_rcp_f32 v125, v125
    v_rcp_f32 v126, v126
    v_rcp_f32 v127, v127
    v_pk_mul_f32 v[120:121], v[120:121], v[48:49]
    v_pk_mul_f32 v[122:123], v[122:123], v[50:51]
    v_pk_mul_f32 v[124:125], v[124:125], v[52:53]
    v_pk_mul_f32 v[126:127], v[126:127], v[54:55]
    v_cvt_pk_bf16_f32 v96, v120, v121
    v_cvt_pk_bf16_f32 v97, v122, v123
    v_cvt_pk_bf16_f32 v98, v124, v125
    v_cvt_pk_bf16_f32 v99, v126, v127
    buffer_store_dwordx4 v[96:99], v14, s[44:47], s97 offen offset:256 sc1
    v_pk_mul_f32 v[120:121], v[56:57], v[56:57]
    v_pk_mul_f32 v[122:123], v[58:59], v[58:59]
    v_pk_mul_f32 v[124:125], v[60:61], v[60:61]
    v_pk_mul_f32 v[126:127], v[62:63], v[62:63]
    v_pk_fma_f32 v[120:121], v[120:121], v[76:77], v[78:79]
    v_pk_fma_f32 v[122:123], v[122:123], v[76:77], v[78:79]
    v_pk_fma_f32 v[124:125], v[124:125], v[76:77], v[78:79]
    v_pk_fma_f32 v[126:127], v[126:127], v[76:77], v[78:79]
    v_pk_mul_f32 v[120:121], v[120:121], v[56:57]
    v_pk_mul_f32 v[122:123], v[122:123], v[58:59]
    v_pk_mul_f32 v[124:125], v[124:125], v[60:61]
    v_pk_mul_f32 v[126:127], v[126:127], v[62:63]
    v_exp_f32 v120, v120
    v_exp_f32 v121, v121
    v_exp_f32 v122, v122
    v_exp_f32 v123, v123
    v_exp_f32 v124, v124
    v_exp_f32 v125, v125
    v_exp_f32 v126, v126
    v_exp_f32 v127, v127
    v_pk_add_f32 v[120:121], v[120:121], 1.0 op_sel_hi:[1,0]
    v_pk_add_f32 v[122:123], v[122:123], 1.0 op_sel_hi:[1,0]
    v_pk_add_f32 v[124:125], v[124:125], 1.0 op_sel_hi:[1,0]
    v_pk_add_f32 v[126:127], v[126:127], 1.0 op_sel_hi:[1,0]
    v_rcp_f32 v120, v120
    v_rcp_f32 v121, v121
    v_rcp_f32 v122, v122
    v_rcp_f32 v123, v123
    v_rcp_f32 v124, v124
    v_rcp_f32 v125, v125
    v_rcp_f32 v126, v126
    v_rcp_f32 v127, v127
    v_pk_mul_f32 v[120:121], v[120:121], v[56:57]
    v_pk_mul_f32 v[122:123], v[122:123], v[58:59]
    v_pk_mul_f32 v[124:125], v[124:125], v[60:61]
    v_pk_mul_f32 v[126:127], v[126:127], v[62:63]
    v_cvt_pk_bf16_f32 v100, v120, v121
    v_cvt_pk_bf16_f32 v101, v122, v123
    v_cvt_pk_bf16_f32 v102, v124, v125
    v_cvt_pk_bf16_f32 v103, v126, v127
    buffer_store_dwordx4 v[100:103], v14, s[44:47], s98 offen offset:256 sc1
    s_barrier
    v_mov_b32 v1, v176
    v_add_u32 v2, 122880, v176
    v_mov_b32 v118, v184
    v_mov_b32 v3, v177
    v_mov_b32 v4, v178
    v_mov_b32 v5, v179
    v_mov_b32 v6, v180
    v_mov_b32 v112, v181
    v_add_u32 v115, 110592, v181
    v_mov_b32 v113, v182
    v_add_u32 v116, 110592, v182
    v_mov_b32 v114, v183
    v_add_u32 v117, 110592, v183
    s_waitcnt vmcnt(6)
    v_lshlrev_b32 v172, 16, v172
    v_lshlrev_b32 v16, 16, v160
    v_and_b32 v17, 0xffff0000, v160
    v_lshlrev_b32 v18, 16, v161
    v_and_b32 v19, 0xffff0000, v161
    v_lshlrev_b32 v20, 16, v162
    v_and_b32 v21, 0xffff0000, v162
    v_lshlrev_b32 v22, 16, v163
    v_and_b32 v23, 0xffff0000, v163
    v_lshlrev_b32 v24, 16, v164
    v_and_b32 v25, 0xffff0000, v164
    v_lshlrev_b32 v26, 16, v165
    v_and_b32 v27, 0xffff0000, v165
    v_lshlrev_b32 v28, 16, v166
    v_and_b32 v29, 0xffff0000, v166
    v_lshlrev_b32 v30, 16, v167
    v_and_b32 v31, 0xffff0000, v167
    v_lshlrev_b32 v32, 16, v168
    v_and_b32 v33, 0xffff0000, v168
    v_lshlrev_b32 v34, 16, v169
    v_and_b32 v35, 0xffff0000, v169
    v_lshlrev_b32 v36, 16, v170
    v_and_b32 v37, 0xffff0000, v170
    v_lshlrev_b32 v38, 16, v171
    v_and_b32 v39, 0xffff0000, v171
    v_pk_add_f32 v[16:17], v[16:17], v[172:173] op_sel_hi:[1,0]
    v_pk_add_f32 v[18:19], v[18:19], v[172:173] op_sel_hi:[1,0]
    v_pk_add_f32 v[20:21], v[20:21], v[172:173] op_sel_hi:[1,0]
    v_pk_add_f32 v[22:23], v[22:23], v[172:173] op_sel_hi:[1,0]
    v_pk_add_f32 v[24:25], v[24:25], v[172:173] op_sel_hi:[1,0]
    v_pk_add_f32 v[26:27], v[26:27], v[172:173] op_sel_hi:[1,0]
    v_pk_add_f32 v[28:29], v[28:29], v[172:173] op_sel_hi:[1,0]
    v_pk_add_f32 v[30:31], v[30:31], v[172:173] op_sel_hi:[1,0]
    v_pk_add_f32 v[32:33], v[32:33], v[172:173] op_sel_hi:[1,0]
    v_pk_add_f32 v[34:35], v[34:35], v[172:173] op_sel_hi:[1,0]
    v_pk_add_f32 v[36:37], v[36:37], v[172:173] op_sel_hi:[1,0]
    v_pk_add_f32 v[38:39], v[38:39], v[172:173] op_sel_hi:[1,0]
    v_mov_b32 v40, 0
    v_mov_b32 v41, 0
    v_mov_b32 v42, 0
    v_mov_b32 v43, 0
    v_mov_b32 v44, 0
    v_mov_b32 v45, 0
    v_mov_b32 v46, 0
    v_mov_b32 v47, 0
    v_mov_b32 v48, 0
    v_mov_b32 v49, 0
    v_mov_b32 v50, 0
    v_mov_b32 v51, 0
    v_mov_b32 v52, 0
    v_mov_b32 v53, 0
    v_mov_b32 v54, 0
    v_mov_b32 v55, 0
    v_mov_b32 v56, 0
    v_mov_b32 v57, 0
    v_mov_b32 v58, 0
    v_mov_b32 v59, 0
    v_mov_b32 v60, 0
    v_mov_b32 v61, 0
    v_mov_b32 v62, 0
    v_mov_b32 v63, 0
    v_mov_b32 v64, 0
    v_mov_b32 v65, 0
    v_mov_b32 v66, 0
    v_mov_b32 v67, 0
    v_mov_b32 v68, 0
    v_mov_b32 v69, 0
    v_mov_b32 v70, 0
    v_mov_b32 v71, 0
    v_mov_b32 v72, 0
    v_mov_b32 v73, 0
    v_mov_b32 v74, 0
    v_mov_b32 v75, 0
    v_mov_b32 v76, 0
    v_mov_b32 v77, 0
    v_mov_b32 v78, 0
    v_mov_b32 v79, 0
    v_mov_b32 v80, 0
    v_mov_b32 v81, 0
    v_mov_b32 v82, 0
    v_mov_b32 v83, 0
    v_mov_b32 v84, 0
    v_mov_b32 v85, 0
    v_mov_b32 v86, 0
    v_mov_b32 v87, 0
    v_mov_b32 v88, 0
    v_mov_b32 v89, 0
    v_mov_b32 v90, 0
    v_mov_b32 v91, 0
    v_mov_b32 v92, 0
    v_mov_b32 v93, 0
    v_mov_b32 v94, 0
    v_mov_b32 v95, 0
    v_mov_b32 v96, 0
    v_mov_b32 v97, 0
    v_mov_b32 v98, 0
    v_mov_b32 v99, 0
    v_mov_b32 v100, 0
    v_mov_b32 v101, 0
    v_mov_b32 v102, 0
    v_mov_b32 v103, 0
    v_mov_b32 v104, 0
    v_mov_b32 v105, 0
    v_mov_b32 v106, 0
    v_mov_b32 v107, 0
    v_mov_b32 v108, 0
    v_mov_b32 v109, 0
    v_mov_b32 v110, 0
    v_mov_b32 v111, 0
    v_mov_b32 v119, 160256
    v_mov_b32 v120, 1
    s_mov_b64 exec, 1
    s_waitcnt vmcnt(0) lgkmcnt(0)
    ds_add_rtn_u32 v120, v119, v120
    s_waitcnt lgkmcnt(0)
    v_readfirstlane_b32 s3, v120
    s_mov_b64 exec, -1
    s_cmp_lg_u32 s3, 3
    s_cbranch_scc1 L_noflagB
    v_mov_b32 v121, s7
    s_mov_b32 exec_lo, 0xffffffff
    s_mov_b32 exec_hi, 0
    buffer_store_dword v121, v11, s[44:47], s53 offen sc1
    s_mov_b64 exec, -1
L_noflagB:
    s_mul_i32 s56, s60, 3
    s_add_u32 s56, s56, s59
    s_lshl_b32 s56, s56, 2
    v_lshlrev_b32 v8, 4, v0
    s_mul_i32 s63, s4, 3072
    s_add_u32 s63, s63, 14680064
    v_mov_b32 v9, s7
    s_add_u32 s3, s58, 1
    s_and_b32 s3, s3, 3
    s_lshl_b32 s48, s3, 9
    s_add_u32 s48, s48, s99
    s_add_u32 s53, s48, 0
    s_add_u32 s3, s3, s56
    s_mul_i32 s3, s3, 36864
    s_add_u32 s3, s3, s63
    s_add_u32 s96, s3, 0
    s_add_u32 s3, s58, 2
    s_and_b32 s3, s3, 3
    s_lshl_b32 s48, s3, 9
    s_add_u32 s48, s48, s99
    s_add_u32 s54, s48, 4
    s_add_u32 s3, s3, s56
    s_mul_i32 s3, s3, 36864
    s_add_u32 s3, s3, s63
    s_add_u32 s97, s3, 12288
    s_add_u32 s3, s58, 3
    s_and_b32 s3, s3, 3
    s_lshl_b32 s48, s3, 9
    s_add_u32 s48, s48, s99
    s_add_u32 s55, s48, 8
    s_add_u32 s3, s3, s56
    s_mul_i32 s3, s3, 36864
    s_add_u32 s3, s3, s63
    s_add_u32 s98, s3, 24576
    s_add_u32 s48, s56, s58
    s_mul_i32 s48, s48, 36864
    s_add_u32 s63, s63, s48
    s_mul_i32 s3, s4, 3328
    s_add_u32 s3, s3, 122880
    v_and_b32 v7, 15, v0
    v_mul_u32_u24 v7, 208, v7
    v_lshrrev_b32 v127, 4, v0
    v_lshlrev_b32 v127, 4, v127
    v_add3_u32 v7, v7, v127, s3
    v_add_u32 v133, 0, v0
    v_mul_u32_u24 v134, 87382, v133
    v_lshrrev_b32 v134, 20, v134
    v_mul_u32_u24 v136, 12, v134
    v_sub_u32 v135, v133, v136
    v_lshlrev_b32 v135, 4, v135
    v_mul_u32_u24 v136, 208, v134
    v_add3_u32 v122, v135, v136, s3
    v_mul_u32_u24 v136, 1152, v134
    v_add_u32 v12, v135, v136
    v_add_u32 v133, 64, v0
    v_mul_u32_u24 v134, 87382, v133
    v_lshrrev_b32 v134, 20, v134
    v_mul_u32_u24 v136, 12, v134
    v_sub_u32 v135, v133, v136
    v_lshlrev_b32 v135, 4, v135
    v_mul_u32_u24 v136, 208, v134
    v_add3_u32 v123, v135, v136, s3
    v_mul_u32_u24 v136, 1152, v134
    v_add_u32 v13, v135, v136
    v_add_u32 v133, 128, v0
    v_mul_u32_u24 v134, 87382, v133
    v_lshrrev_b32 v134, 20, v134
    v_mul_u32_u24 v136, 12, v134
    v_sub_u32 v135, v133, v136
    v_lshlrev_b32 v135, 4, v135
    v_mul_u32_u24 v136, 208, v134
    v_add3_u32 v124, v135, v136, s3
    v_mul_u32_u24 v136, 1152, v134
    v_add_u32 v14, v135, v136
    s_barrier
    ds_read_b64_tr_b16 v[200:201], v3 offset:0
    ds_read_b64_tr_b16 v[202:203], v3 offset:4096
    ds_read_b128 v[176:179], v1 offset:0
    ds_read_b64_tr_b16 v[204:205], v4 offset:0
    ds_read_b64_tr_b16 v[206:207], v4 offset:4096
    ds_read_b128 v[180:183], v1 offset:64
    ds_read_b128 v[184:187], v1 offset:512
    ds_read_b128 v[188:191], v1 offset:576
    ds_read_b128 v[192:195], v1 offset:1024
    ds_read_b128 v[196:199], v1 offset:1088
    ds_read_b64_tr_b16 v[208:209], v5 offset:0
    ds_read_b64_tr_b16 v[210:211], v5 offset:4096
    ds_read_b64_tr_b16 v[212:213], v6 offset:0
    ds_read_b64_tr_b16 v[214:215], v6 offset:4096
    s_mov_b32 s57, 5
.p2align 3
g2_5:
    s_waitcnt lgkmcnt(7)
    v_mfma_f32_16x16x32_bf16 v[16:19], v[176:179], v[200:203], v[16:19]
    ds_read_b64_tr_b16 v[240:241], v3 offset:8192
    v_mfma_f32_16x16x32_bf16 v[40:43], v[176:179], v[204:207], v[40:43]
    ds_read_b64_tr_b16 v[242:243], v3 offset:12288
    v_mfma_f32_16x16x32_bf16 v[44:47], v[180:183], v[204:207], v[44:47]
    ds_read_b128 v[216:219], v1 offset:12544
    v_mfma_f32_16x16x32_bf16 v[20:23], v[180:183], v[200:203], v[20:23]
    ds_read_b64_tr_b16 v[244:245], v4 offset:8192
    v_mfma_f32_16x16x32_bf16 v[24:27], v[184:187], v[200:203], v[24:27]
    ds_read_b64_tr_b16 v[246:247], v4 offset:12288
    v_mfma_f32_16x16x32_bf16 v[48:51], v[184:187], v[204:207], v[48:51]
    ds_read_b128 v[220:223], v1 offset:12608
    s_waitcnt lgkmcnt(10)
    v_mfma_f32_16x16x32_bf16 v[52:55], v[188:191], v[204:207], v[52:55]
    ds_read_b128 v[224:227], v1 offset:13056
    v_mfma_f32_16x16x32_bf16 v[28:31], v[188:191], v[200:203], v[28:31]
    ds_read_b128 v[228:231], v1 offset:13120
    v_mfma_f32_16x16x32_bf16 v[32:35], v[192:195], v[200:203], v[32:35]
    ds_read_b128 v[232:235], v1 offset:13568
    v_mfma_f32_16x16x32_bf16 v[56:59], v[192:195], v[204:207], v[56:59]
    ds_read_b128 v[236:239], v1 offset:13632
    v_mfma_f32_16x16x32_bf16 v[60:63], v[196:199], v[204:207], v[60:63]
    ds_read_b64_tr_b16 v[248:249], v5 offset:8192
    v_mfma_f32_16x16x32_bf16 v[36:39], v[196:199], v[200:203], v[36:39]
    ds_read_b64_tr_b16 v[250:251], v5 offset:12288
    s_waitcnt lgkmcnt(12)
    v_mfma_f32_16x16x32_bf16 v[84:87], v[196:199], v[208:211], v[84:87]
    ds_read_b64_tr_b16 v[252:253], v6 offset:8192
    v_mfma_f32_16x16x32_bf16 v[108:111], v[196:199], v[212:215], v[108:111]
    ds_read_b64_tr_b16 v[254:255], v6 offset:12288
    v_mfma_f32_16x16x32_bf16 v[104:107], v[192:195], v[212:215], v[104:107]
    v_mfma_f32_16x16x32_bf16 v[80:83], v[192:195], v[208:211], v[80:83]
    v_mfma_f32_16x16x32_bf16 v[76:79], v[188:191], v[208:211], v[76:79]
    v_mfma_f32_16x16x32_bf16 v[100:103], v[188:191], v[212:215], v[100:103]
    v_mfma_f32_16x16x32_bf16 v[96:99], v[184:187], v[212:215], v[96:99]
    v_mfma_f32_16x16x32_bf16 v[72:75], v[184:187], v[208:211], v[72:75]
    v_mfma_f32_16x16x32_bf16 v[68:71], v[180:183], v[208:211], v[68:71]
    v_mfma_f32_16x16x32_bf16 v[92:95], v[180:183], v[212:215], v[92:95]
    v_mfma_f32_16x16x32_bf16 v[88:91], v[176:179], v[212:215], v[88:91]
    v_mfma_f32_16x16x32_bf16 v[64:67], v[176:179], v[208:211], v[64:67]
    s_waitcnt lgkmcnt(8)
    v_mfma_f32_16x16x32_bf16 v[16:19], v[216:219], v[240:243], v[16:19]
    v_mfma_f32_16x16x32_bf16 v[40:43], v[216:219], v[244:247], v[40:43]
    v_mfma_f32_16x16x32_bf16 v[44:47], v[220:223], v[244:247], v[44:47]
    s_waitcnt lgkmcnt(0)
    s_barrier
    v_mfma_f32_16x16x32_bf16 v[20:23], v[220:223], v[240:243], v[20:23]
    ds_read_b64_tr_b16 v[200:201], v3 offset:16384
    v_mfma_f32_16x16x32_bf16 v[24:27], v[224:227], v[240:243], v[24:27]
    ds_read_b64_tr_b16 v[202:203], v3 offset:20480
    v_mfma_f32_16x16x32_bf16 v[48:51], v[224:227], v[244:247], v[48:51]
    ds_read_b128 v[176:179], v1 offset:25088
    v_mfma_f32_16x16x32_bf16 v[52:55], v[228:231], v[244:247], v[52:55]
    ds_read_b64_tr_b16 v[204:205], v4 offset:16384
    v_mfma_f32_16x16x32_bf16 v[28:31], v[228:231], v[240:243], v[28:31]
    ds_read_b64_tr_b16 v[206:207], v4 offset:20480
    v_mfma_f32_16x16x32_bf16 v[32:35], v[232:235], v[240:243], v[32:35]
    ds_read_b128 v[180:183], v1 offset:25152
    v_mfma_f32_16x16x32_bf16 v[56:59], v[232:235], v[244:247], v[56:59]
    ds_read_b128 v[184:187], v1 offset:25600
    v_mfma_f32_16x16x32_bf16 v[60:63], v[236:239], v[244:247], v[60:63]
    ds_read_b128 v[188:191], v1 offset:25664
    v_mfma_f32_16x16x32_bf16 v[36:39], v[236:239], v[240:243], v[36:39]
    ds_read_b128 v[192:195], v1 offset:26112
    v_mfma_f32_16x16x32_bf16 v[84:87], v[236:239], v[248:251], v[84:87]
    ds_read_b128 v[196:199], v1 offset:26176
    v_mfma_f32_16x16x32_bf16 v[108:111], v[236:239], v[252:255], v[108:111]
    ds_read_b64_tr_b16 v[208:209], v5 offset:16384
    v_mfma_f32_16x16x32_bf16 v[104:107], v[232:235], v[252:255], v[104:107]
    ds_read_b64_tr_b16 v[210:211], v5 offset:20480
    v_mfma_f32_16x16x32_bf16 v[80:83], v[232:235], v[248:251], v[80:83]
    ds_read_b64_tr_b16 v[212:213], v6 offset:16384
    v_mfma_f32_16x16x32_bf16 v[76:79], v[228:231], v[248:251], v[76:79]
    ds_read_b64_tr_b16 v[214:215], v6 offset:20480
    v_mfma_f32_16x16x32_bf16 v[100:103], v[228:231], v[252:255], v[100:103]
    v_mfma_f32_16x16x32_bf16 v[96:99], v[224:227], v[252:255], v[96:99]
    v_mfma_f32_16x16x32_bf16 v[72:75], v[224:227], v[248:251], v[72:75]
    v_mfma_f32_16x16x32_bf16 v[68:71], v[220:223], v[248:251], v[68:71]
    v_mfma_f32_16x16x32_bf16 v[92:95], v[220:223], v[252:255], v[92:95]
    v_mfma_f32_16x16x32_bf16 v[88:91], v[216:219], v[252:255], v[88:91]
    v_mfma_f32_16x16x32_bf16 v[64:67], v[216:219], v[248:251], v[64:67]
    s_waitcnt lgkmcnt(7)
    v_mfma_f32_16x16x32_bf16 v[16:19], v[176:179], v[200:203], v[16:19]
    ds_read_b64_tr_b16 v[240:241], v3 offset:24576
    v_mfma_f32_16x16x32_bf16 v[40:43], v[176:179], v[204:207], v[40:43]
    ds_read_b64_tr_b16 v[242:243], v3 offset:28672
    v_mfma_f32_16x16x32_bf16 v[44:47], v[180:183], v[204:207], v[44:47]
    ds_read_b128 v[216:219], v1 offset:37632
    v_mfma_f32_16x16x32_bf16 v[20:23], v[180:183], v[200:203], v[20:23]
    ds_read_b64_tr_b16 v[244:245], v4 offset:24576
    v_mfma_f32_16x16x32_bf16 v[24:27], v[184:187], v[200:203], v[24:27]
    ds_read_b64_tr_b16 v[246:247], v4 offset:28672
    v_mfma_f32_16x16x32_bf16 v[48:51], v[184:187], v[204:207], v[48:51]
    ds_read_b128 v[220:223], v1 offset:37696
    s_waitcnt lgkmcnt(10)
    v_mfma_f32_16x16x32_bf16 v[52:55], v[188:191], v[204:207], v[52:55]
    ds_read_b128 v[224:227], v1 offset:38144
    v_mfma_f32_16x16x32_bf16 v[28:31], v[188:191], v[200:203], v[28:31]
    ds_read_b128 v[228:231], v1 offset:38208
    v_mfma_f32_16x16x32_bf16 v[32:35], v[192:195], v[200:203], v[32:35]
    ds_read_b128 v[232:235], v1 offset:38656
    v_mfma_f32_16x16x32_bf16 v[56:59], v[192:195], v[204:207], v[56:59]
    ds_read_b128 v[236:239], v1 offset:38720
    v_mfma_f32_16x16x32_bf16 v[60:63], v[196:199], v[204:207], v[60:63]
    ds_read_b64_tr_b16 v[248:249], v5 offset:24576
    v_mfma_f32_16x16x32_bf16 v[36:39], v[196:199], v[200:203], v[36:39]
    ds_read_b64_tr_b16 v[250:251], v5 offset:28672
    s_waitcnt lgkmcnt(12)
    v_mfma_f32_16x16x32_bf16 v[84:87], v[196:199], v[208:211], v[84:87]
    ds_read_b64_tr_b16 v[252:253], v6 offset:24576
    v_mfma_f32_16x16x32_bf16 v[108:111], v[196:199], v[212:215], v[108:111]
    ds_read_b64_tr_b16 v[254:255], v6 offset:28672
    v_mfma_f32_16x16x32_bf16 v[104:107], v[192:195], v[212:215], v[104:107]
    v_mfma_f32_16x16x32_bf16 v[80:83], v[192:195], v[208:211], v[80:83]
    v_mfma_f32_16x16x32_bf16 v[76:79], v[188:191], v[208:211], v[76:79]
    v_mfma_f32_16x16x32_bf16 v[100:103], v[188:191], v[212:215], v[100:103]
    v_mfma_f32_16x16x32_bf16 v[96:99], v[184:187], v[212:215], v[96:99]
    v_mfma_f32_16x16x32_bf16 v[72:75], v[184:187], v[208:211], v[72:75]
    v_mfma_f32_16x16x32_bf16 v[68:71], v[180:183], v[208:211], v[68:71]
    v_mfma_f32_16x16x32_bf16 v[92:95], v[180:183], v[212:215], v[92:95]
    v_mfma_f32_16x16x32_bf16 v[88:91], v[176:179], v[212:215], v[88:91]
    v_mfma_f32_16x16x32_bf16 v[64:67], v[176:179], v[208:211], v[64:67]
    s_waitcnt lgkmcnt(8)
    v_mfma_f32_16x16x32_bf16 v[16:19], v[216:219], v[240:243], v[16:19]
    v_mfma_f32_16x16x32_bf16 v[40:43], v[216:219], v[244:247], v[40:43]
    v_mfma_f32_16x16x32_bf16 v[44:47], v[220:223], v[244:247], v[44:47]
    s_waitcnt lgkmcnt(0)
    s_barrier
    v_mfma_f32_16x16x32_bf16 v[20:23], v[220:223], v[240:243], v[20:23]
    ds_read_b64_tr_b16 v[200:201], v3 offset:32768
    v_mfma_f32_16x16x32_bf16 v[24:27], v[224:227], v[240:243], v[24:27]
    ds_read_b64_tr_b16 v[202:203], v3 offset:36864
    v_mfma_f32_16x16x32_bf16 v[48:51], v[224:227], v[244:247], v[48:51]
    ds_read_b128 v[176:179], v2 offset:0
    v_mfma_f32_16x16x32_bf16 v[52:55], v[228:231], v[244:247], v[52:55]
    ds_read_b64_tr_b16 v[204:205], v4 offset:32768
    v_mfma_f32_16x16x32_bf16 v[28:31], v[228:231], v[240:243], v[28:31]
    ds_read_b64_tr_b16 v[206:207], v4 offset:36864
    v_mfma_f32_16x16x32_bf16 v[32:35], v[232:235], v[240:243], v[32:35]
    ds_read_b128 v[180:183], v2 offset:64
    v_mfma_f32_16x16x32_bf16 v[56:59], v[232:235], v[244:247], v[56:59]
    ds_read_b128 v[184:187], v2 offset:512
    v_mfma_f32_16x16x32_bf16 v[60:63], v[236:239], v[244:247], v[60:63]
    ds_read_b128 v[188:191], v2 offset:576
    v_mfma_f32_16x16x32_bf16 v[36:39], v[236:239], v[240:243], v[36:39]
    ds_read_b128 v[192:195], v2 offset:1024
    v_mfma_f32_16x16x32_bf16 v[84:87], v[236:239], v[248:251], v[84:87]
    ds_read_b128 v[196:199], v2 offset:1088
    v_mfma_f32_16x16x32_bf16 v[108:111], v[236:239], v[252:255], v[108:111]
    ds_read_b64_tr_b16 v[208:209], v5 offset:32768
    v_mfma_f32_16x16x32_bf16 v[104:107], v[232:235], v[252:255], v[104:107]
    ds_read_b64_tr_b16 v[210:211], v5 offset:36864
    v_mfma_f32_16x16x32_bf16 v[80:83], v[232:235], v[248:251], v[80:83]
    ds_read_b64_tr_b16 v[212:213], v6 offset:32768
    v_mfma_f32_16x16x32_bf16 v[76:79], v[228:231], v[248:251], v[76:79]
    ds_read_b64_tr_b16 v[214:215], v6 offset:36864
    v_mfma_f32_16x16x32_bf16 v[100:103], v[228:231], v[252:255], v[100:103]
    v_mfma_f32_16x16x32_bf16 v[96:99], v[224:227], v[252:255], v[96:99]
    v_mfma_f32_16x16x32_bf16 v[72:75], v[224:227], v[248:251], v[72:75]
    v_mfma_f32_16x16x32_bf16 v[68:71], v[220:223], v[248:251], v[68:71]
    v_mfma_f32_16x16x32_bf16 v[92:95], v[220:223], v[252:255], v[92:95]
    v_mfma_f32_16x16x32_bf16 v[88:91], v[216:219], v[252:255], v[88:91]
    v_mfma_f32_16x16x32_bf16 v[64:67], v[216:219], v[248:251], v[64:67]
    s_waitcnt lgkmcnt(7)
    v_mfma_f32_16x16x32_bf16 v[16:19], v[176:179], v[200:203], v[16:19]
    ds_read_b64_tr_b16 v[240:241], v3 offset:40960
    v_mfma_f32_16x16x32_bf16 v[40:43], v[176:179], v[204:207], v[40:43]
    ds_read_b64_tr_b16 v[242:243], v3 offset:45056
    v_mfma_f32_16x16x32_bf16 v[44:47], v[180:183], v[204:207], v[44:47]
    ds_read_b128 v[216:219], v2 offset:12544
    v_mfma_f32_16x16x32_bf16 v[20:23], v[180:183], v[200:203], v[20:23]
    ds_read_b64_tr_b16 v[244:245], v4 offset:40960
    v_mfma_f32_16x16x32_bf16 v[24:27], v[184:187], v[200:203], v[24:27]
    ds_read_b64_tr_b16 v[246:247], v4 offset:45056
    v_mfma_f32_16x16x32_bf16 v[48:51], v[184:187], v[204:207], v[48:51]
    ds_read_b128 v[220:223], v2 offset:12608
    s_waitcnt lgkmcnt(10)
    v_mfma_f32_16x16x32_bf16 v[52:55], v[188:191], v[204:207], v[52:55]
    ds_read_b128 v[224:227], v2 offset:13056
    v_mfma_f32_16x16x32_bf16 v[28:31], v[188:191], v[200:203], v[28:31]
    ds_read_b128 v[228:231], v2 offset:13120
    v_mfma_f32_16x16x32_bf16 v[32:35], v[192:195], v[200:203], v[32:35]
    ds_read_b128 v[232:235], v2 offset:13568
    v_mfma_f32_16x16x32_bf16 v[56:59], v[192:195], v[204:207], v[56:59]
    ds_read_b128 v[236:239], v2 offset:13632
    v_mfma_f32_16x16x32_bf16 v[60:63], v[196:199], v[204:207], v[60:63]
    ds_read_b64_tr_b16 v[248:249], v5 offset:40960
    v_mfma_f32_16x16x32_bf16 v[36:39], v[196:199], v[200:203], v[36:39]
    ds_read_b64_tr_b16 v[250:251], v5 offset:45056
    s_waitcnt lgkmcnt(12)
    v_mfma_f32_16x16x32_bf16 v[84:87], v[196:199], v[208:211], v[84:87]
    ds_read_b64_tr_b16 v[252:253], v6 offset:40960
    v_mfma_f32_16x16x32_bf16 v[108:111], v[196:199], v[212:215], v[108:111]
    ds_read_b64_tr_b16 v[254:255], v6 offset:45056
    v_mfma_f32_16x16x32_bf16 v[104:107], v[192:195], v[212:215], v[104:107]
    v_mfma_f32_16x16x32_bf16 v[80:83], v[192:195], v[208:211], v[80:83]
    v_mfma_f32_16x16x32_bf16 v[76:79], v[188:191], v[208:211], v[76:79]
    v_mfma_f32_16x16x32_bf16 v[100:103], v[188:191], v[212:215], v[100:103]
    v_mfma_f32_16x16x32_bf16 v[96:99], v[184:187], v[212:215], v[96:99]
    v_mfma_f32_16x16x32_bf16 v[72:75], v[184:187], v[208:211], v[72:75]
    v_mfma_f32_16x16x32_bf16 v[68:71], v[180:183], v[208:211], v[68:71]
    v_mfma_f32_16x16x32_bf16 v[92:95], v[180:183], v[212:215], v[92:95]
    v_mfma_f32_16x16x32_bf16 v[88:91], v[176:179], v[212:215], v[88:91]
    v_mfma_f32_16x16x32_bf16 v[64:67], v[176:179], v[208:211], v[64:67]
    s_waitcnt lgkmcnt(8)
    v_mfma_f32_16x16x32_bf16 v[16:19], v[216:219], v[240:243], v[16:19]
    s_sub_u32 s57, s57, 1
    s_cmp_lg_u32 s57, 0
    v_mfma_f32_16x16x32_bf16 v[40:43], v[216:219], v[244:247], v[40:43]
    v_mfma_f32_16x16x32_bf16 v[44:47], v[220:223], v[244:247], v[44:47]
    s_waitcnt lgkmcnt(0)
    s_barrier
    v_mfma_f32_16x16x32_bf16 v[20:23], v[220:223], v[240:243], v[20:23]
    ds_read_b64_tr_b16 v[200:201], v3 offset:0
    v_mfma_f32_16x16x32_bf16 v[24:27], v[224:227], v[240:243], v[24:27]
    ds_read_b64_tr_b16 v[202:203], v3 offset:4096
    v_mfma_f32_16x16x32_bf16 v[48:51], v[224:227], v[244:247], v[48:51]
    ds_read_b128 v[176:179], v1 offset:0
    v_mfma_f32_16x16x32_bf16 v[52:55], v[228:231], v[244:247], v[52:55]
    ds_read_b64_tr_b16 v[204:205], v4 offset:0
    v_mfma_f32_16x16x32_bf16 v[28:31], v[228:231], v[240:243], v[28:31]
    ds_read_b64_tr_b16 v[206:207], v4 offset:4096
    v_mfma_f32_16x16x32_bf16 v[32:35], v[232:235], v[240:243], v[32:35]
    ds_read_b128 v[180:183], v1 offset:64
    v_mfma_f32_16x16x32_bf16 v[56:59], v[232:235], v[244:247], v[56:59]
    ds_read_b128 v[184:187], v1 offset:512
    v_mfma_f32_16x16x32_bf16 v[60:63], v[236:239], v[244:247], v[60:63]
    ds_read_b128 v[188:191], v1 offset:576
    v_mfma_f32_16x16x32_bf16 v[36:39], v[236:239], v[240:243], v[36:39]
    ds_read_b128 v[192:195], v1 offset:1024
    v_mfma_f32_16x16x32_bf16 v[84:87], v[236:239], v[248:251], v[84:87]
    ds_read_b128 v[196:199], v1 offset:1088
    v_mfma_f32_16x16x32_bf16 v[108:111], v[236:239], v[252:255], v[108:111]
    ds_read_b64_tr_b16 v[208:209], v5 offset:0
    v_mfma_f32_16x16x32_bf16 v[104:107], v[232:235], v[252:255], v[104:107]
    ds_read_b64_tr_b16 v[210:211], v5 offset:4096
    v_mfma_f32_16x16x32_bf16 v[80:83], v[232:235], v[248:251], v[80:83]
    ds_read_b64_tr_b16 v[212:213], v6 offset:0
    v_mfma_f32_16x16x32_bf16 v[76:79], v[228:231], v[248:251], v[76:79]
    ds_read_b64_tr_b16 v[214:215], v6 offset:4096
    v_mfma_f32_16x16x32_bf16 v[100:103], v[228:231], v[252:255], v[100:103]
    v_mfma_f32_16x16x32_bf16 v[96:99], v[224:227], v[252:255], v[96:99]
    v_mfma_f32_16x16x32_bf16 v[72:75], v[224:227], v[248:251], v[72:75]
    v_mfma_f32_16x16x32_bf16 v[68:71], v[220:223], v[248:251], v[68:71]
    v_mfma_f32_16x16x32_bf16 v[92:95], v[220:223], v[252:255], v[92:95]
    v_mfma_f32_16x16x32_bf16 v[88:91], v[216:219], v[252:255], v[88:91]
    v_mfma_f32_16x16x32_bf16 v[64:67], v[216:219], v[248:251], v[64:67]
    s_cbranch_scc1 g2_5
L_g2_tail:
    s_waitcnt lgkmcnt(7)
    v_mfma_f32_16x16x32_bf16 v[16:19], v[176:179], v[200:203], v[16:19]
    ds_read_b64_tr_b16 v[240:241], v3 offset:8192
    v_mfma_f32_16x16x32_bf16 v[40:43], v[176:179], v[204:207], v[40:43]
    ds_read_b64_tr_b16 v[242:243], v3 offset:12288
    v_mfma_f32_16x16x32_bf16 v[44:47], v[180:183], v[204:207], v[44:47]
    ds_read_b128 v[216:219], v1 offset:12544
    v_mfma_f32_16x16x32_bf16 v[20:23], v[180:183], v[200:203], v[20:23]
    ds_read_b64_tr_b16 v[244:245], v4 offset:8192
    v_mfma_f32_16x16x32_bf16 v[24:27], v[184:187], v[200:203], v[24:27]
    ds_read_b64_tr_b16 v[246:247], v4 offset:12288
    v_mfma_f32_16x16x32_bf16 v[48:51], v[184:187], v[204:207], v[48:51]
    ds_read_b128 v[220:223], v1 offset:12608
    s_waitcnt lgkmcnt(10)
    v_mfma_f32_16x16x32_bf16 v[52:55], v[188:191], v[204:207], v[52:55]
    ds_read_b128 v[224:227], v1 offset:13056
    v_mfma_f32_16x16x32_bf16 v[28:31], v[188:191], v[200:203], v[28:31]
    ds_read_b128 v[228:231], v1 offset:13120
    v_mfma_f32_16x16x32_bf16 v[32:35], v[192:195], v[200:203], v[32:35]
    ds_read_b128 v[232:235], v1 offset:13568
    v_mfma_f32_16x16x32_bf16 v[56:59], v[192:195], v[204:207], v[56:59]
    ds_read_b128 v[236:239], v1 offset:13632
    v_mfma_f32_16x16x32_bf16 v[60:63], v[196:199], v[204:207], v[60:63]
    ds_read_b64_tr_b16 v[248:249], v5 offset:8192
    v_mfma_f32_16x16x32_bf16 v[36:39], v[196:199], v[200:203], v[36:39]
    ds_read_b64_tr_b16 v[250:251], v5 offset:12288
    s_waitcnt lgkmcnt(12)
    v_mfma_f32_16x16x32_bf16 v[84:87], v[196:199], v[208:211], v[84:87]
    ds_read_b64_tr_b16 v[252:253], v6 offset:8192
    v_mfma_f32_16x16x32_bf16 v[108:111], v[196:199], v[212:215], v[108:111]
    ds_read_b64_tr_b16 v[254:255], v6 offset:12288
    v_mfma_f32_16x16x32_bf16 v[104:107], v[192:195], v[212:215], v[104:107]
    v_mfma_f32_16x16x32_bf16 v[80:83], v[192:195], v[208:211], v[80:83]
    v_mfma_f32_16x16x32_bf16 v[76:79], v[188:191], v[208:211], v[76:79]
    v_mfma_f32_16x16x32_bf16 v[100:103], v[188:191], v[212:215], v[100:103]
    v_mfma_f32_16x16x32_bf16 v[96:99], v[184:187], v[212:215], v[96:99]
    v_mfma_f32_16x16x32_bf16 v[72:75], v[184:187], v[208:211], v[72:75]
    v_mfma_f32_16x16x32_bf16 v[68:71], v[180:183], v[208:211], v[68:71]
    v_mfma_f32_16x16x32_bf16 v[92:95], v[180:183], v[212:215], v[92:95]
    v_mfma_f32_16x16x32_bf16 v[88:91], v[176:179], v[212:215], v[88:91]
    v_mfma_f32_16x16x32_bf16 v[64:67], v[176:179], v[208:211], v[64:67]
    s_waitcnt lgkmcnt(8)
    v_mfma_f32_16x16x32_bf16 v[16:19], v[216:219], v[240:243], v[16:19]
    v_mfma_f32_16x16x32_bf16 v[40:43], v[216:219], v[244:247], v[40:43]
    v_mfma_f32_16x16x32_bf16 v[44:47], v[220:223], v[244:247], v[44:47]
    s_waitcnt lgkmcnt(0)
    s_barrier
    v_mfma_f32_16x16x32_bf16 v[20:23], v[220:223], v[240:243], v[20:23]
    ds_read_b64_tr_b16 v[200:201], v3 offset:16384
    v_mfma_f32_16x16x32_bf16 v[24:27], v[224:227], v[240:243], v[24:27]
    ds_read_b64_tr_b16 v[202:203], v3 offset:20480
    v_mfma_f32_16x16x32_bf16 v[48:51], v[224:227], v[244:247], v[48:51]
    ds_read_b128 v[176:179], v1 offset:25088
    v_mfma_f32_16x16x32_bf16 v[52:55], v[228:231], v[244:247], v[52:55]
    ds_read_b64_tr_b16 v[204:205], v4 offset:16384
    v_mfma_f32_16x16x32_bf16 v[28:31], v[228:231], v[240:243], v[28:31]
    ds_read_b64_tr_b16 v[206:207], v4 offset:20480
    v_mfma_f32_16x16x32_bf16 v[32:35], v[232:235], v[240:243], v[32:35]
    ds_read_b128 v[180:183], v1 offset:25152
    v_mfma_f32_16x16x32_bf16 v[56:59], v[232:235], v[244:247], v[56:59]
    ds_read_b128 v[184:187], v1 offset:25600
    v_mfma_f32_16x16x32_bf16 v[60:63], v[236:239], v[244:247], v[60:63]
    ds_read_b128 v[188:191], v1 offset:25664
    v_mfma_f32_16x16x32_bf16 v[36:39], v[236:239], v[240:243], v[36:39]
    ds_read_b128 v[192:195], v1 offset:26112
    v_mfma_f32_16x16x32_bf16 v[84:87], v[236:239], v[248:251], v[84:87]
    ds_read_b128 v[196:199], v1 offset:26176
    v_mfma_f32_16x16x32_bf16 v[108:111], v[236:239], v[252:255], v[108:111]
    ds_read_b64_tr_b16 v[208:209], v5 offset:16384
    v_mfma_f32_16x16x32_bf16 v[104:107], v[232:235], v[252:255], v[104:107]
    ds_read_b64_tr_b16 v[210:211], v5 offset:20480
    v_mfma_f32_16x16x32_bf16 v[80:83], v[232:235], v[248:251], v[80:83]
    ds_read_b64_tr_b16 v[212:213], v6 offset:16384
    v_mfma_f32_16x16x32_bf16 v[76:79], v[228:231], v[248:251], v[76:79]
    ds_read_b64_tr_b16 v[214:215], v6 offset:20480
    v_mfma_f32_16x16x32_bf16 v[100:103], v[228:231], v[252:255], v[100:103]
    v_mfma_f32_16x16x32_bf16 v[96:99], v[224:227], v[252:255], v[96:99]
    v_mfma_f32_16x16x32_bf16 v[72:75], v[224:227], v[248:251], v[72:75]
    v_mfma_f32_16x16x32_bf16 v[68:71], v[220:223], v[248:251], v[68:71]
    v_mfma_f32_16x16x32_bf16 v[92:95], v[220:223], v[252:255], v[92:95]
    v_mfma_f32_16x16x32_bf16 v[88:91], v[216:219], v[252:255], v[88:91]
    v_mfma_f32_16x16x32_bf16 v[64:67], v[216:219], v[248:251], v[64:67]
    s_waitcnt lgkmcnt(8)
    v_mfma_f32_16x16x32_bf16 v[16:19], v[176:179], v[200:203], v[16:19]
    ds_read_b64_tr_b16 v[240:241], v3 offset:24576
    v_mfma_f32_16x16x32_bf16 v[40:43], v[176:179], v[204:207], v[40:43]
    ds_read_b64_tr_b16 v[242:243], v3 offset:28672
    v_mfma_f32_16x16x32_bf16 v[44:47], v[180:183], v[204:207], v[44:47]
    ds_read_b128 v[216:219], v1 offset:37632
    v_mfma_f32_16x16x32_bf16 v[20:23], v[180:183], v[200:203], v[20:23]
    ds_read_b64_tr_b16 v[244:245], v4 offset:24576
    s_waitcnt lgkmcnt(10)
    v_mfma_f32_16x16x32_bf16 v[24:27], v[184:187], v[200:203], v[24:27]
    ds_read_b64_tr_b16 v[246:247], v4 offset:28672
    v_mfma_f32_16x16x32_bf16 v[48:51], v[184:187], v[204:207], v[48:51]
    ds_read_b128 v[220:223], v1 offset:37696
    v_mfma_f32_16x16x32_bf16 v[52:55], v[188:191], v[204:207], v[52:55]
    ds_read_b128 v[224:227], v1 offset:38144
    v_mfma_f32_16x16x32_bf16 v[28:31], v[188:191], v[200:203], v[28:31]
    ds_read_b128 v[228:231], v1 offset:38208
    s_waitcnt lgkmcnt(12)
    v_mfma_f32_16x16x32_bf16 v[32:35], v[192:195], v[200:203], v[32:35]
    ds_read_b128 v[232:235], v1 offset:38656
    v_mfma_f32_16x16x32_bf16 v[56:59], v[192:195], v[204:207], v[56:59]
    ds_read_b128 v[236:239], v1 offset:38720
    v_mfma_f32_16x16x32_bf16 v[60:63], v[196:199], v[204:207], v[60:63]
    ds_read_b64_tr_b16 v[248:249], v5 offset:24576
    v_mfma_f32_16x16x32_bf16 v[36:39], v[196:199], v[200:203], v[36:39]
    ds_read_b64_tr_b16 v[250:251], v5 offset:28672
    s_waitcnt lgkmcnt(12)
    v_mfma_f32_16x16x32_bf16 v[84:87], v[196:199], v[208:211], v[84:87]
    ds_read_b64_tr_b16 v[252:253], v6 offset:24576
    v_mfma_f32_16x16x32_bf16 v[108:111], v[196:199], v[212:215], v[108:111]
    ds_read_b64_tr_b16 v[254:255], v6 offset:28672
    v_mfma_f32_16x16x32_bf16 v[104:107], v[192:195], v[212:215], v[104:107]
    ds_read_b64_tr_b16 v[126:127], v115 offset:37376
    v_mfma_f32_16x16x32_bf16 v[80:83], v[192:195], v[208:211], v[80:83]
    ds_read_b64_tr_b16 v[128:129], v115 offset:43520
    v_mfma_f32_16x16x32_bf16 v[76:79], v[188:191], v[208:211], v[76:79]
    ds_read_b64_tr_b16 v[130:131], v115 offset:37384
    v_mfma_f32_16x16x32_bf16 v[100:103], v[188:191], v[212:215], v[100:103]
    ds_read_b64_tr_b16 v[132:133], v115 offset:43528
    v_mfma_f32_16x16x32_bf16 v[96:99], v[184:187], v[212:215], v[96:99]
    ds_read_b64_tr_b16 v[134:135], v116 offset:37376
    v_mfma_f32_16x16x32_bf16 v[72:75], v[184:187], v[208:211], v[72:75]
    ds_read_b64_tr_b16 v[136:137], v116 offset:43520
    v_mfma_f32_16x16x32_bf16 v[68:71], v[180:183], v[208:211], v[68:71]
    ds_read_b64_tr_b16 v[138:139], v116 offset:37384
    v_mfma_f32_16x16x32_bf16 v[92:95], v[180:183], v[212:215], v[92:95]
    v_mfma_f32_16x16x32_bf16 v[88:91], v[176:179], v[212:215], v[88:91]
    v_mfma_f32_16x16x32_bf16 v[64:67], v[176:179], v[208:211], v[64:67]
    s_waitcnt lgkmcnt(14)
    v_mfma_f32_16x16x32_bf16 v[16:19], v[216:219], v[240:243], v[16:19]
    v_mfma_f32_16x16x32_bf16 v[40:43], v[216:219], v[244:247], v[40:43]
    v_mfma_f32_16x16x32_bf16 v[44:47], v[220:223], v[244:247], v[44:47]
    s_waitcnt lgkmcnt(0)
    s_barrier
    v_mfma_f32_16x16x32_bf16 v[20:23], v[220:223], v[240:243], v[20:23]
    ds_read_b64_tr_b16 v[200:201], v3 offset:32768
    v_mfma_f32_16x16x32_bf16 v[24:27], v[224:227], v[240:243], v[24:27]
    ds_read_b64_tr_b16 v[202:203], v3 offset:36864
    v_mfma_f32_16x16x32_bf16 v[48:51], v[224:227], v[244:247], v[48:51]
    ds_read_b128 v[176:179], v2 offset:0
    v_mfma_f32_16x16x32_bf16 v[52:55], v[228:231], v[244:247], v[52:55]
    ds_read_b64_tr_b16 v[204:205], v4 offset:32768
    v_mfma_f32_16x16x32_bf16 v[28:31], v[228:231], v[240:243], v[28:31]
    ds_read_b64_tr_b16 v[206:207], v4 offset:36864
    v_mfma_f32_16x16x32_bf16 v[32:35], v[232:235], v[240:243], v[32:35]
    ds_read_b128 v[180:183], v2 offset:64
    v_mfma_f32_16x16x32_bf16 v[56:59], v[232:235], v[244:247], v[56:59]
    ds_read_b128 v[184:187], v2 offset:512
    v_mfma_f32_16x16x32_bf16 v[60:63], v[236:239], v[244:247], v[60:63]
    ds_read_b128 v[188:191], v2 offset:576
    v_mfma_f32_16x16x32_bf16 v[36:39], v[236:239], v[240:243], v[36:39]
    ds_read_b128 v[192:195], v2 offset:1024
    v_mfma_f32_16x16x32_bf16 v[84:87], v[236:239], v[248:251], v[84:87]
    ds_read_b128 v[196:199], v2 offset:1088
    v_mfma_f32_16x16x32_bf16 v[108:111], v[236:239], v[252:255], v[108:111]
    ds_read_b64_tr_b16 v[208:209], v5 offset:32768
    v_mfma_f32_16x16x32_bf16 v[104:107], v[232:235], v[252:255], v[104:107]
    ds_read_b64_tr_b16 v[210:211], v5 offset:36864
    v_mfma_f32_16x16x32_bf16 v[80:83], v[232:235], v[248:251], v[80:83]
    ds_read_b64_tr_b16 v[212:213], v6 offset:32768
    v_mfma_f32_16x16x32_bf16 v[76:79], v[228:231], v[248:251], v[76:79]
    ds_read_b64_tr_b16 v[214:215], v6 offset:36864
    v_mfma_f32_16x16x32_bf16 v[100:103], v[228:231], v[252:255], v[100:103]
    ds_read_b64_tr_b16 v[140:141], v116 offset:43528
    v_mfma_f32_16x16x32_bf16 v[96:99], v[224:227], v[252:255], v[96:99]
    ds_read_b64_tr_b16 v[142:143], v117 offset:37376
    v_mfma_f32_16x16x32_bf16 v[72:75], v[224:227], v[248:251], v[72:75]
    ds_read_b64_tr_b16 v[144:145], v117 offset:43520
    v_mfma_f32_16x16x32_bf16 v[68:71], v[220:223], v[248:251], v[68:71]
    ds_read_b64_tr_b16 v[146:147], v117 offset:37384
    v_mfma_f32_16x16x32_bf16 v[92:95], v[220:223], v[252:255], v[92:95]
    ds_read_b64_tr_b16 v[148:149], v117 offset:43528
    v_mfma_f32_16x16x32_bf16 v[88:91], v[216:219], v[252:255], v[88:91]
    ds_read_b64_tr_b16 v[150:151], v115 offset:0
    v_mfma_f32_16x16x32_bf16 v[64:67], v[216:219], v[248:251], v[64:67]
    ds_read_b64_tr_b16 v[152:153], v115 offset:8
    s_waitcnt lgkmcnt(14)
    v_mfma_f32_16x16x32_bf16 v[16:19], v[176:179], v[200:203], v[16:19]
    ds_read_b64_tr_b16 v[240:241], v3 offset:40960
    v_mfma_f32_16x16x32_bf16 v[40:43], v[176:179], v[204:207], v[40:43]
    ds_read_b64_tr_b16 v[242:243], v3 offset:45056
    v_mfma_f32_16x16x32_bf16 v[44:47], v[180:183], v[204:207], v[44:47]
    ds_read_b128 v[216:219], v2 offset:12544
    v_mfma_f32_16x16x32_bf16 v[20:23], v[180:183], v[200:203], v[20:23]
    ds_read_b64_tr_b16 v[244:245], v4 offset:40960
    v_mfma_f32_16x16x32_bf16 v[24:27], v[184:187], v[200:203], v[24:27]
    ds_read_b64_tr_b16 v[246:247], v4 offset:45056
    v_mfma_f32_16x16x32_bf16 v[48:51], v[184:187], v[204:207], v[48:51]
    ds_read_b128 v[220:223], v2 offset:12608
    s_waitcnt lgkmcnt(14)
    v_mfma_f32_16x16x32_bf16 v[52:55], v[188:191], v[204:207], v[52:55]
    ds_read_b128 v[224:227], v2 offset:13056
    v_mfma_f32_16x16x32_bf16 v[28:31], v[188:191], v[200:203], v[28:31]
    ds_read_b128 v[228:231], v2 offset:13120
    v_mfma_f32_16x16x32_bf16 v[32:35], v[192:195], v[200:203], v[32:35]
    ds_read_b128 v[232:235], v2 offset:13568
    v_mfma_f32_16x16x32_bf16 v[56:59], v[192:195], v[204:207], v[56:59]
    ds_read_b128 v[236:239], v2 offset:13632
    v_mfma_f32_16x16x32_bf16 v[60:63], v[196:199], v[204:207], v[60:63]
    ds_read_b64_tr_b16 v[248:249], v5 offset:40960
    v_mfma_f32_16x16x32_bf16 v[36:39], v[196:199], v[200:203], v[36:39]
    ds_read_b64_tr_b16 v[250:251], v5 offset:45056
    v_mfma_f32_16x16x32_bf16 v[84:87], v[196:199], v[208:211], v[84:87]
    ds_read_b64_tr_b16 v[252:253], v6 offset:40960
    s_waitcnt lgkmcnt(14)
    v_mfma_f32_16x16x32_bf16 v[108:111], v[196:199], v[212:215], v[108:111]
    ds_read_b64_tr_b16 v[254:255], v6 offset:45056
    v_mfma_f32_16x16x32_bf16 v[104:107], v[192:195], v[212:215], v[104:107]
    ds_read_b64_tr_b16 v[154:155], v116 offset:0
    v_mfma_f32_16x16x32_bf16 v[80:83], v[192:195], v[208:211], v[80:83]
    ds_read_b64_tr_b16 v[156:157], v116 offset:8
    v_mfma_f32_16x16x32_bf16 v[76:79], v[188:191], v[208:211], v[76:79]
    ds_read_b64_tr_b16 v[158:159], v117 offset:0
    v_mfma_f32_16x16x32_bf16 v[100:103], v[188:191], v[212:215], v[100:103]
    ds_read_b64_tr_b16 v[160:161], v117 offset:8
    v_mfma_f32_16x16x32_bf16 v[96:99], v[184:187], v[212:215], v[96:99]
    v_mfma_f32_16x16x32_bf16 v[72:75], v[184:187], v[208:211], v[72:75]
    v_mfma_f32_16x16x32_bf16 v[68:71], v[180:183], v[208:211], v[68:71]
    v_mfma_f32_16x16x32_bf16 v[92:95], v[180:183], v[212:215], v[92:95]
    v_mfma_f32_16x16x32_bf16 v[88:91], v[176:179], v[212:215], v[88:91]
    v_mfma_f32_16x16x32_bf16 v[64:67], v[176:179], v[208:211], v[64:67]
    s_waitcnt lgkmcnt(12)
    v_mfma_f32_16x16x32_bf16 v[16:19], v[216:219], v[240:243], v[16:19]
    ds_read_b64_tr_b16 v[176:177], v112 offset:0
    v_mfma_f32_16x16x32_bf16 v[40:43], v[216:219], v[244:247], v[40:43]
    ds_read_b64_tr_b16 v[178:179], v112 offset:6144
    v_mfma_f32_16x16x32_bf16 v[44:47], v[220:223], v[244:247], v[44:47]
    ds_read_b64_tr_b16 v[180:181], v112 offset:8
    v_mfma_f32_16x16x32_bf16 v[20:23], v[220:223], v[240:243], v[20:23]
    ds_read_b64_tr_b16 v[182:183], v112 offset:6152
    s_waitcnt lgkmcnt(14)
    v_mfma_f32_16x16x32_bf16 v[24:27], v[224:227], v[240:243], v[24:27]
    ds_read_b64_tr_b16 v[184:185], v113 offset:0
    v_mfma_f32_16x16x32_bf16 v[48:51], v[224:227], v[244:247], v[48:51]
    ds_read_b64_tr_b16 v[186:187], v113 offset:6144
    v_mfma_f32_16x16x32_bf16 v[52:55], v[228:231], v[244:247], v[52:55]
    ds_read_b64_tr_b16 v[188:189], v113 offset:8
    v_mfma_f32_16x16x32_bf16 v[28:31], v[228:231], v[240:243], v[28:31]
    ds_read_b64_tr_b16 v[190:191], v113 offset:6152
    s_waitcnt lgkmcnt(14)
    v_mfma_f32_16x16x32_bf16 v[32:35], v[232:235], v[240:243], v[32:35]
    ds_read_b64_tr_b16 v[192:193], v114 offset:0
    v_mfma_f32_16x16x32_bf16 v[56:59], v[232:235], v[244:247], v[56:59]
    ds_read_b64_tr_b16 v[194:195], v114 offset:6144
    v_mfma_f32_16x16x32_bf16 v[60:63], v[236:239], v[244:247], v[60:63]
    ds_read_b64_tr_b16 v[196:197], v114 offset:8
    v_mfma_f32_16x16x32_bf16 v[36:39], v[236:239], v[240:243], v[36:39]
    ds_read_b64_tr_b16 v[198:199], v114 offset:6152
    v_mfma_f32_16x16x32_bf16 v[84:87], v[236:239], v[248:251], v[84:87]
    s_waitcnt lgkmcnt(14)
    v_mfma_f32_16x16x32_bf16 v[108:111], v[236:239], v[252:255], v[108:111]
    v_mfma_f32_16x16x32_bf16 v[104:107], v[232:235], v[252:255], v[104:107]
    s_barrier
    v_mfma_f32_16x16x32_bf16 v[80:83], v[232:235], v[248:251], v[80:83]
    ds_read_b64_tr_b16 v[212:213], v118 offset:1536
    v_mfma_f32_16x16x32_bf16 v[76:79], v[228:231], v[248:251], v[76:79]
    ds_read_b64_tr_b16 v[214:215], v118 offset:1792
    v_mfma_f32_16x16x32_bf16 v[100:103], v[228:231], v[252:255], v[100:103]
    ds_read_b64_tr_b16 v[162:163], v118 offset:2048
    v_mfma_f32_16x16x32_bf16 v[96:99], v[224:227], v[252:255], v[96:99]
    ds_read_b64_tr_b16 v[200:201], v118 offset:0
    v_mfma_f32_16x16x32_bf16 v[72:75], v[224:227], v[248:251], v[72:75]
    ds_read_b64_tr_b16 v[202:203], v118 offset:256
    v_mfma_f32_16x16x32_bf16 v[68:71], v[220:223], v[248:251], v[68:71]
    ds_read_b64_tr_b16 v[204:205], v118 offset:512
    v_mfma_f32_16x16x32_bf16 v[92:95], v[220:223], v[252:255], v[92:95]
    ds_read_b64_tr_b16 v[206:207], v118 offset:768
    v_mfma_f32_16x16x32_bf16 v[88:91], v[216:219], v[252:255], v[88:91]
    ds_read_b64_tr_b16 v[208:209], v118 offset:1024
    v_mfma_f32_16x16x32_bf16 v[64:67], v[216:219], v[248:251], v[64:67]
    ds_read_b64_tr_b16 v[210:211], v118 offset:1280
    s_waitcnt lgkmcnt(7)
    v_mfma_f32_16x16x32_bf16 v[40:43], v[126:129], v[212:215], v[40:43]
    ds_read_b64_tr_b16 v[216:217], v112 offset:12544
    v_mfma_f32_16x16x32_bf16 v[44:47], v[130:133], v[212:215], v[44:47]
    ds_read_b64_tr_b16 v[218:219], v112 offset:18688
    v_mfma_f32_16x16x32_bf16 v[48:51], v[134:137], v[212:215], v[48:51]
    ds_read_b64_tr_b16 v[220:221], v112 offset:12552
    v_mfma_f32_16x16x32_bf16 v[52:55], v[138:141], v[212:215], v[52:55]
    ds_read_b64_tr_b16 v[222:223], v112 offset:18696
    v_mfma_f32_16x16x32_bf16 v[56:59], v[142:145], v[212:215], v[56:59]
    ds_read_b64_tr_b16 v[224:225], v113 offset:12544
    v_mfma_f32_16x16x32_bf16 v[60:63], v[146:149], v[212:215], v[60:63]
    ds_read_b64_tr_b16 v[226:227], v113 offset:18688
    s_waitcnt lgkmcnt(12)
    v_mfma_f32_16x16x16_bf16 v[40:43], v[150:151], v[162:163], v[40:43]
    ds_read_b64_tr_b16 v[228:229], v113 offset:12552
    v_mfma_f32_16x16x16_bf16 v[44:47], v[152:153], v[162:163], v[44:47]
    ds_read_b64_tr_b16 v[230:231], v113 offset:18696
    v_mfma_f32_16x16x16_bf16 v[48:51], v[154:155], v[162:163], v[48:51]
    ds_read_b64_tr_b16 v[232:233], v114 offset:12544
    v_mfma_f32_16x16x16_bf16 v[52:55], v[156:157], v[162:163], v[52:55]
    ds_read_b64_tr_b16 v[234:235], v114 offset:18688
    v_mfma_f32_16x16x16_bf16 v[56:59], v[158:159], v[162:163], v[56:59]
    ds_read_b64_tr_b16 v[236:237], v114 offset:12552
    v_mfma_f32_16x16x16_bf16 v[60:63], v[160:161], v[162:163], v[60:63]
    ds_read_b64_tr_b16 v[238:239], v114 offset:18696
    s_waitcnt lgkmcnt(14)
    v_mfma_f32_16x16x32_bf16 v[40:43], v[176:179], v[200:203], v[40:43]
    ds_read_b64_tr_b16 v[240:241], v112 offset:25088
    v_mfma_f32_16x16x32_bf16 v[44:47], v[180:183], v[200:203], v[44:47]
    ds_read_b64_tr_b16 v[242:243], v112 offset:31232
    v_mfma_f32_16x16x32_bf16 v[48:51], v[184:187], v[200:203], v[48:51]
    ds_read_b64_tr_b16 v[244:245], v112 offset:25096
    v_mfma_f32_16x16x32_bf16 v[52:55], v[188:191], v[200:203], v[52:55]
    ds_read_b64_tr_b16 v[246:247], v112 offset:31240
    v_mfma_f32_16x16x32_bf16 v[56:59], v[192:195], v[200:203], v[56:59]
    ds_read_b64_tr_b16 v[248:249], v113 offset:25088
    v_mfma_f32_16x16x32_bf16 v[60:63], v[196:199], v[200:203], v[60:63]
    ds_read_b64_tr_b16 v[250:251], v113 offset:31232
    s_waitcnt lgkmcnt(12)
    v_mfma_f32_16x16x32_bf16 v[40:43], v[216:219], v[204:207], v[40:43]
    ds_read_b64_tr_b16 v[252:253], v113 offset:25096
    v_mfma_f32_16x16x32_bf16 v[44:47], v[220:223], v[204:207], v[44:47]
    ds_read_b64_tr_b16 v[254:255], v113 offset:31240
    v_mfma_f32_16x16x32_bf16 v[48:51], v[224:227], v[204:207], v[48:51]
    ds_read_b64_tr_b16 v[164:165], v114 offset:25088
    s_waitcnt lgkmcnt(9)
    v_mfma_f32_16x16x32_bf16 v[52:55], v[228:231], v[204:207], v[52:55]
    ds_read_b64_tr_b16 v[166:167], v114 offset:31232
    v_mfma_f32_16x16x32_bf16 v[56:59], v[232:235], v[204:207], v[56:59]
    ds_read_b64_tr_b16 v[168:169], v114 offset:25096
    v_mfma_f32_16x16x32_bf16 v[60:63], v[236:239], v[204:207], v[60:63]
    ds_read_b64_tr_b16 v[170:171], v114 offset:31240
    s_barrier
    s_waitcnt lgkmcnt(6)
    v_mfma_f32_16x16x32_bf16 v[40:43], v[240:243], v[208:211], v[40:43]
    ds_read_b64_tr_b16 v[212:213], v118 offset:11264
    v_mfma_f32_16x16x32_bf16 v[44:47], v[244:247], v[208:211], v[44:47]
    ds_read_b64_tr_b16 v[214:215], v118 offset:11520
    v_mfma_f32_16x16x32_bf16 v[48:51], v[248:251], v[208:211], v[48:51]
    ds_read_b64_tr_b16 v[162:163], v118 offset:11776
    s_waitcnt lgkmcnt(3)
    v_mfma_f32_16x16x32_bf16 v[52:55], v[252:255], v[208:211], v[52:55]
    ds_read_b64_tr_b16 v[200:201], v118 offset:9728
    v_mfma_f32_16x16x32_bf16 v[56:59], v[164:167], v[208:211], v[56:59]
    ds_read_b64_tr_b16 v[202:203], v118 offset:9984
    v_mfma_f32_16x16x32_bf16 v[60:63], v[168:171], v[208:211], v[60:63]
    s_waitcnt lgkmcnt(3)
    v_mfma_f32_16x16x32_bf16 v[64:67], v[126:129], v[212:215], v[64:67]
    ds_read_b64_tr_b16 v[204:205], v118 offset:10240
    v_mfma_f32_16x16x32_bf16 v[68:71], v[130:133], v[212:215], v[68:71]
    ds_read_b64_tr_b16 v[206:207], v118 offset:10496
    v_mfma_f32_16x16x32_bf16 v[72:75], v[134:137], v[212:215], v[72:75]
    ds_read_b64_tr_b16 v[208:209], v118 offset:10752
    v_mfma_f32_16x16x32_bf16 v[76:79], v[138:141], v[212:215], v[76:79]
    ds_read_b64_tr_b16 v[210:211], v118 offset:11008
    v_mfma_f32_16x16x32_bf16 v[80:83], v[142:145], v[212:215], v[80:83]
    v_cvt_pk_bf16_f32 v40, v40, v41
    v_cvt_pk_bf16_f32 v41, v42, v43
    v_mfma_f32_16x16x32_bf16 v[84:87], v[146:149], v[212:215], v[84:87]
    v_cvt_pk_bf16_f32 v42, v44, v45
    v_cvt_pk_bf16_f32 v43, v46, v47
    s_waitcnt lgkmcnt(6)
    v_mfma_f32_16x16x16_bf16 v[64:67], v[150:151], v[162:163], v[64:67]
    ds_read_b64_tr_b16 v[212:213], v118 offset:20992
    v_mfma_f32_16x16x16_bf16 v[68:71], v[152:153], v[162:163], v[68:71]
    ds_read_b64_tr_b16 v[214:215], v118 offset:21248
    v_mfma_f32_16x16x16_bf16 v[72:75], v[154:155], v[162:163], v[72:75]
    buffer_store_dwordx4 v[40:43], v8, s[44:47], s96 offen offset:0 sc1
    v_mfma_f32_16x16x16_bf16 v[76:79], v[156:157], v[162:163], v[76:79]
    v_cvt_pk_bf16_f32 v44, v48, v49
    v_cvt_pk_bf16_f32 v45, v50, v51
    v_mfma_f32_16x16x16_bf16 v[80:83], v[158:159], v[162:163], v[80:83]
    v_cvt_pk_bf16_f32 v46, v52, v53
    v_cvt_pk_bf16_f32 v47, v54, v55
    v_mfma_f32_16x16x16_bf16 v[84:87], v[160:161], v[162:163], v[84:87]
    buffer_store_dwordx4 v[44:47], v8, s[44:47], s96 offen offset:1024 sc1
    s_waitcnt lgkmcnt(6)
    v_mfma_f32_16x16x32_bf16 v[64:67], v[176:179], v[200:203], v[64:67]
    ds_read_b64_tr_b16 v[162:163], v118 offset:21504
    v_cvt_pk_bf16_f32 v48, v56, v57
    v_mfma_f32_16x16x32_bf16 v[68:71], v[180:183], v[200:203], v[68:71]
    v_cvt_pk_bf16_f32 v49, v58, v59
    v_cvt_pk_bf16_f32 v50, v60, v61
    v_mfma_f32_16x16x32_bf16 v[72:75], v[184:187], v[200:203], v[72:75]
    v_cvt_pk_bf16_f32 v51, v62, v63
    v_mfma_f32_16x16x32_bf16 v[76:79], v[188:191], v[200:203], v[76:79]
    buffer_store_dwordx4 v[48:51], v8, s[44:47], s96 offen offset:2048 sc1
    v_mfma_f32_16x16x32_bf16 v[80:83], v[192:195], v[200:203], v[80:83]
    v_mfma_f32_16x16x32_bf16 v[84:87], v[196:199], v[200:203], v[84:87]
    s_waitcnt lgkmcnt(5)
    v_mfma_f32_16x16x32_bf16 v[64:67], v[216:219], v[204:207], v[64:67]
    ds_read_b64_tr_b16 v[200:201], v118 offset:19456
    v_mfma_f32_16x16x32_bf16 v[68:71], v[220:223], v[204:207], v[68:71]
    ds_read_b64_tr_b16 v[202:203], v118 offset:19712
    v_mfma_f32_16x16x32_bf16 v[72:75], v[224:227], v[204:207], v[72:75]
    v_mfma_f32_16x16x32_bf16 v[76:79], v[228:231], v[204:207], v[76:79]
    v_mfma_f32_16x16x32_bf16 v[80:83], v[232:235], v[204:207], v[80:83]
    v_mfma_f32_16x16x32_bf16 v[84:87], v[236:239], v[204:207], v[84:87]
    s_waitcnt lgkmcnt(5)
    v_mfma_f32_16x16x32_bf16 v[64:67], v[240:243], v[208:211], v[64:67]
    ds_read_b64_tr_b16 v[204:205], v118 offset:19968
    v_mfma_f32_16x16x32_bf16 v[68:71], v[244:247], v[208:211], v[68:71]
    ds_read_b64_tr_b16 v[206:207], v118 offset:20224
    v_mfma_f32_16x16x32_bf16 v[72:75], v[248:251], v[208:211], v[72:75]
    v_mfma_f32_16x16x32_bf16 v[76:79], v[252:255], v[208:211], v[76:79]
    v_mfma_f32_16x16x32_bf16 v[80:83], v[164:167], v[208:211], v[80:83]
    v_mfma_f32_16x16x32_bf16 v[84:87], v[168:171], v[208:211], v[84:87]
    s_waitcnt lgkmcnt(5)
    v_mfma_f32_16x16x32_bf16 v[88:91], v[126:129], v[212:215], v[88:91]
    ds_read_b64_tr_b16 v[208:209], v118 offset:20480
    v_mfma_f32_16x16x32_bf16 v[92:95], v[130:133], v[212:215], v[92:95]
    ds_read_b64_tr_b16 v[210:211], v118 offset:20736
    v_mfma_f32_16x16x32_bf16 v[96:99], v[134:137], v[212:215], v[96:99]
    v_mfma_f32_16x16x32_bf16 v[100:103], v[138:141], v[212:215], v[100:103]
    v_mfma_f32_16x16x32_bf16 v[104:107], v[142:145], v[212:215], v[104:107]
    v_cvt_pk_bf16_f32 v64, v64, v65
    v_cvt_pk_bf16_f32 v65, v66, v67
    v_mfma_f32_16x16x32_bf16 v[108:111], v[146:149], v[212:215], v[108:111]
    v_cvt_pk_bf16_f32 v66, v68, v69
    v_cvt_pk_bf16_f32 v67, v70, v71
    s_waitcnt lgkmcnt(6)
    v_mfma_f32_16x16x16_bf16 v[88:91], v[150:151], v[162:163], v[88:91]
    ds_read_b64_tr_b16 v[212:213], v118 offset:30720
    v_mfma_f32_16x16x16_bf16 v[92:95], v[152:153], v[162:163], v[92:95]
    ds_read_b64_tr_b16 v[214:215], v118 offset:30976
    v_mfma_f32_16x16x16_bf16 v[96:99], v[154:155], v[162:163], v[96:99]
    buffer_store_dwordx4 v[64:67], v8, s[44:47], s97 offen offset:0 sc1
    v_mfma_f32_16x16x16_bf16 v[100:103], v[156:157], v[162:163], v[100:103]
    v_cvt_pk_bf16_f32 v68, v72, v73
    v_cvt_pk_bf16_f32 v69, v74, v75
    v_mfma_f32_16x16x16_bf16 v[104:107], v[158:159], v[162:163], v[104:107]
    v_cvt_pk_bf16_f32 v70, v76, v77
    v_cvt_pk_bf16_f32 v71, v78, v79
    v_mfma_f32_16x16x16_bf16 v[108:111], v[160:161], v[162:163], v[108:111]
    buffer_store_dwordx4 v[68:71], v8, s[44:47], s97 offen offset:1024 sc1
    s_waitcnt lgkmcnt(6)
    v_mfma_f32_16x16x32_bf16 v[88:91], v[176:179], v[200:203], v[88:91]
    ds_read_b64_tr_b16 v[162:163], v118 offset:31232
    v_cvt_pk_bf16_f32 v72, v80, v81
    v_mfma_f32_16x16x32_bf16 v[92:95], v[180:183], v[200:203], v[92:95]
    v_cvt_pk_bf16_f32 v73, v82, v83
    v_cvt_pk_bf16_f32 v74, v84, v85
    v_mfma_f32_16x16x32_bf16 v[96:99], v[184:187], v[200:203], v[96:99]
    v_cvt_pk_bf16_f32 v75, v86, v87
    v_mfma_f32_16x16x32_bf16 v[100:103], v[188:191], v[200:203], v[100:103]
    buffer_store_dwordx4 v[72:75], v8, s[44:47], s97 offen offset:2048 sc1
    v_mfma_f32_16x16x32_bf16 v[104:107], v[192:195], v[200:203], v[104:107]
    v_mfma_f32_16x16x32_bf16 v[108:111], v[196:199], v[200:203], v[108:111]
    s_waitcnt lgkmcnt(5)
    v_mfma_f32_16x16x32_bf16 v[88:91], v[216:219], v[204:207], v[88:91]
    ds_read_b64_tr_b16 v[200:201], v118 offset:29184
    v_mfma_f32_16x16x32_bf16 v[92:95], v[220:223], v[204:207], v[92:95]
    ds_read_b64_tr_b16 v[202:203], v118 offset:29440
    v_mfma_f32_16x16x32_bf16 v[96:99], v[224:227], v[204:207], v[96:99]
    v_mfma_f32_16x16x32_bf16 v[100:103], v[228:231], v[204:207], v[100:103]
    v_mfma_f32_16x16x32_bf16 v[104:107], v[232:235], v[204:207], v[104:107]
    v_mfma_f32_16x16x32_bf16 v[108:111], v[236:239], v[204:207], v[108:111]
    s_waitcnt lgkmcnt(5)
    v_mfma_f32_16x16x32_bf16 v[88:91], v[240:243], v[208:211], v[88:91]
    ds_read_b64_tr_b16 v[204:205], v118 offset:29696
    v_mfma_f32_16x16x32_bf16 v[92:95], v[244:247], v[208:211], v[92:95]
    ds_read_b64_tr_b16 v[206:207], v118 offset:29952
    v_mfma_f32_16x16x32_bf16 v[96:99], v[248:251], v[208:211], v[96:99]
    v_mfma_f32_16x16x32_bf16 v[100:103], v[252:255], v[208:211], v[100:103]
    v_mfma_f32_16x16x32_bf16 v[104:107], v[164:167], v[208:211], v[104:107]
    v_mfma_f32_16x16x32_bf16 v[108:111], v[168:171], v[208:211], v[108:111]
    s_waitcnt lgkmcnt(5)
    v_mfma_f32_16x16x32_bf16 v[16:19], v[126:129], v[212:215], v[16:19]
    ds_read_b64_tr_b16 v[208:209], v118 offset:30208
    v_mfma_f32_16x16x32_bf16 v[20:23], v[130:133], v[212:215], v[20:23]
    ds_read_b64_tr_b16 v[210:211], v118 offset:30464
    v_mfma_f32_16x16x32_bf16 v[24:27], v[134:137], v[212:215], v[24:27]
    v_mfma_f32_16x16x32_bf16 v[28:31], v[138:141], v[212:215], v[28:31]
    v_mfma_f32_16x16x32_bf16 v[32:35], v[142:145], v[212:215], v[32:35]
    v_cvt_pk_bf16_f32 v88, v88, v89
    v_cvt_pk_bf16_f32 v89, v90, v91
    v_mfma_f32_16x16x32_bf16 v[36:39], v[146:149], v[212:215], v[36:39]
    v_cvt_pk_bf16_f32 v90, v92, v93
    v_cvt_pk_bf16_f32 v91, v94, v95
    s_waitcnt lgkmcnt(6)
    v_mfma_f32_16x16x16_bf16 v[16:19], v[150:151], v[162:163], v[16:19]
    buffer_store_dwordx4 v[88:91], v8, s[44:47], s98 offen offset:0 sc1
    v_mfma_f32_16x16x16_bf16 v[20:23], v[152:153], v[162:163], v[20:23]
    v_cvt_pk_bf16_f32 v92, v96, v97
    v_cvt_pk_bf16_f32 v93, v98, v99
    v_mfma_f32_16x16x16_bf16 v[24:27], v[154:155], v[162:163], v[24:27]
    v_cvt_pk_bf16_f32 v94, v100, v101
    v_cvt_pk_bf16_f32 v95, v102, v103
    v_mfma_f32_16x16x16_bf16 v[28:31], v[156:157], v[162:163], v[28:31]
    buffer_store_dwordx4 v[92:95], v8, s[44:47], s98 offen offset:1024 sc1
    v_mfma_f32_16x16x16_bf16 v[32:35], v[158:159], v[162:163], v[32:35]
    v_cvt_pk_bf16_f32 v96, v104, v105
    v_cvt_pk_bf16_f32 v97, v106, v107
    v_mfma_f32_16x16x16_bf16 v[36:39], v[160:161], v[162:163], v[36:39]
    v_cvt_pk_bf16_f32 v98, v108, v109
    v_cvt_pk_bf16_f32 v99, v110, v111
    s_waitcnt lgkmcnt(4)
    v_mfma_f32_16x16x32_bf16 v[16:19], v[176:179], v[200:203], v[16:19]
    buffer_store_dwordx4 v[96:99], v8, s[44:47], s98 offen offset:2048 sc1
    v_mfma_f32_16x16x32_bf16 v[20:23], v[180:183], v[200:203], v[20:23]
    v_mfma_f32_16x16x32_bf16 v[24:27], v[184:187], v[200:203], v[24:27]
    v_mfma_f32_16x16x32_bf16 v[28:31], v[188:191], v[200:203], v[28:31]
    v_mfma_f32_16x16x32_bf16 v[32:35], v[192:195], v[200:203], v[32:35]
    v_mfma_f32_16x16x32_bf16 v[36:39], v[196:199], v[200:203], v[36:39]
    s_waitcnt lgkmcnt(2)
    v_mfma_f32_16x16x32_bf16 v[16:19], v[216:219], v[204:207], v[16:19]
    v_mfma_f32_16x16x32_bf16 v[20:23], v[220:223], v[204:207], v[20:23]
    v_mfma_f32_16x16x32_bf16 v[24:27], v[224:227], v[204:207], v[24:27]
    v_mfma_f32_16x16x32_bf16 v[28:31], v[228:231], v[204:207], v[28:31]
    v_mfma_f32_16x16x32_bf16 v[32:35], v[232:235], v[204:207], v[32:35]
    v_mfma_f32_16x16x32_bf16 v[36:39], v[236:239], v[204:207], v[36:39]
    s_waitcnt lgkmcnt(0)
    v_mfma_f32_16x16x32_bf16 v[16:19], v[240:243], v[208:211], v[16:19]
    v_mfma_f32_16x16x32_bf16 v[20:23], v[244:247], v[208:211], v[20:23]
    v_mfma_f32_16x16x32_bf16 v[24:27], v[248:251], v[208:211], v[24:27]
    v_mfma_f32_16x16x32_bf16 v[28:31], v[252:255], v[208:211], v[28:31]
    v_mfma_f32_16x16x32_bf16 v[32:35], v[164:167], v[208:211], v[32:35]
    v_mfma_f32_16x16x32_bf16 v[36:39], v[168:171], v[208:211], v[36:39]
    s_load_dwordx4 s[56:59], s[50:51], 0 glc
    s_mov_b64 exec, 1
    s_waitcnt vmcnt(6)
    buffer_store_dword v9, off, s[44:47], s53 sc1
    s_waitcnt vmcnt(4)
    buffer_store_dword v9, off, s[44:47], s54 sc1
    s_waitcnt vmcnt(2)
    buffer_store_dword v9, off, s[44:47], s55 sc1
    s_mov_b64 exec, -1
    s_mov_b32 s48, 65536
    s_mov_b32 s49, 0
L_x_poll:
    s_waitcnt lgkmcnt(0)
    s_bitcmp1_b32 s49, 0
    s_cbranch_scc1 L_x_no0
    s_cmp_lg_u32 s56, s7
    s_cbranch_scc1 L_x_no0
    s_add_u32 s3, s63, 0
    buffer_load_dwordx4 v[176:179], v8, s[44:47], s3 offen offset:0 sc1
    buffer_load_dwordx4 v[180:183], v8, s[44:47], s3 offen offset:1024 sc1
    buffer_load_dwordx4 v[184:187], v8, s[44:47], s3 offen offset:2048 sc1
    s_bitset1_b32 s49, 0
    s_mov_b32 s60, 0
L_x_no0:
    s_bitcmp1_b32 s49, 1
    s_cbranch_scc1 L_x_no1
    s_cmp_lg_u32 s57, s7
    s_cbranch_scc1 L_x_no1
    s_add_u32 s3, s63, 12288
    buffer_load_dwordx4 v[188:191], v8, s[44:47], s3 offen offset:0 sc1
    buffer_load_dwordx4 v[192:195], v8, s[44:47], s3 offen offset:1024 sc1
    buffer_load_dwordx4 v[196:199], v8, s[44:47], s3 offen offset:2048 sc1
    s_bitset1_b32 s49, 1
    s_mov_b32 s60, 1
L_x_no1:
    s_bitcmp1_b32 s49, 2
    s_cbranch_scc1 L_x_no2
    s_cmp_lg_u32 s58, s7
    s_cbranch_scc1 L_x_no2
    s_add_u32 s3, s63, 24576
    buffer_load_dwordx4 v[200:203], v8, s[44:47], s3 offen offset:0 sc1
    buffer_load_dwordx4 v[204:207], v8, s[44:47], s3 offen offset:1024 sc1
    buffer_load_dwordx4 v[208:211], v8, s[44:47], s3 offen offset:2048 sc1
    s_bitset1_b32 s49, 2
    s_mov_b32 s60, 2
L_x_no2:
    s_cmp_eq_u32 s49, 7
    s_cbranch_scc1 L_x_all
    s_sub_u32 s48, s48, 1
    s_cmp_eq_u32 s48, 0
    s_cbranch_scc1 L_x_all
    s_load_dwordx4 s[56:59], s[50:51], 0 glc
    s_branch L_x_poll
L_x_all:
    s_mov_b32 s96, 0x3f80
    s_mov_b32 s97, 0x3f800000
    s_cmp_eq_u32 s60, 2
    s_cbranch_scc1 L_x_l2
    s_waitcnt vmcnt(0)
L_x_l2:
    s_waitcnt vmcnt(3)
    v_dot2c_f32_bf16 v16, s96, v176
    v_dot2c_f32_bf16 v17, s97, v176
    v_dot2c_f32_bf16 v18, s96, v177
    v_dot2c_f32_bf16 v19, s97, v177
    v_dot2c_f32_bf16 v20, s96, v178
    v_dot2c_f32_bf16 v21, s97, v178
    v_dot2c_f32_bf16 v22, s96, v179
    v_dot2c_f32_bf16 v23, s97, v179
    v_dot2c_f32_bf16 v24, s96, v180
    v_dot2c_f32_bf16 v25, s97, v180
    v_dot2c_f32_bf16 v26, s96, v181
    v_dot2c_f32_bf16 v27, s97, v181
    v_dot2c_f32_bf16 v28, s96, v182
    v_dot2c_f32_bf16 v29, s97, v182
    v_dot2c_f32_bf16 v30, s96, v183
    v_dot2c_f32_bf16 v31, s97, v183
    v_dot2c_f32_bf16 v32, s96, v184
    v_dot2c_f32_bf16 v33, s97, v184
    v_dot2c_f32_bf16 v34, s96, v185
    v_dot2c_f32_bf16 v35, s97, v185
    v_dot2c_f32_bf16 v36, s96, v186
    v_dot2c_f32_bf16 v37, s97, v186
    v_dot2c_f32_bf16 v38, s96, v187
    v_dot2c_f32_bf16 v39, s97, v187
    v_dot2c_f32_bf16 v16, s96, v188
    v_dot2c_f32_bf16 v17, s97, v188
    v_dot2c_f32_bf16 v18, s96, v189
    v_dot2c_f32_bf16 v19, s97, v189
    v_dot2c_f32_bf16 v20, s96, v190
    v_dot2c_f32_bf16 v21, s97, v190
    v_dot2c_f32_bf16 v22, s96, v191
    v_dot2c_f32_bf16 v23, s97, v191
    v_dot2c_f32_bf16 v24, s96, v192
    v_dot2c_f32_bf16 v25, s97, v192
    v_dot2c_f32_bf16 v26, s96, v193
    v_dot2c_f32_bf16 v27, s97, v193
    v_dot2c_f32_bf16 v28, s96, v194
    v_dot2c_f32_bf16 v29, s97, v194
    v_dot2c_f32_bf16 v30, s96, v195
    v_dot2c_f32_bf16 v31, s97, v195
    v_dot2c_f32_bf16 v32, s96, v196
    v_dot2c_f32_bf16 v33, s97, v196
    v_dot2c_f32_bf16 v34, s96, v197
    v_dot2c_f32_bf16 v35, s97, v197
    v_dot2c_f32_bf16 v36, s96, v198
    v_dot2c_f32_bf16 v37, s97, v198
    v_dot2c_f32_bf16 v38, s96, v199
    v_dot2c_f32_bf16 v39, s97, v199
    s_waitcnt vmcnt(0) lgkmcnt(0)
    v_dot2c_f32_bf16 v16, s96, v200
    v_dot2c_f32_bf16 v17, s97, v200
    v_dot2c_f32_bf16 v18, s96, v201
    v_dot2c_f32_bf16 v19, s97, v201
    v_dot2c_f32_bf16 v20, s96, v202
    v_dot2c_f32_bf16 v21, s97, v202
    v_dot2c_f32_bf16 v22, s96, v203
    v_dot2c_f32_bf16 v23, s97, v203
    v_dot2c_f32_bf16 v24, s96, v204
    v_dot2c_f32_bf16 v25, s97, v204
    v_dot2c_f32_bf16 v26, s96, v205
    v_dot2c_f32_bf16 v27, s97, v205
    v_dot2c_f32_bf16 v28, s96, v206
    v_dot2c_f32_bf16 v29, s97, v206
    v_dot2c_f32_bf16 v30, s96, v207
    v_dot2c_f32_bf16 v31, s97, v207
    v_dot2c_f32_bf16 v32, s96, v208
    v_dot2c_f32_bf16 v33, s97, v208
    v_dot2c_f32_bf16 v34, s96, v209
    v_dot2c_f32_bf16 v35, s97, v209
    v_dot2c_f32_bf16 v36, s96, v210
    v_dot2c_f32_bf16 v37, s97, v210
    v_dot2c_f32_bf16 v38, s96, v211
    v_dot2c_f32_bf16 v39, s97, v211
    v_cvt_pk_bf16_f32 v216, v16, v17
    v_cvt_pk_bf16_f32 v217, v18, v19
    v_cvt_pk_bf16_f32 v218, v20, v21
    v_cvt_pk_bf16_f32 v219, v22, v23
    ds_write_b128 v7, v[216:219] offset:0
    v_cvt_pk_bf16_f32 v220, v24, v25
    v_cvt_pk_bf16_f32 v221, v26, v27
    v_cvt_pk_bf16_f32 v222, v28, v29
    v_cvt_pk_bf16_f32 v223, v30, v31
    ds_write_b128 v7, v[220:223] offset:64
    v_cvt_pk_bf16_f32 v224, v32, v33
    v_cvt_pk_bf16_f32 v225, v34, v35
    v_cvt_pk_bf16_f32 v226, v36, v37
    v_cvt_pk_bf16_f32 v227, v38, v39
    ds_write_b128 v7, v[224:227] offset:128
    ds_read_b128 v[228:231], v122
    ds_read_b128 v[232:235], v123
    ds_read_b128 v[236:239], v124
    s_waitcnt lgkmcnt(2)
    buffer_store_dwordx4 v[228:231], v12, s[40:43], s62 offen sc1
    s_waitcnt lgkmcnt(1)
    buffer_store_dwordx4 v[232:235], v13, s[40:43], s62 offen sc1
    s_waitcnt lgkmcnt(0)
    buffer_store_dwordx4 v[236:239], v14, s[40:43], s62 offen sc1
    s_branch L_fin
L_aux:
    s_and_b32 s54, s6, 3
    s_and_b32 s3, s6, 28
    s_and_b32 s55, s6, 16
    s_add_u32 s3, s3, s55
    s_lshr_b64 s[48:49], s[100:101], s3
    s_and_b32 s55, s48, 15
    s_lshr_b32 s3, s5, 1
    s_mul_i32 s3, s3, 12
    s_add_u32 s55, s55, s3
    s_sub_u32 s53, s4, 4
    s_lshr_b32 s58, s5, 1
    s_mul_i32 s60, s6, 43
    s_lshr_b32 s60, s60, 7
    s_mul_i32 s3, s60, 3
    s_sub_u32 s59, s6, s3
    s_and_b32 s3, s5, 1
    s_lshl_b32 s3, s3, 3
    s_add_u32 s60, s60, s3
    v_lshlrev_b32 v10, 4, v0
    v_lshrrev_b32 v1, 4, v0
    v_bfe_u32 v2, v0, 1, 3
    v_and_b32 v3, 1, v0
    v_add_u32 v4, 0, v1
    v_xor_b32 v5, v2, v4
    v_lshlrev_b32 v4, 12, v4
    v_lshl_add_u32 v4, v5, 5, v4
    v_lshl_add_u32 v11, v3, 4, v4
    v_subrev_u32 v11, 0, v11
    v_add_u32 v4, 4, v1
    v_xor_b32 v5, v2, v4
    v_lshlrev_b32 v4, 12, v4
    v_lshl_add_u32 v4, v5, 5, v4
    v_lshl_add_u32 v12, v3, 4, v4
    v_subrev_u32 v12, 1024, v12
    s_cmp_ge_u32 s53, 2
    s_cselect_b32 s3, 2147418112, 0
    v_add_u32 v4, 0, v0
    v_mul_u32_u24 v5, 43691, v4
    v_lshrrev_b32 v5, 20, v5
    v_mul_u32_u24 v7, 24, v5
    v_sub_u32 v6, v4, v7
    v_bfe_u32 v7, v5, 1, 1
    v_lshlrev_b32 v7, 2, v7
    v_xor_b32 v6, v6, v7
    v_mul_u32_u24 v5, 1152, v5
    v_lshl_add_u32 v15, v6, 4, v5
    v_subrev_u32 v15, 0, v15
    v_or_b32 v56, s3, v15
    v_add_u32 v4, 64, v0
    v_mul_u32_u24 v5, 43691, v4
    v_lshrrev_b32 v5, 20, v5
    v_mul_u32_u24 v7, 24, v5
    v_sub_u32 v6, v4, v7
    v_bfe_u32 v7, v5, 1, 1
    v_lshlrev_b32 v7, 2, v7
    v_xor_b32 v6, v6, v7
    v_mul_u32_u24 v5, 1152, v5
    v_lshl_add_u32 v16, v6, 4, v5
    v_subrev_u32 v16, 1024, v16
    v_or_b32 v57, s3, v16
    v_add_u32 v4, 128, v0
    v_mul_u32_u24 v5, 43691, v4
    v_lshrrev_b32 v5, 20, v5
    v_mul_u32_u24 v7, 24, v5
    v_sub_u32 v6, v4, v7
    v_bfe_u32 v7, v5, 1, 1
    v_lshlrev_b32 v7, 2, v7
    v_xor_b32 v6, v6, v7
    v_mul_u32_u24 v5, 1152, v5
    v_lshl_add_u32 v17, v6, 4, v5
    v_subrev_u32 v17, 2048, v17
    v_or_b32 v58, s3, v17
    s_mul_i32 s8, s58, 144
    s_add_u32 s8, s8, s53
    s_mul_i32 s8, s8, 9216
    s_mul_i32 s3, s59, 3072
    s_add_u32 s8, s8, s3
    s_add_u32 s8, s8, 4194304
    s_mul_i32 s9, s58, 1152
    s_lshl_b32 s3, s53, 3
    s_add_u32 s9, s9, s3
    s_lshl_b32 s9, s9, 12
    s_lshl_b32 s3, s60, 8
    s_add_u32 s9, s9, s3
    s_mul_i32 s61, s53, 3136
    s_mul_i32 s62, s53, 3072
    s_lshl_b32 s63, s53, 11
    s_lshl_b32 s3, s53, 1
    s_add_u32 s3, s3, 0
    s_cmp_ge_u32 s3, 3
    s_cselect_b32 s48, 3072, 0
    s_lshl_b32 s3, s3, 10
    s_add_u32 s3, s3, s48
    s_add_u32 s3, s3, 147968
    v_add_u32 v60, s3, v10
    s_lshl_b32 s3, s53, 1
    s_add_u32 s3, s3, 1
    s_cmp_ge_u32 s3, 3
    s_cselect_b32 s48, 3072, 0
    s_lshl_b32 s3, s3, 10
    s_add_u32 s3, s3, s48
    s_add_u32 s3, s3, 147968
    v_add_u32 v61, s3, v10
    v_mov_b32 v64, 0xbdd2d3e8
    v_mov_b32 v66, 0xc0135761
    v_mov_b32 v65, 0xbdd2d3e8
    v_mov_b32 v67, 0xc0135761
    v_mul_u32_u24 v62, 9216, v1
    v_and_b32 v63, 15, v0
    v_lshl_add_u32 v62, v63, 4, v62
    s_mul_i32 s96, s55, 3
    s_add_u32 s96, s96, s53
    s_mul_i32 s96, s96, 36864
    s_mul_i32 s3, s54, 2304
    s_add_u32 s96, s96, s3
    s_add_u32 s96, s96, 4196352
    s_mul_i32 s3, s58, 3
    s_add_u32 s3, s3, s59
    s_lshl_b32 s3, s3, 4
    s_add_u32 s3, s3, s60
    s_lshl_b32 s3, s3, 9
    s_add_u32 s3, s3, 655360
    s_add_u32 s98, s44, s3
    s_addc_u32 s99, s45, 0
    s_lshl_b32 s3, s53, 7
    s_load_dword s30, s[98:99], s3 glc
    v_min_u32 v68, 2, v1
    v_lshlrev_b32 v68, 12, v68
    v_lshl_add_u32 v68, v63, 7, v68
    s_lshl_b32 s97, s6, 2
    s_add_u32 s97, s97, s53
    s_mul_i32 s97, s97, 3
    s_add_u32 s97, s97, 512
    s_mul_i32 s10, s58, 4718592
    s_and_b32 s3, s5, 1
    s_lshl_b32 s3, s3, 11
    s_add_u32 s10, s10, s3
    s_cmp_eq_u32 s4, 7
    s_cbranch_scc1 L_aux7
    s_lshl_b32 s3, s53, 8
    v_add_u32 v1, s3, v0
    v_add_u32 v2, 0, v1
    v_mul_u32_u24 v3, 87382, v2
    v_lshrrev_b32 v3, 20, v3
    v_mul_u32_u24 v5, 12, v3
    v_sub_u32 v4, v2, v5
    v_bfe_u32 v5, v3, 3, 1
    v_lshlrev_b32 v5, 1, v5
    v_xor_b32 v4, v4, v5
    v_mul_u32_u24 v3, 9216, v3
    v_lshl_add_u32 v46, v4, 4, v3
    v_subrev_u32 v46, 0, v46
    v_add_u32 v2, 64, v1
    v_mul_u32_u24 v3, 87382, v2
    v_lshrrev_b32 v3, 20, v3
    v_mul_u32_u24 v5, 12, v3
    v_sub_u32 v4, v2, v5
    v_bfe_u32 v5, v3, 3, 1
    v_lshlrev_b32 v5, 1, v5
    v_xor_b32 v4, v4, v5
    v_mul_u32_u24 v3, 9216, v3
    v_lshl_add_u32 v47, v4, 4, v3
    v_subrev_u32 v47, 1024, v47
    v_add_u32 v2, 128, v1
    v_mul_u32_u24 v3, 87382, v2
    v_lshrrev_b32 v3, 20, v3
    v_mul_u32_u24 v5, 12, v3
    v_sub_u32 v4, v2, v5
    v_bfe_u32 v5, v3, 3, 1
    v_lshlrev_b32 v5, 1, v5
    v_xor_b32 v4, v4, v5
    v_mul_u32_u24 v3, 9216, v3
    v_lshl_add_u32 v48, v4, 4, v3
    v_subrev_u32 v48, 2048, v48
    v_add_u32 v2, 192, v1
    v_mul_u32_u24 v3, 87382, v2
    v_lshrrev_b32 v3, 20, v3
    v_mul_u32_u24 v5, 12, v3
    v_sub_u32 v4, v2, v5
    v_bfe_u32 v5, v3, 3, 1
    v_lshlrev_b32 v5, 1, v5
    v_xor_b32 v4, v4, v5
    v_mul_u32_u24 v3, 9216, v3
    v_lshl_add_u32 v49, v4, 4, v3
    v_subrev_u32 v49, 3072, v49
    s_mul_i32 s12, s55, 192
    s_lshl_b32 s14, s53, 12
    s_add_u32 s14, s14, 18432
    s_mul_i32 s13, s54, 2304
    s_add_u32 s13, s13, 1048576
    s_mul_i32 s15, s53, 6144
    s_and_b32 s28, s5, 7
    s_lshl_b32 s28, s28, 2
    s_lshr_b32 s3, s6, 2
    s_add_u32 s3, s3, s54
    s_and_b32 s3, s3, 3
    s_mov_b32 s16, 171051040
    s_mov_b32 s17, 348429512
    s_mov_b32 s18, 586629547
    s_mov_b32 s19, 764071508
    s_mov_b32 s36, 1002271543
    s_mov_b32 s37, 1022
    s_cmp_eq_u32 s3, 1
    s_cselect_b32 s16, 137529376, s16
    s_cselect_b32 s17, 446962982, s17
    s_cselect_b32 s18, 553171339, s18
    s_cselect_b32 s19, 862604978, s19
    s_cselect_b32 s36, 968813335, s36
    s_cselect_b32 s37, 1022, s37
    s_cmp_eq_u32 s3, 2
    s_cselect_b32 s16, 140609568, s16
    s_cselect_b32 s17, 378808549, s17
    s_cselect_b32 s18, 556250510, s18
    s_cselect_b32 s19, 794450545, s19
    s_cselect_b32 s36, 971892506, s36
    s_cselect_b32 s37, 1021, s37
    s_cmp_eq_u32 s3, 3
    s_cselect_b32 s16, 239175712, s16
    s_cselect_b32 s17, 345350341, s17
    s_cselect_b32 s18, 654783980, s18
    s_cselect_b32 s19, 760992337, s19
    s_cselect_b32 s36, 1070425976, s36
    s_cselect_b32 s37, 989, s37
    s_mul_i32 s3, s53, 384
    v_add_u32 v1, s3, v0
    v_add_u32 v2, 0, v1
    v_mul_u32_u24 v3, 7282, v2
    v_lshrrev_b32 v3, 20, v3
    v_mul_u32_u24 v5, 144, v3
    v_sub_u32 v4, v2, v5
    v_mul_u32_u24 v3, 9216, v3
    v_lshl_add_u32 v40, v4, 4, v3
    v_subrev_u32 v40, 0, v40
    v_add_u32 v2, 64, v1
    v_mul_u32_u24 v3, 7282, v2
    v_lshrrev_b32 v3, 20, v3
    v_mul_u32_u24 v5, 144, v3
    v_sub_u32 v4, v2, v5
    v_mul_u32_u24 v3, 9216, v3
    v_lshl_add_u32 v41, v4, 4, v3
    v_subrev_u32 v41, 1024, v41
    v_add_u32 v2, 128, v1
    v_mul_u32_u24 v3, 7282, v2
    v_lshrrev_b32 v3, 20, v3
    v_mul_u32_u24 v5, 144, v3
    v_sub_u32 v4, v2, v5
    v_mul_u32_u24 v3, 9216, v3
    v_lshl_add_u32 v42, v4, 4, v3
    v_subrev_u32 v42, 2048, v42
    v_add_u32 v2, 192, v1
    v_mul_u32_u24 v3, 7282, v2
    v_lshrrev_b32 v3, 20, v3
    v_mul_u32_u24 v5, 144, v3
    v_sub_u32 v4, v2, v5
    v_mul_u32_u24 v3, 9216, v3
    v_lshl_add_u32 v43, v4, 4, v3
    v_subrev_u32 v43, 3072, v43
    v_add_u32 v2, 256, v1
    v_mul_u32_u24 v3, 7282, v2
    v_lshrrev_b32 v3, 20, v3
    v_mul_u32_u24 v5, 144, v3
    v_sub_u32 v4, v2, v5
    v_mul_u32_u24 v3, 9216, v3
    v_lshl_add_u32 v44, v4, 4, v3
    v_subrev_u32 v44, 0, v44
    v_add_u32 v2, 320, v1
    v_mul_u32_u24 v3, 7282, v2
    v_lshrrev_b32 v3, 20, v3
    v_mul_u32_u24 v5, 144, v3
    v_sub_u32 v4, v2, v5
    v_mul_u32_u24 v3, 9216, v3
    v_lshl_add_u32 v45, v4, 4, v3
    v_subrev_u32 v45, 1024, v45
    s_barrier
    s_bfe_u32 s3, s16, 327680
    s_add_u32 s3, s3, s28
    s_and_b32 s3, s3, 31
    s_mul_i32 s3, s3, 589824
    s_add_u32 m0, s14, 0
    s_add_u32 s3, s3, s12
    buffer_load_dwordx4 v46, s[24:27], s3 offen offset:0 lds
    buffer_load_dwordx4 v47, s[24:27], s3 offen offset:1024 lds
    buffer_load_dwordx4 v48, s[24:27], s3 offen offset:2048 lds
    buffer_load_dwordx4 v49, s[24:27], s3 offen offset:3072 lds
    s_bfe_u32 s3, s16, 327685
    s_add_u32 s3, s3, s28
    s_and_b32 s3, s3, 31
    s_mul_i32 s3, s3, 589824
    s_add_u32 m0, s14, 30720
    s_add_u32 s3, s3, s12
    buffer_load_dwordx4 v46, s[24:27], s3 offen offset:0 lds
    buffer_load_dwordx4 v47, s[24:27], s3 offen offset:1024 lds
    buffer_load_dwordx4 v48, s[24:27], s3 offen offset:2048 lds
    buffer_load_dwordx4 v49, s[24:27], s3 offen offset:3072 lds
    s_bfe_u32 s3, s16, 327690
    s_add_u32 s3, s3, s28
    s_and_b32 s3, s3, 31
    s_mul_i32 s3, s3, 589824
    s_add_u32 m0, s14, 61440
    s_add_u32 s3, s3, s12
    buffer_load_dwordx4 v46, s[24:27], s3 offen offset:0 lds
    buffer_load_dwordx4 v47, s[24:27], s3 offen offset:1024 lds
    buffer_load_dwordx4 v48, s[24:27], s3 offen offset:2048 lds
    buffer_load_dwordx4 v49, s[24:27], s3 offen offset:3072 lds
    s_barrier
    s_bfe_u32 s3, s16, 327680
    s_add_u32 s3, s3, s28
    s_and_b32 s3, s3, 31
    s_mul_i32 s3, s3, 73728
    s_add_u32 s3, s3, s13
    s_add_u32 m0, s15, 0
    s_nop 0
    buffer_load_dwordx4 v40, s[44:47], s3 offen offset:0 sc1 lds
    buffer_load_dwordx4 v41, s[44:47], s3 offen offset:1024 sc1 lds
    buffer_load_dwordx4 v42, s[44:47], s3 offen offset:2048 sc1 lds
    buffer_load_dwordx4 v43, s[44:47], s3 offen offset:3072 sc1 lds
    s_add_u32 m0, s15, 4096
    s_nop 0
    buffer_load_dwordx4 v44, s[44:47], s3 offen offset:0 sc1 lds
    buffer_load_dwordx4 v45, s[44:47], s3 offen offset:1024 sc1 lds
    s_bfe_u32 s3, s16, 327685
    s_add_u32 s3, s3, s28
    s_and_b32 s3, s3, 31
    s_mul_i32 s3, s3, 73728
    s_add_u32 s3, s3, s13
    s_add_u32 m0, s15, 30720
    s_nop 0
    buffer_load_dwordx4 v40, s[44:47], s3 offen offset:0 sc1 lds
    buffer_load_dwordx4 v41, s[44:47], s3 offen offset:1024 sc1 lds
    buffer_load_dwordx4 v42, s[44:47], s3 offen offset:2048 sc1 lds
    buffer_load_dwordx4 v43, s[44:47], s3 offen offset:3072 sc1 lds
    s_add_u32 m0, s15, 34816
    s_nop 0
    buffer_load_dwordx4 v44, s[44:47], s3 offen offset:0 sc1 lds
    buffer_load_dwordx4 v45, s[44:47], s3 offen offset:1024 sc1 lds
    s_waitcnt vmcnt(6)
    s_barrier
    s_bfe_u32 s3, s16, 327690
    s_add_u32 s3, s3, s28
    s_and_b32 s3, s3, 31
    s_mul_i32 s3, s3, 73728
    s_add_u32 s3, s3, s13
    s_add_u32 m0, s15, 61440
    s_nop 0
    buffer_load_dwordx4 v40, s[44:47], s3 offen offset:0 sc1 lds
    buffer_load_dwordx4 v41, s[44:47], s3 offen offset:1024 sc1 lds
    buffer_load_dwordx4 v42, s[44:47], s3 offen offset:2048 sc1 lds
    buffer_load_dwordx4 v43, s[44:47], s3 offen offset:3072 sc1 lds
    s_add_u32 m0, s15, 65536
    s_nop 0
    buffer_load_dwordx4 v44, s[44:47], s3 offen offset:0 sc1 lds
    buffer_load_dwordx4 v45, s[44:47], s3 offen offset:1024 sc1 lds
    s_waitcnt vmcnt(6)
    s_barrier
    s_bfe_u32 s3, s16, 327695
    s_add_u32 s3, s3, s28
    s_and_b32 s3, s3, 31
    s_mul_i32 s3, s3, 73728
    s_add_u32 s3, s3, s13
    s_add_u32 m0, s15, 92160
    s_nop 0
    buffer_load_dwordx4 v40, s[44:47], s3 offen offset:0 sc1 lds
    buffer_load_dwordx4 v41, s[44:47], s3 offen offset:1024 sc1 lds
    buffer_load_dwordx4 v42, s[44:47], s3 offen offset:2048 sc1 lds
    buffer_load_dwordx4 v43, s[44:47], s3 offen offset:3072 sc1 lds
    s_add_u32 m0, s15, 96256
    s_nop 0
    buffer_load_dwordx4 v44, s[44:47], s3 offen offset:0 sc1 lds
    buffer_load_dwordx4 v45, s[44:47], s3 offen offset:1024 sc1 lds
    s_bfe_u32 s3, s16, 327695
    s_add_u32 s3, s3, s28
    s_and_b32 s3, s3, 31
    s_mul_i32 s3, s3, 589824
    s_add_u32 m0, s14, 92160
    s_add_u32 s3, s3, s12
    buffer_load_dwordx4 v46, s[24:27], s3 offen offset:0 lds
    buffer_load_dwordx4 v47, s[24:27], s3 offen offset:1024 lds
    buffer_load_dwordx4 v48, s[24:27], s3 offen offset:2048 lds
    buffer_load_dwordx4 v49, s[24:27], s3 offen offset:3072 lds
    s_waitcnt vmcnt(10)
    s_barrier
    s_bfe_u32 s3, s16, 327700
    s_add_u32 s3, s3, s28
    s_and_b32 s3, s3, 31
    s_mul_i32 s3, s3, 73728
    s_add_u32 s3, s3, s13
    s_add_u32 m0, s15, 122880
    s_nop 0
    buffer_load_dwordx4 v40, s[44:47], s3 offen offset:0 sc1 lds
    buffer_load_dwordx4 v41, s[44:47], s3 offen offset:1024 sc1 lds
    buffer_load_dwordx4 v42, s[44:47], s3 offen offset:2048 sc1 lds
    buffer_load_dwordx4 v43, s[44:47], s3 offen offset:3072 sc1 lds
    s_add_u32 m0, s15, 126976
    s_nop 0
    buffer_load_dwordx4 v44, s[44:47], s3 offen offset:0 sc1 lds
    buffer_load_dwordx4 v45, s[44:47], s3 offen offset:1024 sc1 lds
    s_bfe_u32 s3, s16, 327700
    s_add_u32 s3, s3, s28
    s_and_b32 s3, s3, 31
    s_mul_i32 s3, s3, 589824
    s_add_u32 m0, s14, 122880
    s_add_u32 s3, s3, s12
    buffer_load_dwordx4 v46, s[24:27], s3 offen offset:0 lds
    buffer_load_dwordx4 v47, s[24:27], s3 offen offset:1024 lds
    buffer_load_dwordx4 v48, s[24:27], s3 offen offset:2048 lds
    buffer_load_dwordx4 v49, s[24:27], s3 offen offset:3072 lds
    s_waitcnt vmcnt(10)
    s_barrier
    s_bfe_u32 s3, s16, 327705
    s_add_u32 s3, s3, s28
    s_and_b32 s3, s3, 31
    s_mul_i32 s3, s3, 73728
    s_add_u32 s3, s3, s13
    s_add_u32 m0, s15, 0
    s_nop 0
    buffer_load_dwordx4 v40, s[44:47], s3 offen offset:0 sc1 lds
    buffer_load_dwordx4 v41, s[44:47], s3 offen offset:1024 sc1 lds
    buffer_load_dwordx4 v42, s[44:47], s3 offen offset:2048 sc1 lds
    buffer_load_dwordx4 v43, s[44:47], s3 offen offset:3072 sc1 lds
    s_add_u32 m0, s15, 4096
    s_nop 0
    buffer_load_dwordx4 v44, s[44:47], s3 offen offset:0 sc1 lds
    buffer_load_dwordx4 v45, s[44:47], s3 offen offset:1024 sc1 lds
    s_bfe_u32 s3, s16, 327705
    s_add_u32 s3, s3, s28
    s_and_b32 s3, s3, 31
    s_mul_i32 s3, s3, 589824
    s_add_u32 m0, s14, 0
    s_add_u32 s3, s3, s12
    buffer_load_dwordx4 v46, s[24:27], s3 offen offset:0 lds
    buffer_load_dwordx4 v47, s[24:27], s3 offen offset:1024 lds
    buffer_load_dwordx4 v48, s[24:27], s3 offen offset:2048 lds
    buffer_load_dwordx4 v49, s[24:27], s3 offen offset:3072 lds
    s_waitcnt vmcnt(10)
    s_barrier
    s_bfe_u32 s3, s17, 327680
    s_add_u32 s3, s3, s28
    s_and_b32 s3, s3, 31
    s_mul_i32 s3, s3, 73728
    s_add_u32 s3, s3, s13
    s_add_u32 m0, s15, 30720
    s_nop 0
    buffer_load_dwordx4 v40, s[44:47], s3 offen offset:0 sc1 lds
    buffer_load_dwordx4 v41, s[44:47], s3 offen offset:1024 sc1 lds
    buffer_load_dwordx4 v42, s[44:47], s3 offen offset:2048 sc1 lds
    buffer_load_dwordx4 v43, s[44:47], s3 offen offset:3072 sc1 lds
    s_add_u32 m0, s15, 34816
    s_nop 0
    buffer_load_dwordx4 v44, s[44:47], s3 offen offset:0 sc1 lds
    buffer_load_dwordx4 v45, s[44:47], s3 offen offset:1024 sc1 lds
    s_bfe_u32 s3, s17, 327680
    s_add_u32 s3, s3, s28
    s_and_b32 s3, s3, 31
    s_mul_i32 s3, s3, 589824
    s_add_u32 m0, s14, 30720
    s_add_u32 s3, s3, s12
    buffer_load_dwordx4 v46, s[24:27], s3 offen offset:0 lds
    buffer_load_dwordx4 v47, s[24:27], s3 offen offset:1024 lds
    buffer_load_dwordx4 v48, s[24:27], s3 offen offset:2048 lds
    buffer_load_dwordx4 v49, s[24:27], s3 offen offset:3072 lds
    s_waitcnt vmcnt(10)
    s_barrier
    s_bfe_u32 s3, s17, 327685
    s_add_u32 s3, s3, s28
    s_and_b32 s3, s3, 31
    s_mul_i32 s3, s3, 73728
    s_add_u32 s3, s3, s13
    s_add_u32 m0, s15, 61440
    s_nop 0
    buffer_load_dwordx4 v40, s[44:47], s3 offen offset:0 sc1 lds
    buffer_load_dwordx4 v41, s[44:47], s3 offen offset:1024 sc1 lds
    buffer_load_dwordx4 v42, s[44:47], s3 offen offset:2048 sc1 lds
    buffer_load_dwordx4 v43, s[44:47], s3 offen offset:3072 sc1 lds
    s_add_u32 m0, s15, 65536
    s_nop 0
    buffer_load_dwordx4 v44, s[44:47], s3 offen offset:0 sc1 lds
    buffer_load_dwordx4 v45, s[44:47], s3 offen offset:1024 sc1 lds
    s_bfe_u32 s3, s17, 327685
    s_add_u32 s3, s3, s28
    s_and_b32 s3, s3, 31
    s_mul_i32 s3, s3, 589824
    s_add_u32 m0, s14, 61440
    s_add_u32 s3, s3, s12
    buffer_load_dwordx4 v46, s[24:27], s3 offen offset:0 lds
    buffer_load_dwordx4 v47, s[24:27], s3 offen offset:1024 lds
    buffer_load_dwordx4 v48, s[24:27], s3 offen offset:2048 lds
    buffer_load_dwordx4 v49, s[24:27], s3 offen offset:3072 lds
    s_waitcnt vmcnt(10)
    s_barrier
    s_bfe_u32 s3, s17, 327690
    s_add_u32 s3, s3, s28
    s_and_b32 s3, s3, 31
    s_mul_i32 s3, s3, 73728
    s_add_u32 s3, s3, s13
    s_add_u32 m0, s15, 92160
    s_nop 0
    buffer_load_dwordx4 v40, s[44:47], s3 offen offset:0 sc1 lds
    buffer_load_dwordx4 v41, s[44:47], s3 offen offset:1024 sc1 lds
    buffer_load_dwordx4 v42, s[44:47], s3 offen offset:2048 sc1 lds
    buffer_load_dwordx4 v43, s[44:47], s3 offen offset:3072 sc1 lds
    s_add_u32 m0, s15, 96256
    s_nop 0
    buffer_load_dwordx4 v44, s[44:47], s3 offen offset:0 sc1 lds
    buffer_load_dwordx4 v45, s[44:47], s3 offen offset:1024 sc1 lds
    s_bfe_u32 s3, s17, 327690
    s_add_u32 s3, s3, s28
    s_and_b32 s3, s3, 31
    s_mul_i32 s3, s3, 589824
    s_add_u32 m0, s14, 92160
    s_add_u32 s3, s3, s12
    buffer_load_dwordx4 v46, s[24:27], s3 offen offset:0 lds
    buffer_load_dwordx4 v47, s[24:27], s3 offen offset:1024 lds
    buffer_load_dwordx4 v48, s[24:27], s3 offen offset:2048 lds
    buffer_load_dwordx4 v49, s[24:27], s3 offen offset:3072 lds
    s_waitcnt vmcnt(10)
    s_barrier
    s_bfe_u32 s3, s17, 327695
    s_add_u32 s3, s3, s28
    s_and_b32 s3, s3, 31
    s_mul_i32 s3, s3, 73728
    s_add_u32 s3, s3, s13
    s_add_u32 m0, s15, 122880
    s_nop 0
    buffer_load_dwordx4 v40, s[44:47], s3 offen offset:0 sc1 lds
    buffer_load_dwordx4 v41, s[44:47], s3 offen offset:1024 sc1 lds
    buffer_load_dwordx4 v42, s[44:47], s3 offen offset:2048 sc1 lds
    buffer_load_dwordx4 v43, s[44:47], s3 offen offset:3072 sc1 lds
    s_add_u32 m0, s15, 126976
    s_nop 0
    buffer_load_dwordx4 v44, s[44:47], s3 offen offset:0 sc1 lds
    buffer_load_dwordx4 v45, s[44:47], s3 offen offset:1024 sc1 lds
    s_bfe_u32 s3, s17, 327695
    s_add_u32 s3, s3, s28
    s_and_b32 s3, s3, 31
    s_mul_i32 s3, s3, 589824
    s_add_u32 m0, s14, 122880
    s_add_u32 s3, s3, s12
    buffer_load_dwordx4 v46, s[24:27], s3 offen offset:0 lds
    buffer_load_dwordx4 v47, s[24:27], s3 offen offset:1024 lds
    buffer_load_dwordx4 v48, s[24:27], s3 offen offset:2048 lds
    buffer_load_dwordx4 v49, s[24:27], s3 offen offset:3072 lds
    s_waitcnt vmcnt(10)
    s_barrier
    s_bfe_u32 s3, s17, 327700
    s_add_u32 s3, s3, s28
    s_and_b32 s3, s3, 31
    s_mul_i32 s3, s3, 73728
    s_add_u32 s3, s3, s13
    s_add_u32 m0, s15, 0
    s_nop 0
    buffer_load_dwordx4 v40, s[44:47], s3 offen offset:0 sc1 lds
    buffer_load_dwordx4 v41, s[44:47], s3 offen offset:1024 sc1 lds
    buffer_load_dwordx4 v42, s[44:47], s3 offen offset:2048 sc1 lds
    buffer_load_dwordx4 v43, s[44:47], s3 offen offset:3072 sc1 lds
    s_add_u32 m0, s15, 4096
    s_nop 0
    buffer_load_dwordx4 v44, s[44:47], s3 offen offset:0 sc1 lds
    buffer_load_dwordx4 v45, s[44:47], s3 offen offset:1024 sc1 lds
    s_bfe_u32 s3, s17, 327700
    s_add_u32 s3, s3, s28
    s_and_b32 s3, s3, 31
    s_mul_i32 s3, s3, 589824
    s_add_u32 m0, s14, 0
    s_add_u32 s3, s3, s12
    buffer_load_dwordx4 v46, s[24:27], s3 offen offset:0 lds
    buffer_load_dwordx4 v47, s[24:27], s3 offen offset:1024 lds
    buffer_load_dwordx4 v48, s[24:27], s3 offen offset:2048 lds
    buffer_load_dwordx4 v49, s[24:27], s3 offen offset:3072 lds
    s_waitcnt vmcnt(10)
    s_barrier
    s_bfe_u32 s3, s17, 327705
    s_add_u32 s3, s3, s28
    s_and_b32 s3, s3, 31
    s_mul_i32 s3, s3, 73728
    s_add_u32 s3, s3, s13
    s_add_u32 m0, s15, 30720
    s_nop 0
    buffer_load_dwordx4 v40, s[44:47], s3 offen offset:0 sc1 lds
    buffer_load_dwordx4 v41, s[44:47], s3 offen offset:1024 sc1 lds
    buffer_load_dwordx4 v42, s[44:47], s3 offen offset:2048 sc1 lds
    buffer_load_dwordx4 v43, s[44:47], s3 offen offset:3072 sc1 lds
    s_add_u32 m0, s15, 34816
    s_nop 0
    buffer_load_dwordx4 v44, s[44:47], s3 offen offset:0 sc1 lds
    buffer_load_dwordx4 v45, s[44:47], s3 offen offset:1024 sc1 lds
    s_bfe_u32 s3, s17, 327705
    s_add_u32 s3, s3, s28
    s_and_b32 s3, s3, 31
    s_mul_i32 s3, s3, 589824
    s_add_u32 m0, s14, 30720
    s_add_u32 s3, s3, s12
    buffer_load_dwordx4 v46, s[24:27], s3 offen offset:0 lds
    buffer_load_dwordx4 v47, s[24:27], s3 offen offset:1024 lds
    buffer_load_dwordx4 v48, s[24:27], s3 offen offset:2048 lds
    buffer_load_dwordx4 v49, s[24:27], s3 offen offset:3072 lds
    s_waitcnt vmcnt(10)
    s_barrier
    s_bfe_u32 s3, s18, 327680
    s_add_u32 s3, s3, s28
    s_and_b32 s3, s3, 31
    s_mul_i32 s3, s3, 73728
    s_add_u32 s3, s3, s13
    s_add_u32 m0, s15, 61440
    s_nop 0
    buffer_load_dwordx4 v40, s[44:47], s3 offen offset:0 sc1 lds
    buffer_load_dwordx4 v41, s[44:47], s3 offen offset:1024 sc1 lds
    buffer_load_dwordx4 v42, s[44:47], s3 offen offset:2048 sc1 lds
    buffer_load_dwordx4 v43, s[44:47], s3 offen offset:3072 sc1 lds
    s_add_u32 m0, s15, 65536
    s_nop 0
    buffer_load_dwordx4 v44, s[44:47], s3 offen offset:0 sc1 lds
    buffer_load_dwordx4 v45, s[44:47], s3 offen offset:1024 sc1 lds
    s_bfe_u32 s3, s18, 327680
    s_add_u32 s3, s3, s28
    s_and_b32 s3, s3, 31
    s_mul_i32 s3, s3, 589824
    s_add_u32 m0, s14, 61440
    s_add_u32 s3, s3, s12
    buffer_load_dwordx4 v46, s[24:27], s3 offen offset:0 lds
    buffer_load_dwordx4 v47, s[24:27], s3 offen offset:1024 lds
    buffer_load_dwordx4 v48, s[24:27], s3 offen offset:2048 lds
    buffer_load_dwordx4 v49, s[24:27], s3 offen offset:3072 lds
    s_waitcnt vmcnt(10)
    s_barrier
    s_bfe_u32 s3, s18, 327685
    s_add_u32 s3, s3, s28
    s_and_b32 s3, s3, 31
    s_mul_i32 s3, s3, 73728
    s_add_u32 s3, s3, s13
    s_add_u32 m0, s15, 92160
    s_nop 0
    buffer_load_dwordx4 v40, s[44:47], s3 offen offset:0 sc1 lds
    buffer_load_dwordx4 v41, s[44:47], s3 offen offset:1024 sc1 lds
    buffer_load_dwordx4 v42, s[44:47], s3 offen offset:2048 sc1 lds
    buffer_load_dwordx4 v43, s[44:47], s3 offen offset:3072 sc1 lds
    s_add_u32 m0, s15, 96256
    s_nop 0
    buffer_load_dwordx4 v44, s[44:47], s3 offen offset:0 sc1 lds
    buffer_load_dwordx4 v45, s[44:47], s3 offen offset:1024 sc1 lds
    s_bfe_u32 s3, s18, 327685
    s_add_u32 s3, s3, s28
    s_and_b32 s3, s3, 31
    s_mul_i32 s3, s3, 589824
    s_add_u32 m0, s14, 92160
    s_add_u32 s3, s3, s12
    buffer_load_dwordx4 v46, s[24:27], s3 offen offset:0 lds
    buffer_load_dwordx4 v47, s[24:27], s3 offen offset:1024 lds
    buffer_load_dwordx4 v48, s[24:27], s3 offen offset:2048 lds
    buffer_load_dwordx4 v49, s[24:27], s3 offen offset:3072 lds
    s_waitcnt vmcnt(10)
    s_barrier
    s_bfe_u32 s3, s18, 327690
    s_add_u32 s3, s3, s28
    s_and_b32 s3, s3, 31
    s_mul_i32 s3, s3, 73728
    s_add_u32 s3, s3, s13
    s_add_u32 m0, s15, 122880
    s_nop 0
    buffer_load_dwordx4 v40, s[44:47], s3 offen offset:0 sc1 lds
    buffer_load_dwordx4 v41, s[44:47], s3 offen offset:1024 sc1 lds
    buffer_load_dwordx4 v42, s[44:47], s3 offen offset:2048 sc1 lds
    buffer_load_dwordx4 v43, s[44:47], s3 offen offset:3072 sc1 lds
    s_add_u32 m0, s15, 126976
    s_nop 0
    buffer_load_dwordx4 v44, s[44:47], s3 offen offset:0 sc1 lds
    buffer_load_dwordx4 v45, s[44:47], s3 offen offset:1024 sc1 lds
    s_bfe_u32 s3, s18, 327690
    s_add_u32 s3, s3, s28
    s_and_b32 s3, s3, 31
    s_mul_i32 s3, s3, 589824
    s_add_u32 m0, s14, 122880
    s_add_u32 s3, s3, s12
    buffer_load_dwordx4 v46, s[24:27], s3 offen offset:0 lds
    buffer_load_dwordx4 v47, s[24:27], s3 offen offset:1024 lds
    buffer_load_dwordx4 v48, s[24:27], s3 offen offset:2048 lds
    buffer_load_dwordx4 v49, s[24:27], s3 offen offset:3072 lds
    s_waitcnt vmcnt(10)
    s_barrier
    s_bfe_u32 s3, s18, 327695
    s_add_u32 s3, s3, s28
    s_and_b32 s3, s3, 31
    s_mul_i32 s3, s3, 73728
    s_add_u32 s3, s3, s13
    s_add_u32 m0, s15, 0
    s_nop 0
    buffer_load_dwordx4 v40, s[44:47], s3 offen offset:0 sc1 lds
    buffer_load_dwordx4 v41, s[44:47], s3 offen offset:1024 sc1 lds
    buffer_load_dwordx4 v42, s[44:47], s3 offen offset:2048 sc1 lds
    buffer_load_dwordx4 v43, s[44:47], s3 offen offset:3072 sc1 lds
    s_add_u32 m0, s15, 4096
    s_nop 0
    buffer_load_dwordx4 v44, s[44:47], s3 offen offset:0 sc1 lds
    buffer_load_dwordx4 v45, s[44:47], s3 offen offset:1024 sc1 lds
    s_bfe_u32 s3, s18, 327695
    s_add_u32 s3, s3, s28
    s_and_b32 s3, s3, 31
    s_mul_i32 s3, s3, 589824
    s_add_u32 m0, s14, 0
    s_add_u32 s3, s3, s12
    buffer_load_dwordx4 v46, s[24:27], s3 offen offset:0 lds
    buffer_load_dwordx4 v47, s[24:27], s3 offen offset:1024 lds
    buffer_load_dwordx4 v48, s[24:27], s3 offen offset:2048 lds
    buffer_load_dwordx4 v49, s[24:27], s3 offen offset:3072 lds
    s_waitcnt vmcnt(10)
    s_barrier
    s_bfe_u32 s3, s18, 327700
    s_add_u32 s3, s3, s28
    s_and_b32 s3, s3, 31
    s_mul_i32 s3, s3, 73728
    s_add_u32 s3, s3, s13
    s_add_u32 m0, s15, 30720
    s_nop 0
    buffer_load_dwordx4 v40, s[44:47], s3 offen offset:0 sc1 lds
    buffer_load_dwordx4 v41, s[44:47], s3 offen offset:1024 sc1 lds
    buffer_load_dwordx4 v42, s[44:47], s3 offen offset:2048 sc1 lds
    buffer_load_dwordx4 v43, s[44:47], s3 offen offset:3072 sc1 lds
    s_add_u32 m0, s15, 34816
    s_nop 0
    buffer_load_dwordx4 v44, s[44:47], s3 offen offset:0 sc1 lds
    buffer_load_dwordx4 v45, s[44:47], s3 offen offset:1024 sc1 lds
    s_bfe_u32 s3, s18, 327700
    s_add_u32 s3, s3, s28
    s_and_b32 s3, s3, 31
    s_mul_i32 s3, s3, 589824
    s_add_u32 m0, s14, 30720
    s_add_u32 s3, s3, s12
    buffer_load_dwordx4 v46, s[24:27], s3 offen offset:0 lds
    buffer_load_dwordx4 v47, s[24:27], s3 offen offset:1024 lds
    buffer_load_dwordx4 v48, s[24:27], s3 offen offset:2048 lds
    buffer_load_dwordx4 v49, s[24:27], s3 offen offset:3072 lds
    s_waitcnt vmcnt(10)
    s_barrier
    s_bfe_u32 s3, s18, 327705
    s_add_u32 s3, s3, s28
    s_and_b32 s3, s3, 31
    s_mul_i32 s3, s3, 73728
    s_add_u32 s3, s3, s13
    s_add_u32 m0, s15, 61440
    s_nop 0
    buffer_load_dwordx4 v40, s[44:47], s3 offen offset:0 sc1 lds
    buffer_load_dwordx4 v41, s[44:47], s3 offen offset:1024 sc1 lds
    buffer_load_dwordx4 v42, s[44:47], s3 offen offset:2048 sc1 lds
    buffer_load_dwordx4 v43, s[44:47], s3 offen offset:3072 sc1 lds
    s_add_u32 m0, s15, 65536
    s_nop 0
    buffer_load_dwordx4 v44, s[44:47], s3 offen offset:0 sc1 lds
    buffer_load_dwordx4 v45, s[44:47], s3 offen offset:1024 sc1 lds
    s_bfe_u32 s3, s18, 327705
    s_add_u32 s3, s3, s28
    s_and_b32 s3, s3, 31
    s_mul_i32 s3, s3, 589824
    s_add_u32 m0, s14, 61440
    s_add_u32 s3, s3, s12
    buffer_load_dwordx4 v46, s[24:27], s3 offen offset:0 lds
    buffer_load_dwordx4 v47, s[24:27], s3 offen offset:1024 lds
    buffer_load_dwordx4 v48, s[24:27], s3 offen offset:2048 lds
    buffer_load_dwordx4 v49, s[24:27], s3 offen offset:3072 lds
    s_waitcnt vmcnt(10)
    s_barrier
    s_bfe_u32 s3, s19, 327680
    s_add_u32 s3, s3, s28
    s_and_b32 s3, s3, 31
    s_mul_i32 s3, s3, 73728
    s_add_u32 s3, s3, s13
    s_add_u32 m0, s15, 92160
    s_nop 0
    buffer_load_dwordx4 v40, s[44:47], s3 offen offset:0 sc1 lds
    buffer_load_dwordx4 v41, s[44:47], s3 offen offset:1024 sc1 lds
    buffer_load_dwordx4 v42, s[44:47], s3 offen offset:2048 sc1 lds
    buffer_load_dwordx4 v43, s[44:47], s3 offen offset:3072 sc1 lds
    s_add_u32 m0, s15, 96256
    s_nop 0
    buffer_load_dwordx4 v44, s[44:47], s3 offen offset:0 sc1 lds
    buffer_load_dwordx4 v45, s[44:47], s3 offen offset:1024 sc1 lds
    s_bfe_u32 s3, s19, 327680
    s_add_u32 s3, s3, s28
    s_and_b32 s3, s3, 31
    s_mul_i32 s3, s3, 589824
    s_add_u32 m0, s14, 92160
    s_add_u32 s3, s3, s12
    buffer_load_dwordx4 v46, s[24:27], s3 offen offset:0 lds
    buffer_load_dwordx4 v47, s[24:27], s3 offen offset:1024 lds
    buffer_load_dwordx4 v48, s[24:27], s3 offen offset:2048 lds
    buffer_load_dwordx4 v49, s[24:27], s3 offen offset:3072 lds
    s_waitcnt vmcnt(10)
    s_barrier
    s_bfe_u32 s3, s19, 327685
    s_add_u32 s3, s3, s28
    s_and_b32 s3, s3, 31
    s_mul_i32 s3, s3, 73728
    s_add_u32 s3, s3, s13
    s_add_u32 m0, s15, 122880
    s_nop 0
    buffer_load_dwordx4 v40, s[44:47], s3 offen offset:0 sc1 lds
    buffer_load_dwordx4 v41, s[44:47], s3 offen offset:1024 sc1 lds
    buffer_load_dwordx4 v42, s[44:47], s3 offen offset:2048 sc1 lds
    buffer_load_dwordx4 v43, s[44:47], s3 offen offset:3072 sc1 lds
    s_add_u32 m0, s15, 126976
    s_nop 0
    buffer_load_dwordx4 v44, s[44:47], s3 offen offset:0 sc1 lds
    buffer_load_dwordx4 v45, s[44:47], s3 offen offset:1024 sc1 lds
    s_bfe_u32 s3, s19, 327685
    s_add_u32 s3, s3, s28
    s_and_b32 s3, s3, 31
    s_mul_i32 s3, s3, 589824
    s_add_u32 m0, s14, 122880
    s_add_u32 s3, s3, s12
    buffer_load_dwordx4 v46, s[24:27], s3 offen offset:0 lds
    buffer_load_dwordx4 v47, s[24:27], s3 offen offset:1024 lds
    buffer_load_dwordx4 v48, s[24:27], s3 offen offset:2048 lds
    buffer_load_dwordx4 v49, s[24:27], s3 offen offset:3072 lds
    s_waitcnt vmcnt(10)
    s_barrier
    s_bfe_u32 s3, s19, 327690
    s_add_u32 s3, s3, s28
    s_and_b32 s3, s3, 31
    s_mul_i32 s3, s3, 73728
    s_add_u32 s3, s3, s13
    s_add_u32 m0, s15, 0
    s_nop 0
    buffer_load_dwordx4 v40, s[44:47], s3 offen offset:0 sc1 lds
    buffer_load_dwordx4 v41, s[44:47], s3 offen offset:1024 sc1 lds
    buffer_load_dwordx4 v42, s[44:47], s3 offen offset:2048 sc1 lds
    buffer_load_dwordx4 v43, s[44:47], s3 offen offset:3072 sc1 lds
    s_add_u32 m0, s15, 4096
    s_nop 0
    buffer_load_dwordx4 v44, s[44:47], s3 offen offset:0 sc1 lds
    buffer_load_dwordx4 v45, s[44:47], s3 offen offset:1024 sc1 lds
    s_bfe_u32 s3, s19, 327690
    s_add_u32 s3, s3, s28
    s_and_b32 s3, s3, 31
    s_mul_i32 s3, s3, 589824
    s_add_u32 m0, s14, 0
    s_add_u32 s3, s3, s12
    buffer_load_dwordx4 v46, s[24:27], s3 offen offset:0 lds
    buffer_load_dwordx4 v47, s[24:27], s3 offen offset:1024 lds
    buffer_load_dwordx4 v48, s[24:27], s3 offen offset:2048 lds
    buffer_load_dwordx4 v49, s[24:27], s3 offen offset:3072 lds
    s_waitcnt vmcnt(10)
    s_barrier
    s_bfe_u32 s3, s19, 327695
    s_add_u32 s3, s3, s28
    s_and_b32 s3, s3, 31
    s_mul_i32 s3, s3, 73728
    s_add_u32 s3, s3, s13
    s_add_u32 m0, s15, 30720
    s_nop 0
    buffer_load_dwordx4 v40, s[44:47], s3 offen offset:0 sc1 lds
    buffer_load_dwordx4 v41, s[44:47], s3 offen offset:1024 sc1 lds
    buffer_load_dwordx4 v42, s[44:47], s3 offen offset:2048 sc1 lds
    buffer_load_dwordx4 v43, s[44:47], s3 offen offset:3072 sc1 lds
    s_add_u32 m0, s15, 34816
    s_nop 0
    buffer_load_dwordx4 v44, s[44:47], s3 offen offset:0 sc1 lds
    buffer_load_dwordx4 v45, s[44:47], s3 offen offset:1024 sc1 lds
    s_bfe_u32 s3, s19, 327695
    s_add_u32 s3, s3, s28
    s_and_b32 s3, s3, 31
    s_mul_i32 s3, s3, 589824
    s_add_u32 m0, s14, 30720
    s_add_u32 s3, s3, s12
    buffer_load_dwordx4 v46, s[24:27], s3 offen offset:0 lds
    buffer_load_dwordx4 v47, s[24:27], s3 offen offset:1024 lds
    buffer_load_dwordx4 v48, s[24:27], s3 offen offset:2048 lds
    buffer_load_dwordx4 v49, s[24:27], s3 offen offset:3072 lds
    s_waitcnt vmcnt(10)
    s_barrier
    s_bfe_u32 s3, s19, 327700
    s_add_u32 s3, s3, s28
    s_and_b32 s3, s3, 31
    s_mul_i32 s3, s3, 73728
    s_add_u32 s3, s3, s13
    s_add_u32 m0, s15, 61440
    s_nop 0
    buffer_load_dwordx4 v40, s[44:47], s3 offen offset:0 sc1 lds
    buffer_load_dwordx4 v41, s[44:47], s3 offen offset:1024 sc1 lds
    buffer_load_dwordx4 v42, s[44:47], s3 offen offset:2048 sc1 lds
    buffer_load_dwordx4 v43, s[44:47], s3 offen offset:3072 sc1 lds
    s_add_u32 m0, s15, 65536
    s_nop 0
    buffer_load_dwordx4 v44, s[44:47], s3 offen offset:0 sc1 lds
    buffer_load_dwordx4 v45, s[44:47], s3 offen offset:1024 sc1 lds
    s_bfe_u32 s3, s19, 327700
    s_add_u32 s3, s3, s28
    s_and_b32 s3, s3, 31
    s_mul_i32 s3, s3, 589824
    s_add_u32 m0, s14, 61440
    s_add_u32 s3, s3, s12
    buffer_load_dwordx4 v46, s[24:27], s3 offen offset:0 lds
    buffer_load_dwordx4 v47, s[24:27], s3 offen offset:1024 lds
    buffer_load_dwordx4 v48, s[24:27], s3 offen offset:2048 lds
    buffer_load_dwordx4 v49, s[24:27], s3 offen offset:3072 lds
    s_waitcnt vmcnt(10)
    s_barrier
    s_bfe_u32 s3, s19, 327705
    s_add_u32 s3, s3, s28
    s_and_b32 s3, s3, 31
    s_mul_i32 s3, s3, 73728
    s_add_u32 s3, s3, s13
    s_add_u32 m0, s15, 92160
    s_nop 0
    buffer_load_dwordx4 v40, s[44:47], s3 offen offset:0 sc1 lds
    buffer_load_dwordx4 v41, s[44:47], s3 offen offset:1024 sc1 lds
    buffer_load_dwordx4 v42, s[44:47], s3 offen offset:2048 sc1 lds
    buffer_load_dwordx4 v43, s[44:47], s3 offen offset:3072 sc1 lds
    s_add_u32 m0, s15, 96256
    s_nop 0
    buffer_load_dwordx4 v44, s[44:47], s3 offen offset:0 sc1 lds
    buffer_load_dwordx4 v45, s[44:47], s3 offen offset:1024 sc1 lds
    s_bfe_u32 s3, s19, 327705
    s_add_u32 s3, s3, s28
    s_and_b32 s3, s3, 31
    s_mul_i32 s3, s3, 589824
    s_add_u32 m0, s14, 92160
    s_add_u32 s3, s3, s12
    buffer_load_dwordx4 v46, s[24:27], s3 offen offset:0 lds
    buffer_load_dwordx4 v47, s[24:27], s3 offen offset:1024 lds
    buffer_load_dwordx4 v48, s[24:27], s3 offen offset:2048 lds
    buffer_load_dwordx4 v49, s[24:27], s3 offen offset:3072 lds
    s_waitcnt vmcnt(10)
    s_barrier
    s_bfe_u32 s3, s36, 327680
    s_add_u32 s3, s3, s28
    s_and_b32 s3, s3, 31
    s_mul_i32 s3, s3, 73728
    s_add_u32 s3, s3, s13
    s_add_u32 m0, s15, 122880
    s_nop 0
    buffer_load_dwordx4 v40, s[44:47], s3 offen offset:0 sc1 lds
    buffer_load_dwordx4 v41, s[44:47], s3 offen offset:1024 sc1 lds
    buffer_load_dwordx4 v42, s[44:47], s3 offen offset:2048 sc1 lds
    buffer_load_dwordx4 v43, s[44:47], s3 offen offset:3072 sc1 lds
    s_add_u32 m0, s15, 126976
    s_nop 0
    buffer_load_dwordx4 v44, s[44:47], s3 offen offset:0 sc1 lds
    buffer_load_dwordx4 v45, s[44:47], s3 offen offset:1024 sc1 lds
    s_bfe_u32 s3, s36, 327680
    s_add_u32 s3, s3, s28
    s_and_b32 s3, s3, 31
    s_mul_i32 s3, s3, 589824
    s_add_u32 m0, s14, 122880
    s_add_u32 s3, s3, s12
    buffer_load_dwordx4 v46, s[24:27], s3 offen offset:0 lds
    buffer_load_dwordx4 v47, s[24:27], s3 offen offset:1024 lds
    buffer_load_dwordx4 v48, s[24:27], s3 offen offset:2048 lds
    buffer_load_dwordx4 v49, s[24:27], s3 offen offset:3072 lds
    s_waitcnt vmcnt(10)
    s_barrier
    s_bfe_u32 s3, s36, 327685
    s_add_u32 s3, s3, s28
    s_and_b32 s3, s3, 31
    s_mul_i32 s3, s3, 73728
    s_add_u32 s3, s3, s13
    s_add_u32 m0, s15, 0
    s_nop 0
    buffer_load_dwordx4 v40, s[44:47], s3 offen offset:0 sc1 lds
    buffer_load_dwordx4 v41, s[44:47], s3 offen offset:1024 sc1 lds
    buffer_load_dwordx4 v42, s[44:47], s3 offen offset:2048 sc1 lds
    buffer_load_dwordx4 v43, s[44:47], s3 offen offset:3072 sc1 lds
    s_add_u32 m0, s15, 4096
    s_nop 0
    buffer_load_dwordx4 v44, s[44:47], s3 offen offset:0 sc1 lds
    buffer_load_dwordx4 v45, s[44:47], s3 offen offset:1024 sc1 lds
    s_bfe_u32 s3, s36, 327685
    s_add_u32 s3, s3, s28
    s_and_b32 s3, s3, 31
    s_mul_i32 s3, s3, 589824
    s_add_u32 m0, s14, 0
    s_add_u32 s3, s3, s12
    buffer_load_dwordx4 v46, s[24:27], s3 offen offset:0 lds
    buffer_load_dwordx4 v47, s[24:27], s3 offen offset:1024 lds
    buffer_load_dwordx4 v48, s[24:27], s3 offen offset:2048 lds
    buffer_load_dwordx4 v49, s[24:27], s3 offen offset:3072 lds
    s_waitcnt vmcnt(10)
    s_barrier
    s_bfe_u32 s3, s36, 327690
    s_add_u32 s3, s3, s28
    s_and_b32 s3, s3, 31
    s_mul_i32 s3, s3, 73728
    s_add_u32 s3, s3, s13
    s_add_u32 m0, s15, 30720
    s_nop 0
    buffer_load_dwordx4 v40, s[44:47], s3 offen offset:0 sc1 lds
    buffer_load_dwordx4 v41, s[44:47], s3 offen offset:1024 sc1 lds
    buffer_load_dwordx4 v42, s[44:47], s3 offen offset:2048 sc1 lds
    buffer_load_dwordx4 v43, s[44:47], s3 offen offset:3072 sc1 lds
    s_add_u32 m0, s15, 34816
    s_nop 0
    buffer_load_dwordx4 v44, s[44:47], s3 offen offset:0 sc1 lds
    buffer_load_dwordx4 v45, s[44:47], s3 offen offset:1024 sc1 lds
    s_bfe_u32 s3, s36, 327690
    s_add_u32 s3, s3, s28
    s_and_b32 s3, s3, 31
    s_mul_i32 s3, s3, 589824
    s_add_u32 m0, s14, 30720
    s_add_u32 s3, s3, s12
    buffer_load_dwordx4 v46, s[24:27], s3 offen offset:0 lds
    buffer_load_dwordx4 v47, s[24:27], s3 offen offset:1024 lds
    buffer_load_dwordx4 v48, s[24:27], s3 offen offset:2048 lds
    buffer_load_dwordx4 v49, s[24:27], s3 offen offset:3072 lds
    s_waitcnt vmcnt(10)
    s_barrier
    s_bfe_u32 s3, s36, 327695
    s_add_u32 s3, s3, s28
    s_and_b32 s3, s3, 31
    s_mul_i32 s3, s3, 73728
    s_add_u32 s3, s3, s13
    s_add_u32 m0, s15, 61440
    s_nop 0
    buffer_load_dwordx4 v40, s[44:47], s3 offen offset:0 sc1 lds
    buffer_load_dwordx4 v41, s[44:47], s3 offen offset:1024 sc1 lds
    buffer_load_dwordx4 v42, s[44:47], s3 offen offset:2048 sc1 lds
    buffer_load_dwordx4 v43, s[44:47], s3 offen offset:3072 sc1 lds
    s_add_u32 m0, s15, 65536
    s_nop 0
    buffer_load_dwordx4 v44, s[44:47], s3 offen offset:0 sc1 lds
    buffer_load_dwordx4 v45, s[44:47], s3 offen offset:1024 sc1 lds
    s_bfe_u32 s3, s36, 327695
    s_add_u32 s3, s3, s28
    s_and_b32 s3, s3, 31
    s_mul_i32 s3, s3, 589824
    s_add_u32 m0, s14, 61440
    s_add_u32 s3, s3, s12
    buffer_load_dwordx4 v46, s[24:27], s3 offen offset:0 lds
    buffer_load_dwordx4 v47, s[24:27], s3 offen offset:1024 lds
    buffer_load_dwordx4 v48, s[24:27], s3 offen offset:2048 lds
    buffer_load_dwordx4 v49, s[24:27], s3 offen offset:3072 lds
    s_waitcnt vmcnt(10)
    s_barrier
    s_bfe_u32 s3, s36, 327700
    s_add_u32 s3, s3, s28
    s_and_b32 s3, s3, 31
    s_mul_i32 s3, s3, 73728
    s_add_u32 s3, s3, s13
    s_add_u32 m0, s15, 92160
    s_nop 0
    buffer_load_dwordx4 v40, s[44:47], s3 offen offset:0 sc1 lds
    buffer_load_dwordx4 v41, s[44:47], s3 offen offset:1024 sc1 lds
    buffer_load_dwordx4 v42, s[44:47], s3 offen offset:2048 sc1 lds
    buffer_load_dwordx4 v43, s[44:47], s3 offen offset:3072 sc1 lds
    s_add_u32 m0, s15, 96256
    s_nop 0
    buffer_load_dwordx4 v44, s[44:47], s3 offen offset:0 sc1 lds
    buffer_load_dwordx4 v45, s[44:47], s3 offen offset:1024 sc1 lds
    s_bfe_u32 s3, s36, 327700
    s_add_u32 s3, s3, s28
    s_and_b32 s3, s3, 31
    s_mul_i32 s3, s3, 589824
    s_add_u32 m0, s14, 92160
    s_add_u32 s3, s3, s12
    buffer_load_dwordx4 v46, s[24:27], s3 offen offset:0 lds
    buffer_load_dwordx4 v47, s[24:27], s3 offen offset:1024 lds
    buffer_load_dwordx4 v48, s[24:27], s3 offen offset:2048 lds
    buffer_load_dwordx4 v49, s[24:27], s3 offen offset:3072 lds
    s_waitcnt vmcnt(10)
    s_barrier
    s_bfe_u32 s3, s36, 327705
    s_add_u32 s3, s3, s28
    s_and_b32 s3, s3, 31
    s_mul_i32 s3, s3, 73728
    s_add_u32 s3, s3, s13
    s_add_u32 m0, s15, 122880
    s_nop 0
    buffer_load_dwordx4 v40, s[44:47], s3 offen offset:0 sc1 lds
    buffer_load_dwordx4 v41, s[44:47], s3 offen offset:1024 sc1 lds
    buffer_load_dwordx4 v42, s[44:47], s3 offen offset:2048 sc1 lds
    buffer_load_dwordx4 v43, s[44:47], s3 offen offset:3072 sc1 lds
    s_add_u32 m0, s15, 126976
    s_nop 0
    buffer_load_dwordx4 v44, s[44:47], s3 offen offset:0 sc1 lds
    buffer_load_dwordx4 v45, s[44:47], s3 offen offset:1024 sc1 lds
    s_bfe_u32 s3, s36, 327705
    s_add_u32 s3, s3, s28
    s_and_b32 s3, s3, 31
    s_mul_i32 s3, s3, 589824
    s_add_u32 m0, s14, 122880
    s_add_u32 s3, s3, s12
    buffer_load_dwordx4 v46, s[24:27], s3 offen offset:0 lds
    buffer_load_dwordx4 v47, s[24:27], s3 offen offset:1024 lds
    buffer_load_dwordx4 v48, s[24:27], s3 offen offset:2048 lds
    buffer_load_dwordx4 v49, s[24:27], s3 offen offset:3072 lds
    s_waitcnt vmcnt(10)
    s_barrier
    s_bfe_u32 s3, s37, 327680
    s_add_u32 s3, s3, s28
    s_and_b32 s3, s3, 31
    s_mul_i32 s3, s3, 73728
    s_add_u32 s3, s3, s13
    s_add_u32 m0, s15, 0
    s_nop 0
    buffer_load_dwordx4 v40, s[44:47], s3 offen offset:0 sc1 lds
    buffer_load_dwordx4 v41, s[44:47], s3 offen offset:1024 sc1 lds
    buffer_load_dwordx4 v42, s[44:47], s3 offen offset:2048 sc1 lds
    buffer_load_dwordx4 v43, s[44:47], s3 offen offset:3072 sc1 lds
    s_add_u32 m0, s15, 4096
    s_nop 0
    buffer_load_dwordx4 v44, s[44:47], s3 offen offset:0 sc1 lds
    buffer_load_dwordx4 v45, s[44:47], s3 offen offset:1024 sc1 lds
    s_bfe_u32 s3, s37, 327680
    s_add_u32 s3, s3, s28
    s_and_b32 s3, s3, 31
    s_mul_i32 s3, s3, 589824
    s_add_u32 m0, s14, 0
    s_add_u32 s3, s3, s12
    buffer_load_dwordx4 v46, s[24:27], s3 offen offset:0 lds
    buffer_load_dwordx4 v47, s[24:27], s3 offen offset:1024 lds
    buffer_load_dwordx4 v48, s[24:27], s3 offen offset:2048 lds
    buffer_load_dwordx4 v49, s[24:27], s3 offen offset:3072 lds
    s_waitcnt vmcnt(10)
    s_barrier
    s_bfe_u32 s3, s37, 327685
    s_add_u32 s3, s3, s28
    s_and_b32 s3, s3, 31
    s_mul_i32 s3, s3, 73728
    s_add_u32 s3, s3, s13
    s_add_u32 m0, s15, 30720
    s_nop 0
    buffer_load_dwordx4 v40, s[44:47], s3 offen offset:0 sc1 lds
    buffer_load_dwordx4 v41, s[44:47], s3 offen offset:1024 sc1 lds
    buffer_load_dwordx4 v42, s[44:47], s3 offen offset:2048 sc1 lds
    buffer_load_dwordx4 v43, s[44:47], s3 offen offset:3072 sc1 lds
    s_add_u32 m0, s15, 34816
    s_nop 0
    buffer_load_dwordx4 v44, s[44:47], s3 offen offset:0 sc1 lds
    buffer_load_dwordx4 v45, s[44:47], s3 offen offset:1024 sc1 lds
    s_bfe_u32 s3, s37, 327685
    s_add_u32 s3, s3, s28
    s_and_b32 s3, s3, 31
    s_mul_i32 s3, s3, 589824
    s_add_u32 m0, s14, 30720
    s_add_u32 s3, s3, s12
    buffer_load_dwordx4 v46, s[24:27], s3 offen offset:0 lds
    buffer_load_dwordx4 v47, s[24:27], s3 offen offset:1024 lds
    buffer_load_dwordx4 v48, s[24:27], s3 offen offset:2048 lds
    buffer_load_dwordx4 v49, s[24:27], s3 offen offset:3072 lds
    s_waitcnt vmcnt(10)
    s_barrier
    s_bfe_u32 s57, s100, 262144
    s_mul_i32 s57, s57, 393216
    s_add_u32 s57, s57, s9
    s_add_u32 m0, s63, 61440
    s_nop 0
    buffer_load_dwordx4 v11, s[32:35], s57 offen offset:0 lds
    buffer_load_dwordx4 v12, s[32:35], s57 offen offset:1024 lds
    s_add_u32 s57, s57, 131072
    s_add_u32 m0, s63, 69632
    s_nop 0
    buffer_load_dwordx4 v11, s[32:35], s57 offen offset:0 lds
    buffer_load_dwordx4 v12, s[32:35], s57 offen offset:1024 lds
    s_add_u32 s57, s57, 131072
    s_add_u32 m0, s63, 77824
    s_nop 0
    buffer_load_dwordx4 v11, s[32:35], s57 offen offset:0 lds
    buffer_load_dwordx4 v12, s[32:35], s57 offen offset:1024 lds
    s_add_u32 s57, s57, 131072
    s_bfe_u32 s57, s100, 262148
    s_mul_i32 s57, s57, 393216
    s_add_u32 s57, s57, s9
    s_add_u32 m0, s63, 86016
    s_nop 0
    buffer_load_dwordx4 v11, s[32:35], s57 offen offset:0 lds
    buffer_load_dwordx4 v12, s[32:35], s57 offen offset:1024 lds
    s_add_u32 s57, s57, 131072
    s_waitcnt vmcnt(8)
    s_barrier
    s_branch L_aux_g1done
L_aux7:
    s_and_b32 s29, s5, 7
    s_lshl_b32 s52, s29, 5
    s_add_u32 s52, s52, s6
    s_lshl_b32 s52, s52, 9
    s_add_u32 s52, s52, 524288
    s_add_u32 s50, s44, s52
    s_addc_u32 s51, s45, 0
    s_load_dwordx8 s[64:71], s[50:51], 0 glc
    s_load_dwordx8 s[72:79], s[50:51], 128 glc
    s_load_dwordx8 s[80:87], s[50:51], 256 glc
    s_load_dwordx8 s[88:95], s[50:51], 384 glc
    v_mul_u32_u24 v248, 116509, v0
    v_lshrrev_b32 v248, 20, v248
    v_mul_u32_u24 v250, 9, v248
    v_sub_u32 v249, v0, v250
    v_min_u32 v248, 6, v248
    v_mul_u32_u24 v248, 9216, v248
    v_lshl_add_u32 v248, v249, 7, v248
    s_barrier
    s_mov_b32 s48, 65536
poll_6:
    s_waitcnt lgkmcnt(0)
    s_cmp_lg_u64 s[64:65], s[0:1]
    s_cselect_b32 s49, 1, 0
    s_cmp_lg_u64 s[66:67], s[0:1]
    s_cselect_b32 s49, 1, s49
    s_cmp_lg_u64 s[68:69], s[0:1]
    s_cselect_b32 s49, 1, s49
    s_cmp_lg_u64 s[70:71], s[0:1]
    s_cselect_b32 s49, 1, s49
    s_cmp_lg_u64 s[72:73], s[0:1]
    s_cselect_b32 s49, 1, s49
    s_cmp_lg_u64 s[74:75], s[0:1]
    s_cselect_b32 s49, 1, s49
    s_cmp_lg_u64 s[76:77], s[0:1]
    s_cselect_b32 s49, 1, s49
    s_cmp_lg_u64 s[78:79], s[0:1]
    s_cselect_b32 s49, 1, s49
    s_cmp_lg_u64 s[80:81], s[0:1]
    s_cselect_b32 s49, 1, s49
    s_cmp_lg_u64 s[82:83], s[0:1]
    s_cselect_b32 s49, 1, s49
    s_cmp_lg_u64 s[84:85], s[0:1]
    s_cselect_b32 s49, 1, s49
    s_cmp_lg_u64 s[86:87], s[0:1]
    s_cselect_b32 s49, 1, s49
    s_cmp_lg_u64 s[88:89], s[0:1]
    s_cselect_b32 s49, 1, s49
    s_cmp_lg_u64 s[90:91], s[0:1]
    s_cselect_b32 s49, 1, s49
    s_cmp_lg_u64 s[92:93], s[0:1]
    s_cselect_b32 s49, 1, s49
    s_cmp_lg_u64 s[94:95], s[0:1]
    s_cselect_b32 s49, 1, s49
    s_cmp_eq_u32 s49, 0
    s_cbranch_scc1 polld_7
    s_sub_u32 s48, s48, 1
    s_cmp_eq_u32 s48, 0
    s_cbranch_scc1 polld_7
    s_load_dwordx8 s[64:71], s[50:51], 0 glc
    s_load_dwordx8 s[72:79], s[50:51], 128 glc
    s_load_dwordx8 s[80:87], s[50:51], 256 glc
    s_load_dwordx8 s[88:95], s[50:51], 384 glc
    s_branch poll_6
polld_7:
    s_barrier
    s_add_u32 s29, s29, 0
    s_add_u32 s29, s29, 1
    s_and_b32 s29, s29, 7
    s_lshl_b32 s52, s29, 5
    s_add_u32 s52, s52, s6
    s_lshl_b32 s52, s52, 9
    s_add_u32 s52, s52, 524288
    s_add_u32 s50, s44, s52
    s_addc_u32 s51, s45, 0
    s_load_dwordx8 s[64:71], s[50:51], 0 glc
    s_load_dwordx8 s[72:79], s[50:51], 128 glc
    s_load_dwordx8 s[80:87], s[50:51], 256 glc
    s_load_dwordx8 s[88:95], s[50:51], 384 glc
    s_barrier
    s_mov_b32 s48, 65536
poll_8:
    s_waitcnt lgkmcnt(0)
    s_cmp_lg_u64 s[64:65], s[0:1]
    s_cselect_b32 s49, 1, 0
    s_cmp_lg_u64 s[66:67], s[0:1]
    s_cselect_b32 s49, 1, s49
    s_cmp_lg_u64 s[68:69], s[0:1]
    s_cselect_b32 s49, 1, s49
    s_cmp_lg_u64 s[70:71], s[0:1]
    s_cselect_b32 s49, 1, s49
    s_cmp_lg_u64 s[72:73], s[0:1]
    s_cselect_b32 s49, 1, s49
    s_cmp_lg_u64 s[74:75], s[0:1]
    s_cselect_b32 s49, 1, s49
    s_cmp_lg_u64 s[76:77], s[0:1]
    s_cselect_b32 s49, 1, s49
    s_cmp_lg_u64 s[78:79], s[0:1]
    s_cselect_b32 s49, 1, s49
    s_cmp_lg_u64 s[80:81], s[0:1]
    s_cselect_b32 s49, 1, s49
    s_cmp_lg_u64 s[82:83], s[0:1]
    s_cselect_b32 s49, 1, s49
    s_cmp_lg_u64 s[84:85], s[0:1]
    s_cselect_b32 s49, 1, s49
    s_cmp_lg_u64 s[86:87], s[0:1]
    s_cselect_b32 s49, 1, s49
    s_cmp_lg_u64 s[88:89], s[0:1]
    s_cselect_b32 s49, 1, s49
    s_cmp_lg_u64 s[90:91], s[0:1]
    s_cselect_b32 s49, 1, s49
    s_cmp_lg_u64 s[92:93], s[0:1]
    s_cselect_b32 s49, 1, s49
    s_cmp_lg_u64 s[94:95], s[0:1]
    s_cselect_b32 s49, 1, s49
    s_cmp_eq_u32 s49, 0
    s_cbranch_scc1 polld_9
    s_sub_u32 s48, s48, 1
    s_cmp_eq_u32 s48, 0
    s_cbranch_scc1 polld_9
    s_load_dwordx8 s[64:71], s[50:51], 0 glc
    s_load_dwordx8 s[72:79], s[50:51], 128 glc
    s_load_dwordx8 s[80:87], s[50:51], 256 glc
    s_load_dwordx8 s[88:95], s[50:51], 384 glc
    s_branch poll_8
polld_9:
    s_add_u32 s29, s29, 1
    s_and_b32 s29, s29, 7
    s_lshl_b32 s52, s29, 5
    s_add_u32 s52, s52, s6
    s_lshl_b32 s52, s52, 9
    s_add_u32 s52, s52, 524288
    s_add_u32 s50, s44, s52
    s_addc_u32 s51, s45, 0
    s_load_dwordx8 s[64:71], s[50:51], 0 glc
    s_load_dwordx8 s[72:79], s[50:51], 128 glc
    s_load_dwordx8 s[80:87], s[50:51], 256 glc
    s_load_dwordx8 s[88:95], s[50:51], 384 glc
    s_barrier
    s_barrier
    s_mov_b32 s48, 65536
poll_10:
    s_waitcnt lgkmcnt(0)
    s_cmp_lg_u64 s[64:65], s[0:1]
    s_cselect_b32 s49, 1, 0
    s_cmp_lg_u64 s[66:67], s[0:1]
    s_cselect_b32 s49, 1, s49
    s_cmp_lg_u64 s[68:69], s[0:1]
    s_cselect_b32 s49, 1, s49
    s_cmp_lg_u64 s[70:71], s[0:1]
    s_cselect_b32 s49, 1, s49
    s_cmp_lg_u64 s[72:73], s[0:1]
    s_cselect_b32 s49, 1, s49
    s_cmp_lg_u64 s[74:75], s[0:1]
    s_cselect_b32 s49, 1, s49
    s_cmp_lg_u64 s[76:77], s[0:1]
    s_cselect_b32 s49, 1, s49
    s_cmp_lg_u64 s[78:79], s[0:1]
    s_cselect_b32 s49, 1, s49
    s_cmp_lg_u64 s[80:81], s[0:1]
    s_cselect_b32 s49, 1, s49
    s_cmp_lg_u64 s[82:83], s[0:1]
    s_cselect_b32 s49, 1, s49
    s_cmp_lg_u64 s[84:85], s[0:1]
    s_cselect_b32 s49, 1, s49
    s_cmp_lg_u64 s[86:87], s[0:1]
    s_cselect_b32 s49, 1, s49
    s_cmp_lg_u64 s[88:89], s[0:1]
    s_cselect_b32 s49, 1, s49
    s_cmp_lg_u64 s[90:91], s[0:1]
    s_cselect_b32 s49, 1, s49
    s_cmp_lg_u64 s[92:93], s[0:1]
    s_cselect_b32 s49, 1, s49
    s_cmp_lg_u64 s[94:95], s[0:1]
    s_cselect_b32 s49, 1, s49
    s_cmp_eq_u32 s49, 0
    s_cbranch_scc1 polld_11
    s_sub_u32 s48, s48, 1
    s_cmp_eq_u32 s48, 0
    s_cbranch_scc1 polld_11
    s_load_dwordx8 s[64:71], s[50:51], 0 glc
    s_load_dwordx8 s[72:79], s[50:51], 128 glc
    s_load_dwordx8 s[80:87], s[50:51], 256 glc
    s_load_dwordx8 s[88:95], s[50:51], 384 glc
    s_branch poll_10
polld_11:
    s_add_u32 s29, s29, 1
    s_and_b32 s29, s29, 7
    s_lshl_b32 s52, s29, 5
    s_add_u32 s52, s52, s6
    s_lshl_b32 s52, s52, 9
    s_add_u32 s52, s52, 524288
    s_add_u32 s50, s44, s52
    s_addc_u32 s51, s45, 0
    s_load_dwordx8 s[64:71], s[50:51], 0 glc
    s_load_dwordx8 s[72:79], s[50:51], 128 glc
    s_load_dwordx8 s[80:87], s[50:51], 256 glc
    s_load_dwordx8 s[88:95], s[50:51], 384 glc
    s_barrier
    s_barrier
    s_mov_b32 s48, 65536
poll_12:
    s_waitcnt lgkmcnt(0)
    s_cmp_lg_u64 s[64:65], s[0:1]
    s_cselect_b32 s49, 1, 0
    s_cmp_lg_u64 s[66:67], s[0:1]
    s_cselect_b32 s49, 1, s49
    s_cmp_lg_u64 s[68:69], s[0:1]
    s_cselect_b32 s49, 1, s49
    s_cmp_lg_u64 s[70:71], s[0:1]
    s_cselect_b32 s49, 1, s49
    s_cmp_lg_u64 s[72:73], s[0:1]
    s_cselect_b32 s49, 1, s49
    s_cmp_lg_u64 s[74:75], s[0:1]
    s_cselect_b32 s49, 1, s49
    s_cmp_lg_u64 s[76:77], s[0:1]
    s_cselect_b32 s49, 1, s49
    s_cmp_lg_u64 s[78:79], s[0:1]
    s_cselect_b32 s49, 1, s49
    s_cmp_lg_u64 s[80:81], s[0:1]
    s_cselect_b32 s49, 1, s49
    s_cmp_lg_u64 s[82:83], s[0:1]
    s_cselect_b32 s49, 1, s49
    s_cmp_lg_u64 s[84:85], s[0:1]
    s_cselect_b32 s49, 1, s49
    s_cmp_lg_u64 s[86:87], s[0:1]
    s_cselect_b32 s49, 1, s49
    s_cmp_lg_u64 s[88:89], s[0:1]
    s_cselect_b32 s49, 1, s49
    s_cmp_lg_u64 s[90:91], s[0:1]
    s_cselect_b32 s49, 1, s49
    s_cmp_lg_u64 s[92:93], s[0:1]
    s_cselect_b32 s49, 1, s49
    s_cmp_lg_u64 s[94:95], s[0:1]
    s_cselect_b32 s49, 1, s49
    s_cmp_eq_u32 s49, 0
    s_cbranch_scc1 polld_13
    s_sub_u32 s48, s48, 1
    s_cmp_eq_u32 s48, 0
    s_cbranch_scc1 polld_13
    s_load_dwordx8 s[64:71], s[50:51], 0 glc
    s_load_dwordx8 s[72:79], s[50:51], 128 glc
    s_load_dwordx8 s[80:87], s[50:51], 256 glc
    s_load_dwordx8 s[88:95], s[50:51], 384 glc
    s_branch poll_12
polld_13:
    s_add_u32 s29, s29, 1
    s_and_b32 s29, s29, 7
    s_lshl_b32 s52, s29, 5
    s_add_u32 s52, s52, s6
    s_lshl_b32 s52, s52, 9
    s_add_u32 s52, s52, 524288
    s_add_u32 s50, s44, s52
    s_addc_u32 s51, s45, 0
    s_load_dwordx8 s[64:71], s[50:51], 0 glc
    s_load_dwordx8 s[72:79], s[50:51], 128 glc
    s_load_dwordx8 s[80:87], s[50:51], 256 glc
    s_load_dwordx8 s[88:95], s[50:51], 384 glc
    s_barrier
    s_barrier
    s_mov_b32 s48, 65536
poll_14:
    s_waitcnt lgkmcnt(0)
    s_cmp_lg_u64 s[64:65], s[0:1]
    s_cselect_b32 s49, 1, 0
    s_cmp_lg_u64 s[66:67], s[0:1]
    s_cselect_b32 s49, 1, s49
    s_cmp_lg_u64 s[68:69], s[0:1]
    s_cselect_b32 s49, 1, s49
    s_cmp_lg_u64 s[70:71], s[0:1]
    s_cselect_b32 s49, 1, s49
    s_cmp_lg_u64 s[72:73], s[0:1]
    s_cselect_b32 s49, 1, s49
    s_cmp_lg_u64 s[74:75], s[0:1]
    s_cselect_b32 s49, 1, s49
    s_cmp_lg_u64 s[76:77], s[0:1]
    s_cselect_b32 s49, 1, s49
    s_cmp_lg_u64 s[78:79], s[0:1]
    s_cselect_b32 s49, 1, s49
    s_cmp_lg_u64 s[80:81], s[0:1]
    s_cselect_b32 s49, 1, s49
    s_cmp_lg_u64 s[82:83], s[0:1]
    s_cselect_b32 s49, 1, s49
    s_cmp_lg_u64 s[84:85], s[0:1]
    s_cselect_b32 s49, 1, s49
    s_cmp_lg_u64 s[86:87], s[0:1]
    s_cselect_b32 s49, 1, s49
    s_cmp_lg_u64 s[88:89], s[0:1]
    s_cselect_b32 s49, 1, s49
    s_cmp_lg_u64 s[90:91], s[0:1]
    s_cselect_b32 s49, 1, s49
    s_cmp_lg_u64 s[92:93], s[0:1]
    s_cselect_b32 s49, 1, s49
    s_cmp_lg_u64 s[94:95], s[0:1]
    s_cselect_b32 s49, 1, s49
    s_cmp_eq_u32 s49, 0
    s_cbranch_scc1 polld_15
    s_sub_u32 s48, s48, 1
    s_cmp_eq_u32 s48, 0
    s_cbranch_scc1 polld_15
    s_load_dwordx8 s[64:71], s[50:51], 0 glc
    s_load_dwordx8 s[72:79], s[50:51], 128 glc
    s_load_dwordx8 s[80:87], s[50:51], 256 glc
    s_load_dwordx8 s[88:95], s[50:51], 384 glc
    s_branch poll_14
polld_15:
    s_add_u32 s29, s29, 1
    s_and_b32 s29, s29, 7
    s_lshl_b32 s52, s29, 5
    s_add_u32 s52, s52, s6
    s_lshl_b32 s52, s52, 9
    s_add_u32 s52, s52, 524288
    s_add_u32 s50, s44, s52
    s_addc_u32 s51, s45, 0
    s_load_dwordx8 s[64:71], s[50:51], 0 glc
    s_load_dwordx8 s[72:79], s[50:51], 128 glc
    s_load_dwordx8 s[80:87], s[50:51], 256 glc
    s_load_dwordx8 s[88:95], s[50:51], 384 glc
    s_barrier
    s_barrier
    s_mov_b32 s48, 65536
poll_16:
    s_waitcnt lgkmcnt(0)
    s_cmp_lg_u64 s[64:65], s[0:1]
    s_cselect_b32 s49, 1, 0
    s_cmp_lg_u64 s[66:67], s[0:1]
    s_cselect_b32 s49, 1, s49
    s_cmp_lg_u64 s[68:69], s[0:1]
    s_cselect_b32 s49, 1, s49
    s_cmp_lg_u64 s[70:71], s[0:1]
    s_cselect_b32 s49, 1, s49
    s_cmp_lg_u64 s[72:73], s[0:1]
    s_cselect_b32 s49, 1, s49
    s_cmp_lg_u64 s[74:75], s[0:1]
    s_cselect_b32 s49, 1, s49
    s_cmp_lg_u64 s[76:77], s[0:1]
    s_cselect_b32 s49, 1, s49
    s_cmp_lg_u64 s[78:79], s[0:1]
    s_cselect_b32 s49, 1, s49
    s_cmp_lg_u64 s[80:81], s[0:1]
    s_cselect_b32 s49, 1, s49
    s_cmp_lg_u64 s[82:83], s[0:1]
    s_cselect_b32 s49, 1, s49
    s_cmp_lg_u64 s[84:85], s[0:1]
    s_cselect_b32 s49, 1, s49
    s_cmp_lg_u64 s[86:87], s[0:1]
    s_cselect_b32 s49, 1, s49
    s_cmp_lg_u64 s[88:89], s[0:1]
    s_cselect_b32 s49, 1, s49
    s_cmp_lg_u64 s[90:91], s[0:1]
    s_cselect_b32 s49, 1, s49
    s_cmp_lg_u64 s[92:93], s[0:1]
    s_cselect_b32 s49, 1, s49
    s_cmp_lg_u64 s[94:95], s[0:1]
    s_cselect_b32 s49, 1, s49
    s_cmp_eq_u32 s49, 0
    s_cbranch_scc1 polld_17
    s_sub_u32 s48, s48, 1
    s_cmp_eq_u32 s48, 0
    s_cbranch_scc1 polld_17
    s_load_dwordx8 s[64:71], s[50:51], 0 glc
    s_load_dwordx8 s[72:79], s[50:51], 128 glc
    s_load_dwordx8 s[80:87], s[50:51], 256 glc
    s_load_dwordx8 s[88:95], s[50:51], 384 glc
    s_branch poll_16
polld_17:
    s_add_u32 s29, s29, 1
    s_and_b32 s29, s29, 7
    s_lshl_b32 s52, s29, 5
    s_add_u32 s52, s52, s6
    s_lshl_b32 s52, s52, 9
    s_add_u32 s52, s52, 524288
    s_add_u32 s50, s44, s52
    s_addc_u32 s51, s45, 0
    s_load_dwordx8 s[64:71], s[50:51], 0 glc
    s_load_dwordx8 s[72:79], s[50:51], 128 glc
    s_load_dwordx8 s[80:87], s[50:51], 256 glc
    s_load_dwordx8 s[88:95], s[50:51], 384 glc
    s_barrier
    s_barrier
    s_mov_b32 s48, 65536
poll_18:
    s_waitcnt lgkmcnt(0)
    s_cmp_lg_u64 s[64:65], s[0:1]
    s_cselect_b32 s49, 1, 0
    s_cmp_lg_u64 s[66:67], s[0:1]
    s_cselect_b32 s49, 1, s49
    s_cmp_lg_u64 s[68:69], s[0:1]
    s_cselect_b32 s49, 1, s49
    s_cmp_lg_u64 s[70:71], s[0:1]
    s_cselect_b32 s49, 1, s49
    s_cmp_lg_u64 s[72:73], s[0:1]
    s_cselect_b32 s49, 1, s49
    s_cmp_lg_u64 s[74:75], s[0:1]
    s_cselect_b32 s49, 1, s49
    s_cmp_lg_u64 s[76:77], s[0:1]
    s_cselect_b32 s49, 1, s49
    s_cmp_lg_u64 s[78:79], s[0:1]
    s_cselect_b32 s49, 1, s49
    s_cmp_lg_u64 s[80:81], s[0:1]
    s_cselect_b32 s49, 1, s49
    s_cmp_lg_u64 s[82:83], s[0:1]
    s_cselect_b32 s49, 1, s49
    s_cmp_lg_u64 s[84:85], s[0:1]
    s_cselect_b32 s49, 1, s49
    s_cmp_lg_u64 s[86:87], s[0:1]
    s_cselect_b32 s49, 1, s49
    s_cmp_lg_u64 s[88:89], s[0:1]
    s_cselect_b32 s49, 1, s49
    s_cmp_lg_u64 s[90:91], s[0:1]
    s_cselect_b32 s49, 1, s49
    s_cmp_lg_u64 s[92:93], s[0:1]
    s_cselect_b32 s49, 1, s49
    s_cmp_lg_u64 s[94:95], s[0:1]
    s_cselect_b32 s49, 1, s49
    s_cmp_eq_u32 s49, 0
    s_cbranch_scc1 polld_19
    s_sub_u32 s48, s48, 1
    s_cmp_eq_u32 s48, 0
    s_cbranch_scc1 polld_19
    s_load_dwordx8 s[64:71], s[50:51], 0 glc
    s_load_dwordx8 s[72:79], s[50:51], 128 glc
    s_load_dwordx8 s[80:87], s[50:51], 256 glc
    s_load_dwordx8 s[88:95], s[50:51], 384 glc
    s_branch poll_18
polld_19:
    s_add_u32 s29, s29, 1
    s_and_b32 s29, s29, 7
    s_lshl_b32 s52, s29, 5
    s_add_u32 s52, s52, s6
    s_lshl_b32 s52, s52, 9
    s_add_u32 s52, s52, 524288
    s_add_u32 s50, s44, s52
    s_addc_u32 s51, s45, 0
    s_load_dwordx8 s[64:71], s[50:51], 0 glc
    s_load_dwordx8 s[72:79], s[50:51], 128 glc
    s_load_dwordx8 s[80:87], s[50:51], 256 glc
    s_load_dwordx8 s[88:95], s[50:51], 384 glc
    s_barrier
    s_barrier
    s_mov_b32 s48, 65536
poll_20:
    s_waitcnt lgkmcnt(0)
    s_cmp_lg_u64 s[64:65], s[0:1]
    s_cselect_b32 s49, 1, 0
    s_cmp_lg_u64 s[66:67], s[0:1]
    s_cselect_b32 s49, 1, s49
    s_cmp_lg_u64 s[68:69], s[0:1]
    s_cselect_b32 s49, 1, s49
    s_cmp_lg_u64 s[70:71], s[0:1]
    s_cselect_b32 s49, 1, s49
    s_cmp_lg_u64 s[72:73], s[0:1]
    s_cselect_b32 s49, 1, s49
    s_cmp_lg_u64 s[74:75], s[0:1]
    s_cselect_b32 s49, 1, s49
    s_cmp_lg_u64 s[76:77], s[0:1]
    s_cselect_b32 s49, 1, s49
    s_cmp_lg_u64 s[78:79], s[0:1]
    s_cselect_b32 s49, 1, s49
    s_cmp_lg_u64 s[80:81], s[0:1]
    s_cselect_b32 s49, 1, s49
    s_cmp_lg_u64 s[82:83], s[0:1]
    s_cselect_b32 s49, 1, s49
    s_cmp_lg_u64 s[84:85], s[0:1]
    s_cselect_b32 s49, 1, s49
    s_cmp_lg_u64 s[86:87], s[0:1]
    s_cselect_b32 s49, 1, s49
    s_cmp_lg_u64 s[88:89], s[0:1]
    s_cselect_b32 s49, 1, s49
    s_cmp_lg_u64 s[90:91], s[0:1]
    s_cselect_b32 s49, 1, s49
    s_cmp_lg_u64 s[92:93], s[0:1]
    s_cselect_b32 s49, 1, s49
    s_cmp_lg_u64 s[94:95], s[0:1]
    s_cselect_b32 s49, 1, s49
    s_cmp_eq_u32 s49, 0
    s_cbranch_scc1 polld_21
    s_sub_u32 s48, s48, 1
    s_cmp_eq_u32 s48, 0
    s_cbranch_scc1 polld_21
    s_load_dwordx8 s[64:71], s[50:51], 0 glc
    s_load_dwordx8 s[72:79], s[50:51], 128 glc
    s_load_dwordx8 s[80:87], s[50:51], 256 glc
    s_load_dwordx8 s[88:95], s[50:51], 384 glc
    s_branch poll_20
polld_21:
    s_barrier
    s_barrier
    s_barrier
    s_barrier
    s_barrier
    s_barrier
    s_barrier
    s_barrier
    s_barrier
    s_barrier
    s_barrier
    s_barrier
    s_getpc_b64 s[40:41]
pc_22:
    s_lshl_b32 s3, s6, 9
    s_min_u32 s3, s3, L_g2_tail-L_g1_done-512
    s_sub_u32 s40, s40, pc_22-L_g1_done
    s_subb_u32 s41, s41, 0
    s_add_u32 s40, s40, s3
    s_addc_u32 s41, s41, 0
    s_load_dword s42, s[40:41], 0
    s_load_dword s42, s[40:41], 64
    s_load_dword s42, s[40:41], 128
    s_load_dword s42, s[40:41], 192
    s_load_dword s42, s[40:41], 256
    s_load_dword s42, s[40:41], 320
    s_load_dword s42, s[40:41], 384
    s_load_dword s42, s[40:41], 448
    s_barrier
    s_barrier
    s_getpc_b64 s[40:41]
pc_23:
    s_lshl_b32 s3, s6, 9
    s_min_u32 s3, s3, L_att-L_aux7-512
    s_sub_u32 s40, s40, pc_23-L_aux7
    s_subb_u32 s41, s41, 0
    s_add_u32 s40, s40, s3
    s_addc_u32 s41, s41, 0
    s_load_dword s42, s[40:41], 0
    s_load_dword s42, s[40:41], 64
    s_load_dword s42, s[40:41], 128
    s_load_dword s42, s[40:41], 192
    s_load_dword s42, s[40:41], 256
    s_load_dword s42, s[40:41], 320
    s_load_dword s42, s[40:41], 384
    s_load_dword s42, s[40:41], 448
    s_barrier
    s_barrier
    s_barrier
    s_barrier
    s_bfe_u32 s57, s100, 262144
    s_mul_i32 s57, s57, 393216
    s_add_u32 s57, s57, s9
    s_add_u32 m0, s63, 61440
    s_nop 0
    buffer_load_dwordx4 v11, s[32:35], s57 offen offset:0 lds
    buffer_load_dwordx4 v12, s[32:35], s57 offen offset:1024 lds
    s_add_u32 s57, s57, 131072
    s_add_u32 m0, s63, 69632
    s_nop 0
    buffer_load_dwordx4 v11, s[32:35], s57 offen offset:0 lds
    buffer_load_dwordx4 v12, s[32:35], s57 offen offset:1024 lds
    s_add_u32 s57, s57, 131072
    s_add_u32 m0, s63, 77824
    s_nop 0
    buffer_load_dwordx4 v11, s[32:35], s57 offen offset:0 lds
    buffer_load_dwordx4 v12, s[32:35], s57 offen offset:1024 lds
    s_add_u32 s57, s57, 131072
    s_bfe_u32 s57, s100, 262148
    s_mul_i32 s57, s57, 393216
    s_add_u32 s57, s57, s9
    s_add_u32 m0, s63, 86016
    s_nop 0
    buffer_load_dwordx4 v11, s[32:35], s57 offen offset:0 lds
    buffer_load_dwordx4 v12, s[32:35], s57 offen offset:1024 lds
    s_add_u32 s57, s57, 131072
    s_barrier
    s_cmp_lg_u32 s2, 0
    s_cbranch_scc1 L_noepoch
    s_mov_b32 s3, 0
    v_mov_b32 v20, s7
    s_mov_b64 exec, 1
    buffer_store_dword v20, off, s[44:47], s3 sc1
    s_mov_b64 exec, -1
L_noepoch:
L_aux_g1done:
    s_setprio 3
    s_barrier
    s_cmp_eq_u32 s4, 7
    s_cbranch_scc1 L_nosh
    ds_read_b128 v[24:27], v60
    ds_read_b128 v[32:35], v60 offset:3072
    ds_read_b128 v[28:31], v61
    ds_read_b128 v[36:39], v61 offset:3072
    s_waitcnt lgkmcnt(0)
    v_pk_add_f32 v[24:25], v[24:25], v[32:33]
    v_pk_add_f32 v[26:27], v[26:27], v[34:35]
    v_pk_add_f32 v[28:29], v[28:29], v[36:37]
    v_pk_add_f32 v[30:31], v[30:31], v[38:39]
    v_pk_mul_f32 v[44:45], v[24:25], v[24:25]
    v_pk_mul_f32 v[46:47], v[26:27], v[26:27]
    v_pk_mul_f32 v[48:49], v[28:29], v[28:29]
    v_pk_mul_f32 v[50:51], v[30:31], v[30:31]
    v_pk_fma_f32 v[44:45], v[44:45], v[64:65], v[66:67]
    v_pk_fma_f32 v[46:47], v[46:47], v[64:65], v[66:67]
    v_pk_fma_f32 v[48:49], v[48:49], v[64:65], v[66:67]
    v_pk_fma_f32 v[50:51], v[50:51], v[64:65], v[66:67]
    v_pk_mul_f32 v[44:45], v[44:45], v[24:25]
    v_pk_mul_f32 v[46:47], v[46:47], v[26:27]
    v_pk_mul_f32 v[48:49], v[48:49], v[28:29]
    v_pk_mul_f32 v[50:51], v[50:51], v[30:31]
    v_exp_f32 v44, v44
    v_exp_f32 v45, v45
    v_exp_f32 v46, v46
    v_exp_f32 v47, v47
    v_exp_f32 v48, v48
    v_exp_f32 v49, v49
    v_exp_f32 v50, v50
    v_exp_f32 v51, v51
    v_pk_add_f32 v[44:45], v[44:45], 1.0 op_sel_hi:[1,0]
    v_pk_add_f32 v[46:47], v[46:47], 1.0 op_sel_hi:[1,0]
    v_pk_add_f32 v[48:49], v[48:49], 1.0 op_sel_hi:[1,0]
    v_pk_add_f32 v[50:51], v[50:51], 1.0 op_sel_hi:[1,0]
    v_rcp_f32 v44, v44
    v_rcp_f32 v45, v45
    v_rcp_f32 v46, v46
    v_rcp_f32 v47, v47
    v_rcp_f32 v48, v48
    v_rcp_f32 v49, v49
    v_rcp_f32 v50, v50
    v_rcp_f32 v51, v51
    v_pk_mul_f32 v[44:45], v[44:45], v[24:25]
    v_pk_mul_f32 v[46:47], v[46:47], v[26:27]
    v_pk_mul_f32 v[48:49], v[48:49], v[28:29]
    v_pk_mul_f32 v[50:51], v[50:51], v[30:31]
    v_cvt_pk_bf16_f32 v32, v44, v45
    v_cvt_pk_bf16_f32 v33, v46, v47
    v_cvt_pk_bf16_f32 v34, v48, v49
    v_cvt_pk_bf16_f32 v35, v50, v51
    buffer_store_dwordx4 v[32:35], v62, s[44:47], s96 offen sc1
L_nosh:
    s_setprio 0
    s_waitcnt vmcnt(0)
    s_and_b32 s3, s5, 1
    s_lshl_b32 s3, s3, 7
    s_add_u32 s12, s98, s3
    s_addc_u32 s13, s99, 0
    s_xor_b32 s3, s3, 128
    s_add_u32 s14, s98, s3
    s_addc_u32 s15, s99, 0
    s_barrier
    s_load_dwordx4 s[16:19], s[12:13], 0 glc
    s_load_dwordx4 s[28:31], s[12:13], 256 glc
    s_mov_b32 s48, 65536
poll_24:
    s_waitcnt lgkmcnt(0)
    s_cmp_lg_u64 s[16:17], s[0:1]
    s_cselect_b32 s49, 1, 0
    s_cmp_lg_u64 s[18:19], s[0:1]
    s_cselect_b32 s49, 1, s49
    s_cmp_lg_u64 s[28:29], s[0:1]
    s_cselect_b32 s49, 1, s49
    s_cmp_lg_u64 s[30:31], s[0:1]
    s_cselect_b32 s49, 1, s49
    s_cmp_eq_u32 s49, 0
    s_cbranch_scc1 polld_25
    s_sub_u32 s48, s48, 1
    s_cmp_eq_u32 s48, 0
    s_cbranch_scc1 polld_25
    s_load_dwordx4 s[16:19], s[12:13], 0 glc
    s_load_dwordx4 s[28:31], s[12:13], 256 glc
    s_branch poll_24
polld_25:
    s_bfe_u32 s56, s100, 262144
    s_mul_i32 s56, s56, 110592
    s_add_u32 s56, s56, s8
    s_add_u32 m0, s61, 0
    s_nop 0
    buffer_load_dwordx4 v10, s[44:47], s56 offen offset:0 sc1 lds
    buffer_load_dwordx4 v10, s[44:47], s56 offen offset:1024 sc1 lds
    buffer_load_dwordx4 v10, s[44:47], s56 offen offset:2048 sc1 lds
    s_add_u32 s56, s56, 36864
    s_add_u32 m0, s61, 12544
    s_nop 0
    buffer_load_dwordx4 v10, s[44:47], s56 offen offset:0 sc1 lds
    buffer_load_dwordx4 v10, s[44:47], s56 offen offset:1024 sc1 lds
    buffer_load_dwordx4 v10, s[44:47], s56 offen offset:2048 sc1 lds
    s_add_u32 s56, s56, 36864
    s_add_u32 m0, s61, 25088
    s_nop 0
    buffer_load_dwordx4 v10, s[44:47], s56 offen offset:0 sc1 lds
    buffer_load_dwordx4 v10, s[44:47], s56 offen offset:1024 sc1 lds
    buffer_load_dwordx4 v10, s[44:47], s56 offen offset:2048 sc1 lds
    s_add_u32 s56, s56, 36864
    s_bfe_u32 s56, s100, 262148
    s_mul_i32 s56, s56, 110592
    s_add_u32 s56, s56, s8
    s_add_u32 m0, s61, 37632
    s_nop 0
    buffer_load_dwordx4 v10, s[44:47], s56 offen offset:0 sc1 lds
    buffer_load_dwordx4 v10, s[44:47], s56 offen offset:1024 sc1 lds
    buffer_load_dwordx4 v10, s[44:47], s56 offen offset:2048 sc1 lds
    s_add_u32 s56, s56, 36864
    s_lshl_b32 s52, s60, 2
    s_add_u32 s52, s52, s58
    s_lshl_b32 s52, s52, 7
    s_add_u32 s52, s52, 32768
    s_add_u32 s50, s44, s52
    s_addc_u32 s51, s45, 0
    s_mul_i32 s36, s58, 144
    s_lshl_b32 s3, s53, 3
    s_add_u32 s36, s36, s3
    s_mul_i32 s36, s36, 1152
    s_mul_i32 s3, s59, 384
    s_add_u32 s36, s36, s3
    s_lshl_b32 s37, s60, 1
    s_lshr_b32 s3, s53, 1
    s_add_u32 s37, s37, s3
    s_lshl_b32 s37, s37, 3
    s_and_b32 s3, s53, 1
    s_add_u32 s37, s37, s3
    s_mul_i32 s37, s37, 9216
    s_mul_i32 s3, s58, 2304
    s_add_u32 s37, s37, s3
    s_add_u32 s37, s37, 10485760
    s_mul_i32 s54, s53, 2432
    s_add_u32 s54, s54, 50176
    s_waitcnt vmcnt(6)
    s_barrier
    s_add_u32 m0, s61, 122880
    s_nop 0
    buffer_load_dwordx4 v10, s[44:47], s56 offen offset:0 sc1 lds
    buffer_load_dwordx4 v10, s[44:47], s56 offen offset:1024 sc1 lds
    buffer_load_dwordx4 v10, s[44:47], s56 offen offset:2048 sc1 lds
    s_add_u32 s56, s56, 36864
    s_add_u32 m0, s63, 94208
    s_nop 0
    buffer_load_dwordx4 v11, s[32:35], s57 offen offset:0 lds
    buffer_load_dwordx4 v12, s[32:35], s57 offen offset:1024 lds
    s_add_u32 s57, s57, 131072
    s_add_u32 m0, s61, 135424
    s_nop 0
    buffer_load_dwordx4 v10, s[44:47], s56 offen offset:0 sc1 lds
    buffer_load_dwordx4 v10, s[44:47], s56 offen offset:1024 sc1 lds
    buffer_load_dwordx4 v10, s[44:47], s56 offen offset:2048 sc1 lds
    s_add_u32 s56, s56, 36864
    s_add_u32 m0, s63, 102400
    s_nop 0
    buffer_load_dwordx4 v11, s[32:35], s57 offen offset:0 lds
    buffer_load_dwordx4 v12, s[32:35], s57 offen offset:1024 lds
    s_add_u32 s57, s57, 131072
    s_waitcnt vmcnt(10)
    s_barrier
    s_bfe_u32 s56, s100, 262152
    s_mul_i32 s56, s56, 110592
    s_add_u32 s56, s56, s8
    s_add_u32 m0, s61, 0
    s_nop 0
    buffer_load_dwordx4 v10, s[44:47], s56 offen offset:0 sc1 lds
    buffer_load_dwordx4 v10, s[44:47], s56 offen offset:1024 sc1 lds
    buffer_load_dwordx4 v10, s[44:47], s56 offen offset:2048 sc1 lds
    s_add_u32 s56, s56, 36864
    s_bfe_u32 s57, s100, 262152
    s_mul_i32 s57, s57, 393216
    s_add_u32 s57, s57, s9
    s_add_u32 m0, s63, 61440
    s_nop 0
    buffer_load_dwordx4 v11, s[32:35], s57 offen offset:0 lds
    buffer_load_dwordx4 v12, s[32:35], s57 offen offset:1024 lds
    s_add_u32 s57, s57, 131072
    s_add_u32 m0, s61, 12544
    s_nop 0
    buffer_load_dwordx4 v10, s[44:47], s56 offen offset:0 sc1 lds
    buffer_load_dwordx4 v10, s[44:47], s56 offen offset:1024 sc1 lds
    buffer_load_dwordx4 v10, s[44:47], s56 offen offset:2048 sc1 lds
    s_add_u32 s56, s56, 36864
    s_add_u32 m0, s63, 69632
    s_nop 0
    buffer_load_dwordx4 v11, s[32:35], s57 offen offset:0 lds
    buffer_load_dwordx4 v12, s[32:35], s57 offen offset:1024 lds
    s_add_u32 s57, s57, 131072
    s_waitcnt vmcnt(10)
    s_barrier
    s_add_u32 m0, s61, 25088
    s_nop 0
    buffer_load_dwordx4 v10, s[44:47], s56 offen offset:0 sc1 lds
    buffer_load_dwordx4 v10, s[44:47], s56 offen offset:1024 sc1 lds
    buffer_load_dwordx4 v10, s[44:47], s56 offen offset:2048 sc1 lds
    s_add_u32 s56, s56, 36864
    s_add_u32 m0, s63, 77824
    s_nop 0
    buffer_load_dwordx4 v11, s[32:35], s57 offen offset:0 lds
    buffer_load_dwordx4 v12, s[32:35], s57 offen offset:1024 lds
    s_add_u32 s57, s57, 131072
    s_bfe_u32 s56, s100, 262156
    s_mul_i32 s56, s56, 110592
    s_add_u32 s56, s56, s8
    s_add_u32 m0, s61, 37632
    s_nop 0
    buffer_load_dwordx4 v10, s[44:47], s56 offen offset:0 sc1 lds
    buffer_load_dwordx4 v10, s[44:47], s56 offen offset:1024 sc1 lds
    buffer_load_dwordx4 v10, s[44:47], s56 offen offset:2048 sc1 lds
    s_add_u32 s56, s56, 36864
    s_bfe_u32 s57, s100, 262156
    s_mul_i32 s57, s57, 393216
    s_add_u32 s57, s57, s9
    s_add_u32 m0, s63, 86016
    s_nop 0
    buffer_load_dwordx4 v11, s[32:35], s57 offen offset:0 lds
    buffer_load_dwordx4 v12, s[32:35], s57 offen offset:1024 lds
    s_add_u32 s57, s57, 131072
    s_cmp_lg_u32 s4, 7
    s_cbranch_scc1 nopo_26
    s_load_dwordx4 s[16:19], s[14:15], 0 glc
    s_load_dwordx4 s[28:31], s[14:15], 256 glc
nopo_26:
    s_waitcnt vmcnt(10)
    s_barrier
    s_add_u32 m0, s61, 122880
    s_nop 0
    buffer_load_dwordx4 v10, s[44:47], s56 offen offset:0 sc1 lds
    buffer_load_dwordx4 v10, s[44:47], s56 offen offset:1024 sc1 lds
    buffer_load_dwordx4 v10, s[44:47], s56 offen offset:2048 sc1 lds
    s_add_u32 s56, s56, 36864
    s_add_u32 m0, s63, 94208
    s_nop 0
    buffer_load_dwordx4 v11, s[32:35], s57 offen offset:0 lds
    buffer_load_dwordx4 v12, s[32:35], s57 offen offset:1024 lds
    s_add_u32 s57, s57, 131072
    s_add_u32 m0, s61, 135424
    s_nop 0
    buffer_load_dwordx4 v10, s[44:47], s56 offen offset:0 sc1 lds
    buffer_load_dwordx4 v10, s[44:47], s56 offen offset:1024 sc1 lds
    buffer_load_dwordx4 v10, s[44:47], s56 offen offset:2048 sc1 lds
    s_add_u32 s56, s56, 36864
    s_add_u32 m0, s63, 102400
    s_nop 0
    buffer_load_dwordx4 v11, s[32:35], s57 offen offset:0 lds
    buffer_load_dwordx4 v12, s[32:35], s57 offen offset:1024 lds
    s_add_u32 s57, s57, 131072
    s_cmp_lg_u32 s4, 7
    s_cbranch_scc1 nopo_27
    s_mov_b32 s48, 65536
poll_28:
    s_waitcnt lgkmcnt(0)
    s_cmp_lg_u64 s[16:17], s[0:1]
    s_cselect_b32 s49, 1, 0
    s_cmp_lg_u64 s[18:19], s[0:1]
    s_cselect_b32 s49, 1, s49
    s_cmp_lg_u64 s[28:29], s[0:1]
    s_cselect_b32 s49, 1, s49
    s_cmp_lg_u64 s[30:31], s[0:1]
    s_cselect_b32 s49, 1, s49
    s_cmp_eq_u32 s49, 0
    s_cbranch_scc1 polld_29
    s_sub_u32 s48, s48, 1
    s_cmp_eq_u32 s48, 0
    s_cbranch_scc1 polld_29
    s_load_dwordx4 s[16:19], s[14:15], 0 glc
    s_load_dwordx4 s[28:31], s[14:15], 256 glc
    s_branch poll_28
polld_29:
nopo_27:
    s_waitcnt vmcnt(10)
    s_barrier
    s_bfe_u32 s56, s100, 262160
    s_mul_i32 s56, s56, 110592
    s_add_u32 s56, s56, s8
    s_add_u32 m0, s61, 0
    s_nop 0
    buffer_load_dwordx4 v10, s[44:47], s56 offen offset:0 sc1 lds
    buffer_load_dwordx4 v10, s[44:47], s56 offen offset:1024 sc1 lds
    buffer_load_dwordx4 v10, s[44:47], s56 offen offset:2048 sc1 lds
    s_add_u32 s56, s56, 36864
    s_bfe_u32 s57, s100, 262160
    s_mul_i32 s57, s57, 393216
    s_add_u32 s57, s57, s9
    s_add_u32 m0, s63, 61440
    s_nop 0
    buffer_load_dwordx4 v11, s[32:35], s57 offen offset:0 lds
    buffer_load_dwordx4 v12, s[32:35], s57 offen offset:1024 lds
    s_add_u32 s57, s57, 131072
    s_add_u32 m0, s61, 12544
    s_nop 0
    buffer_load_dwordx4 v10, s[44:47], s56 offen offset:0 sc1 lds
    buffer_load_dwordx4 v10, s[44:47], s56 offen offset:1024 sc1 lds
    buffer_load_dwordx4 v10, s[44:47], s56 offen offset:2048 sc1 lds
    s_add_u32 s56, s56, 36864
    s_add_u32 m0, s63, 69632
    s_nop 0
    buffer_load_dwordx4 v11, s[32:35], s57 offen offset:0 lds
    buffer_load_dwordx4 v12, s[32:35], s57 offen offset:1024 lds
    s_add_u32 s57, s57, 131072
    s_waitcnt vmcnt(10)
    s_barrier
    s_add_u32 m0, s61, 25088
    s_nop 0
    buffer_load_dwordx4 v10, s[44:47], s56 offen offset:0 sc1 lds
    buffer_load_dwordx4 v10, s[44:47], s56 offen offset:1024 sc1 lds
    buffer_load_dwordx4 v10, s[44:47], s56 offen offset:2048 sc1 lds
    s_add_u32 s56, s56, 36864
    s_add_u32 m0, s63, 77824
    s_nop 0
    buffer_load_dwordx4 v11, s[32:35], s57 offen offset:0 lds
    buffer_load_dwordx4 v12, s[32:35], s57 offen offset:1024 lds
    s_add_u32 s57, s57, 131072
    s_bfe_u32 s56, s100, 262164
    s_mul_i32 s56, s56, 110592
    s_add_u32 s56, s56, s8
    s_add_u32 m0, s61, 37632
    s_nop 0
    buffer_load_dwordx4 v10, s[44:47], s56 offen offset:0 sc1 lds
    buffer_load_dwordx4 v10, s[44:47], s56 offen offset:1024 sc1 lds
    buffer_load_dwordx4 v10, s[44:47], s56 offen offset:2048 sc1 lds
    s_add_u32 s56, s56, 36864
    s_bfe_u32 s57, s100, 262164
    s_mul_i32 s57, s57, 393216
    s_add_u32 s57, s57, s9
    s_add_u32 m0, s63, 86016
    s_nop 0
    buffer_load_dwordx4 v11, s[32:35], s57 offen offset:0 lds
    buffer_load_dwordx4 v12, s[32:35], s57 offen offset:1024 lds
    s_add_u32 s57, s57, 131072
    s_waitcnt vmcnt(10)
    s_barrier
    s_add_u32 m0, s61, 122880
    s_nop 0
    buffer_load_dwordx4 v10, s[44:47], s56 offen offset:0 sc1 lds
    buffer_load_dwordx4 v10, s[44:47], s56 offen offset:1024 sc1 lds
    buffer_load_dwordx4 v10, s[44:47], s56 offen offset:2048 sc1 lds
    s_add_u32 s56, s56, 36864
    s_add_u32 m0, s63, 94208
    s_nop 0
    buffer_load_dwordx4 v11, s[32:35], s57 offen offset:0 lds
    buffer_load_dwordx4 v12, s[32:35], s57 offen offset:1024 lds
    s_add_u32 s57, s57, 131072
    s_add_u32 m0, s61, 135424
    s_nop 0
    buffer_load_dwordx4 v10, s[44:47], s56 offen offset:0 sc1 lds
    buffer_load_dwordx4 v10, s[44:47], s56 offen offset:1024 sc1 lds
    buffer_load_dwordx4 v10, s[44:47], s56 offen offset:2048 sc1 lds
    s_add_u32 s56, s56, 36864
    s_add_u32 m0, s63, 102400
    s_nop 0
    buffer_load_dwordx4 v11, s[32:35], s57 offen offset:0 lds
    buffer_load_dwordx4 v12, s[32:35], s57 offen offset:1024 lds
    s_add_u32 s57, s57, 131072
    s_waitcnt vmcnt(10)
    s_barrier
    s_bfe_u32 s56, s100, 262168
    s_mul_i32 s56, s56, 110592
    s_add_u32 s56, s56, s8
    s_add_u32 m0, s61, 0
    s_nop 0
    buffer_load_dwordx4 v10, s[44:47], s56 offen offset:0 sc1 lds
    buffer_load_dwordx4 v10, s[44:47], s56 offen offset:1024 sc1 lds
    buffer_load_dwordx4 v10, s[44:47], s56 offen offset:2048 sc1 lds
    s_add_u32 s56, s56, 36864
    s_bfe_u32 s57, s100, 262168
    s_mul_i32 s57, s57, 393216
    s_add_u32 s57, s57, s9
    s_add_u32 m0, s63, 61440
    s_nop 0
    buffer_load_dwordx4 v11, s[32:35], s57 offen offset:0 lds
    buffer_load_dwordx4 v12, s[32:35], s57 offen offset:1024 lds
    s_add_u32 s57, s57, 131072
    s_add_u32 m0, s61, 12544
    s_nop 0
    buffer_load_dwordx4 v10, s[44:47], s56 offen offset:0 sc1 lds
    buffer_load_dwordx4 v10, s[44:47], s56 offen offset:1024 sc1 lds
    buffer_load_dwordx4 v10, s[44:47], s56 offen offset:2048 sc1 lds
    s_add_u32 s56, s56, 36864
    s_add_u32 m0, s63, 69632
    s_nop 0
    buffer_load_dwordx4 v11, s[32:35], s57 offen offset:0 lds
    buffer_load_dwordx4 v12, s[32:35], s57 offen offset:1024 lds
    s_add_u32 s57, s57, 131072
    s_waitcnt vmcnt(10)
    s_barrier
    s_add_u32 m0, s61, 25088
    s_nop 0
    buffer_load_dwordx4 v10, s[44:47], s56 offen offset:0 sc1 lds
    buffer_load_dwordx4 v10, s[44:47], s56 offen offset:1024 sc1 lds
    buffer_load_dwordx4 v10, s[44:47], s56 offen offset:2048 sc1 lds
    s_add_u32 s56, s56, 36864
    s_add_u32 m0, s63, 77824
    s_nop 0
    buffer_load_dwordx4 v11, s[32:35], s57 offen offset:0 lds
    buffer_load_dwordx4 v12, s[32:35], s57 offen offset:1024 lds
    s_add_u32 s57, s57, 131072
    s_bfe_u32 s56, s100, 262172
    s_mul_i32 s56, s56, 110592
    s_add_u32 s56, s56, s8
    s_add_u32 m0, s61, 37632
    s_nop 0
    buffer_load_dwordx4 v10, s[44:47], s56 offen offset:0 sc1 lds
    buffer_load_dwordx4 v10, s[44:47], s56 offen offset:1024 sc1 lds
    buffer_load_dwordx4 v10, s[44:47], s56 offen offset:2048 sc1 lds
    s_add_u32 s56, s56, 36864
    s_bfe_u32 s57, s100, 262172
    s_mul_i32 s57, s57, 393216
    s_add_u32 s57, s57, s9
    s_add_u32 m0, s63, 86016
    s_nop 0
    buffer_load_dwordx4 v11, s[32:35], s57 offen offset:0 lds
    buffer_load_dwordx4 v12, s[32:35], s57 offen offset:1024 lds
    s_add_u32 s57, s57, 131072
    s_add_u32 m0, s62, 147968
    s_add_u32 s3, s36, 110592
    buffer_load_dwordx4 v15, s[20:23], s3 offen offset:0 lds
    s_cmp_lg_u32 s4, 7
    s_cbranch_scc1 nopo_30
    s_load_dwordx2 s[64:65], s[98:99], 16 glc
    s_load_dwordx2 s[66:67], s[98:99], 144 glc
    s_load_dwordx2 s[68:69], s[98:99], 272 glc
    s_load_dwordx2 s[70:71], s[98:99], 400 glc
nopo_30:
    s_waitcnt vmcnt(11)
    s_barrier
    s_add_u32 m0, s61, 122880
    s_nop 0
    buffer_load_dwordx4 v10, s[44:47], s56 offen offset:0 sc1 lds
    buffer_load_dwordx4 v10, s[44:47], s56 offen offset:1024 sc1 lds
    buffer_load_dwordx4 v10, s[44:47], s56 offen offset:2048 sc1 lds
    s_add_u32 s56, s56, 36864
    s_add_u32 m0, s63, 94208
    s_nop 0
    buffer_load_dwordx4 v11, s[32:35], s57 offen offset:0 lds
    buffer_load_dwordx4 v12, s[32:35], s57 offen offset:1024 lds
    s_add_u32 s57, s57, 131072
    s_add_u32 m0, s61, 135424
    s_nop 0
    buffer_load_dwordx4 v10, s[44:47], s56 offen offset:0 sc1 lds
    buffer_load_dwordx4 v10, s[44:47], s56 offen offset:1024 sc1 lds
    buffer_load_dwordx4 v10, s[44:47], s56 offen offset:2048 sc1 lds
    s_add_u32 s56, s56, 36864
    s_add_u32 m0, s63, 102400
    s_nop 0
    buffer_load_dwordx4 v11, s[32:35], s57 offen offset:0 lds
    buffer_load_dwordx4 v12, s[32:35], s57 offen offset:1024 lds
    s_add_u32 s57, s57, 131072
    s_add_u32 m0, s62, 147968
    s_add_u32 s3, s36, 110592
    buffer_load_dwordx4 v16, s[20:23], s3 offen offset:1024 lds
    s_cmp_lg_u32 s4, 7
    s_cbranch_scc1 nopo_31
    s_mov_b32 s48, 65536
poll_32:
    s_waitcnt lgkmcnt(0)
    s_cmp_lg_u64 s[64:65], s[0:1]
    s_cselect_b32 s49, 1, 0
    s_cmp_lg_u64 s[66:67], s[0:1]
    s_cselect_b32 s49, 1, s49
    s_cmp_lg_u64 s[68:69], s[0:1]
    s_cselect_b32 s49, 1, s49
    s_cmp_lg_u64 s[70:71], s[0:1]
    s_cselect_b32 s49, 1, s49
    s_cmp_eq_u32 s49, 0
    s_cbranch_scc1 polld_33
    s_sub_u32 s48, s48, 1
    s_cmp_eq_u32 s48, 0
    s_cbranch_scc1 polld_33
    s_load_dwordx2 s[64:65], s[98:99], 16 glc
    s_load_dwordx2 s[66:67], s[98:99], 144 glc
    s_load_dwordx2 s[68:69], s[98:99], 272 glc
    s_load_dwordx2 s[70:71], s[98:99], 400 glc
    s_branch poll_32
polld_33:
nopo_31:
    s_waitcnt vmcnt(12)
    s_barrier
    s_bfe_u32 s56, s101, 262144
    s_mul_i32 s56, s56, 110592
    s_add_u32 s56, s56, s8
    s_add_u32 m0, s61, 0
    s_nop 0
    buffer_load_dwordx4 v10, s[44:47], s56 offen offset:0 sc1 lds
    buffer_load_dwordx4 v10, s[44:47], s56 offen offset:1024 sc1 lds
    buffer_load_dwordx4 v10, s[44:47], s56 offen offset:2048 sc1 lds
    s_add_u32 s56, s56, 36864
    s_bfe_u32 s57, s101, 262144
    s_mul_i32 s57, s57, 393216
    s_add_u32 s57, s57, s9
    s_add_u32 m0, s63, 61440
    s_nop 0
    buffer_load_dwordx4 v11, s[32:35], s57 offen offset:0 lds
    buffer_load_dwordx4 v12, s[32:35], s57 offen offset:1024 lds
    s_add_u32 s57, s57, 131072
    s_add_u32 m0, s61, 12544
    s_nop 0
    buffer_load_dwordx4 v10, s[44:47], s56 offen offset:0 sc1 lds
    buffer_load_dwordx4 v10, s[44:47], s56 offen offset:1024 sc1 lds
    buffer_load_dwordx4 v10, s[44:47], s56 offen offset:2048 sc1 lds
    s_add_u32 s56, s56, 36864
    s_add_u32 m0, s63, 69632
    s_nop 0
    buffer_load_dwordx4 v11, s[32:35], s57 offen offset:0 lds
    buffer_load_dwordx4 v12, s[32:35], s57 offen offset:1024 lds
    s_add_u32 s57, s57, 131072
    s_add_u32 m0, s62, 147968
    s_add_u32 s3, s36, 110592
    buffer_load_dwordx4 v17, s[20:23], s3 offen offset:2048 lds
    s_waitcnt vmcnt(12)
    s_barrier
    s_add_u32 m0, s61, 25088
    s_nop 0
    buffer_load_dwordx4 v10, s[44:47], s56 offen offset:0 sc1 lds
    buffer_load_dwordx4 v10, s[44:47], s56 offen offset:1024 sc1 lds
    buffer_load_dwordx4 v10, s[44:47], s56 offen offset:2048 sc1 lds
    s_add_u32 s56, s56, 36864
    s_add_u32 m0, s63, 77824
    s_nop 0
    buffer_load_dwordx4 v11, s[32:35], s57 offen offset:0 lds
    buffer_load_dwordx4 v12, s[32:35], s57 offen offset:1024 lds
    s_add_u32 s57, s57, 131072
    s_bfe_u32 s56, s101, 262148
    s_mul_i32 s56, s56, 110592
    s_add_u32 s56, s56, s8
    s_add_u32 m0, s61, 37632
    s_nop 0
    buffer_load_dwordx4 v10, s[44:47], s56 offen offset:0 sc1 lds
    buffer_load_dwordx4 v10, s[44:47], s56 offen offset:1024 sc1 lds
    buffer_load_dwordx4 v10, s[44:47], s56 offen offset:2048 sc1 lds
    s_add_u32 s56, s56, 36864
    s_bfe_u32 s57, s101, 262148
    s_mul_i32 s57, s57, 393216
    s_add_u32 s57, s57, s9
    s_add_u32 m0, s63, 86016
    s_nop 0
    buffer_load_dwordx4 v11, s[32:35], s57 offen offset:0 lds
    buffer_load_dwordx4 v12, s[32:35], s57 offen offset:1024 lds
    s_add_u32 s57, s57, 131072
    s_add_u32 m0, s62, 110592
    s_add_u32 s3, s36, 147456
    buffer_load_dwordx4 v56, s[20:23], s3 offen offset:0 lds
    s_waitcnt vmcnt(12)
    s_barrier
    s_add_u32 m0, s61, 122880
    s_nop 0
    buffer_load_dwordx4 v10, s[44:47], s56 offen offset:0 sc1 lds
    buffer_load_dwordx4 v10, s[44:47], s56 offen offset:1024 sc1 lds
    buffer_load_dwordx4 v10, s[44:47], s56 offen offset:2048 sc1 lds
    s_add_u32 s56, s56, 36864
    s_add_u32 m0, s63, 94208
    s_nop 0
    buffer_load_dwordx4 v11, s[32:35], s57 offen offset:0 lds
    buffer_load_dwordx4 v12, s[32:35], s57 offen offset:1024 lds
    s_add_u32 s57, s57, 131072
    s_add_u32 m0, s61, 135424
    s_nop 0
    buffer_load_dwordx4 v10, s[44:47], s56 offen offset:0 sc1 lds
    buffer_load_dwordx4 v10, s[44:47], s56 offen offset:1024 sc1 lds
    buffer_load_dwordx4 v10, s[44:47], s56 offen offset:2048 sc1 lds
    s_add_u32 s56, s56, 36864
    s_add_u32 m0, s63, 102400
    s_nop 0
    buffer_load_dwordx4 v11, s[32:35], s57 offen offset:0 lds
    buffer_load_dwordx4 v12, s[32:35], s57 offen offset:1024 lds
    s_add_u32 s57, s57, 131072
    s_add_u32 m0, s62, 110592
    s_add_u32 s3, s36, 147456
    buffer_load_dwordx4 v57, s[20:23], s3 offen offset:1024 lds
    s_lshl_b32 s11, s6, 2
    s_add_u32 s11, s11, s53
    s_getpc_b64 s[40:41]
pc_34:
    s_lshl_b32 s3, s11, 9
    s_min_u32 s3, s3, L_aux-L_g2_tail-512
    s_sub_u32 s40, s40, pc_34-L_g2_tail
    s_subb_u32 s41, s41, 0
    s_add_u32 s40, s40, s3
    s_addc_u32 s41, s41, 0
    s_load_dword s42, s[40:41], 0
    s_load_dword s42, s[40:41], 64
    s_load_dword s42, s[40:41], 128
    s_load_dword s42, s[40:41], 192
    s_load_dword s42, s[40:41], 256
    s_load_dword s42, s[40:41], 320
    s_load_dword s42, s[40:41], 384
    s_load_dword s42, s[40:41], 448
    s_waitcnt vmcnt(12)
    s_barrier
    s_bfe_u32 s56, s101, 262152
    s_mul_i32 s56, s56, 110592
    s_add_u32 s56, s56, s8
    s_add_u32 m0, s61, 0
    s_nop 0
    buffer_load_dwordx4 v10, s[44:47], s56 offen offset:0 sc1 lds
    buffer_load_dwordx4 v10, s[44:47], s56 offen offset:1024 sc1 lds
    buffer_load_dwordx4 v10, s[44:47], s56 offen offset:2048 sc1 lds
    s_add_u32 s56, s56, 36864
    s_bfe_u32 s57, s101, 262152
    s_mul_i32 s57, s57, 393216
    s_add_u32 s57, s57, s9
    s_add_u32 m0, s63, 61440
    s_nop 0
    buffer_load_dwordx4 v11, s[32:35], s57 offen offset:0 lds
    buffer_load_dwordx4 v12, s[32:35], s57 offen offset:1024 lds
    s_add_u32 s57, s57, 131072
    s_add_u32 m0, s61, 12544
    s_nop 0
    buffer_load_dwordx4 v10, s[44:47], s56 offen offset:0 sc1 lds
    buffer_load_dwordx4 v10, s[44:47], s56 offen offset:1024 sc1 lds
    buffer_load_dwordx4 v10, s[44:47], s56 offen offset:2048 sc1 lds
    s_add_u32 s56, s56, 36864
    s_add_u32 m0, s63, 69632
    s_nop 0
    buffer_load_dwordx4 v11, s[32:35], s57 offen offset:0 lds
    buffer_load_dwordx4 v12, s[32:35], s57 offen offset:1024 lds
    s_add_u32 s57, s57, 131072
    s_add_u32 m0, s62, 110592
    s_add_u32 s3, s36, 147456
    buffer_load_dwordx4 v58, s[20:23], s3 offen offset:2048 lds
    s_waitcnt vmcnt(12)
    s_barrier
    s_add_u32 m0, s61, 25088
    s_nop 0
    buffer_load_dwordx4 v10, s[44:47], s56 offen offset:0 sc1 lds
    buffer_load_dwordx4 v10, s[44:47], s56 offen offset:1024 sc1 lds
    buffer_load_dwordx4 v10, s[44:47], s56 offen offset:2048 sc1 lds
    s_add_u32 s56, s56, 36864
    s_add_u32 m0, s63, 77824
    s_nop 0
    buffer_load_dwordx4 v11, s[32:35], s57 offen offset:0 lds
    buffer_load_dwordx4 v12, s[32:35], s57 offen offset:1024 lds
    s_add_u32 s57, s57, 131072
    s_bfe_u32 s56, s101, 262156
    s_mul_i32 s56, s56, 110592
    s_add_u32 s56, s56, s8
    s_add_u32 m0, s61, 37632
    s_nop 0
    buffer_load_dwordx4 v10, s[44:47], s56 offen offset:0 sc1 lds
    buffer_load_dwordx4 v10, s[44:47], s56 offen offset:1024 sc1 lds
    buffer_load_dwordx4 v10, s[44:47], s56 offen offset:2048 sc1 lds
    s_add_u32 s56, s56, 36864
    s_bfe_u32 s57, s101, 262156
    s_mul_i32 s57, s57, 393216
    s_add_u32 s57, s57, s9
    s_add_u32 m0, s63, 86016
    s_nop 0
    buffer_load_dwordx4 v11, s[32:35], s57 offen offset:0 lds
    buffer_load_dwordx4 v12, s[32:35], s57 offen offset:1024 lds
    s_add_u32 s57, s57, 131072
    s_waitcnt vmcnt(11)
    s_barrier
    s_add_u32 m0, s61, 122880
    s_nop 0
    buffer_load_dwordx4 v10, s[44:47], s56 offen offset:0 sc1 lds
    buffer_load_dwordx4 v10, s[44:47], s56 offen offset:1024 sc1 lds
    buffer_load_dwordx4 v10, s[44:47], s56 offen offset:2048 sc1 lds
    s_add_u32 s56, s56, 36864
    s_add_u32 m0, s63, 94208
    s_nop 0
    buffer_load_dwordx4 v11, s[32:35], s57 offen offset:0 lds
    buffer_load_dwordx4 v12, s[32:35], s57 offen offset:1024 lds
    s_add_u32 s57, s57, 131072
    s_add_u32 m0, s61, 135424
    s_nop 0
    buffer_load_dwordx4 v10, s[44:47], s56 offen offset:0 sc1 lds
    buffer_load_dwordx4 v10, s[44:47], s56 offen offset:1024 sc1 lds
    buffer_load_dwordx4 v10, s[44:47], s56 offen offset:2048 sc1 lds
    s_add_u32 s56, s56, 36864
    s_add_u32 m0, s63, 102400
    s_nop 0
    buffer_load_dwordx4 v11, s[32:35], s57 offen offset:0 lds
    buffer_load_dwordx4 v12, s[32:35], s57 offen offset:1024 lds
    s_add_u32 s57, s57, 131072
    s_cmp_lg_u32 s4, 7
    s_cbranch_scc1 nopo_35
    s_load_dwordx8 s[64:71], s[50:51], 0 glc
nopo_35:
    s_waitcnt vmcnt(10)
    s_barrier
    s_add_u32 m0, s62, 0
    s_add_u32 s3, s36, 0
    buffer_load_dwordx4 v15, s[20:23], s3 offen offset:0 lds
    buffer_load_dwordx4 v16, s[20:23], s3 offen offset:1024 lds
    buffer_load_dwordx4 v17, s[20:23], s3 offen offset:2048 lds
    s_add_u32 m0, s62, 12544
    s_add_u32 s3, s36, 36864
    buffer_load_dwordx4 v15, s[20:23], s3 offen offset:0 lds
    buffer_load_dwordx4 v16, s[20:23], s3 offen offset:1024 lds
    buffer_load_dwordx4 v17, s[20:23], s3 offen offset:2048 lds
    s_cmp_lg_u32 s4, 7
    s_cbranch_scc1 nopo_36
    s_mov_b32 s48, 65536
poll_37:
    s_waitcnt lgkmcnt(0)
    s_cmp_lg_u64 s[64:65], s[0:1]
    s_cselect_b32 s49, 1, 0
    s_cmp_lg_u64 s[66:67], s[0:1]
    s_cselect_b32 s49, 1, s49
    s_cmp_lg_u64 s[68:69], s[0:1]
    s_cselect_b32 s49, 1, s49
    s_cmp_lg_u64 s[70:71], s[0:1]
    s_cselect_b32 s49, 1, s49
    s_cmp_eq_u32 s49, 0
    s_cbranch_scc1 polld_38
    s_sub_u32 s48, s48, 1
    s_cmp_eq_u32 s48, 0
    s_cbranch_scc1 polld_38
    s_load_dwordx8 s[64:71], s[50:51], 0 glc
    s_branch poll_37
polld_38:
nopo_36:
    s_waitcnt vmcnt(3)
    s_barrier
    s_add_u32 s3, s58, 1
    s_and_b32 s3, s3, 3
    s_mul_i32 s3, s3, 18432
    s_add_u32 m0, s54, 0
    s_add_u32 s3, s3, s37
    buffer_load_dwordx4 v10, s[44:47], s3 offen offset:0 sc1 lds
    buffer_load_dwordx4 v10, s[44:47], s3 offen offset:1024 sc1 lds
    s_mov_b64 exec, 0xffff
    buffer_load_dwordx4 v10, s[44:47], s3 offen offset:2048 sc1 lds
    s_mov_b64 exec, -1
    s_add_u32 m0, s62, 25088
    s_add_u32 s3, s36, 73728
    buffer_load_dwordx4 v15, s[20:23], s3 offen offset:0 lds
    buffer_load_dwordx4 v16, s[20:23], s3 offen offset:1024 lds
    buffer_load_dwordx4 v17, s[20:23], s3 offen offset:2048 lds
    s_add_u32 s3, s58, 2
    s_and_b32 s3, s3, 3
    s_mul_i32 s3, s3, 18432
    s_add_u32 m0, s54, 9728
    s_add_u32 s3, s3, s37
    buffer_load_dwordx4 v10, s[44:47], s3 offen offset:0 sc1 lds
    buffer_load_dwordx4 v10, s[44:47], s3 offen offset:1024 sc1 lds
    s_mov_b64 exec, 0xffff
    buffer_load_dwordx4 v10, s[44:47], s3 offen offset:2048 sc1 lds
    s_mov_b64 exec, -1
    s_add_u32 s3, s58, 3
    s_and_b32 s3, s3, 3
    s_mul_i32 s3, s3, 18432
    s_add_u32 m0, s54, 19456
    s_add_u32 s3, s3, s37
    buffer_load_dwordx4 v10, s[44:47], s3 offen offset:0 sc1 lds
    buffer_load_dwordx4 v10, s[44:47], s3 offen offset:1024 sc1 lds
    s_mov_b64 exec, 0xffff
    buffer_load_dwordx4 v10, s[44:47], s3 offen offset:2048 sc1 lds
    s_mov_b64 exec, -1
    s_add_u32 s3, s58, 4
    s_and_b32 s3, s3, 3
    s_mul_i32 s3, s3, 18432
    s_add_u32 m0, s54, 29184
    s_add_u32 s3, s3, s37
    buffer_load_dwordx4 v10, s[44:47], s3 offen offset:0 sc1 lds
    buffer_load_dwordx4 v10, s[44:47], s3 offen offset:1024 sc1 lds
    s_mov_b64 exec, 0xffff
    buffer_load_dwordx4 v10, s[44:47], s3 offen offset:2048 sc1 lds
    s_mov_b64 exec, -1
    s_waitcnt vmcnt(9)
    s_barrier
    s_waitcnt vmcnt(0)
    s_barrier
    s_branch L_fin
L_att:
    s_cmp_eq_u32 s4, 0
    s_cbranch_scc0 L_att_s0
    s_barrier
L_att_s0:
    s_add_u32 s3, s5, 24
    s_sub_u32 s48, s6, 24
    s_lshl_b32 s52, s48, 5
    s_add_u32 s52, s52, s3
    s_lshl_b32 s52, s52, 9
    s_add_u32 s52, s52, 524288
    s_add_u32 s50, s44, s52
    s_addc_u32 s51, s45, 0
    s_sub_u32 s96, s6, 24
    s_and_b32 s97, s4, 3
    s_lshr_b32 s98, s4, 2
    v_lshrrev_b32 v70, 4, v0
    v_and_b32 v71, 15, v0
    v_mov_b32 v72, 2147418112
    s_cmp_eq_u32 s98, 0
    s_cbranch_scc1 L_att_ph
    v_add_u32 v73, 0, v0
    v_mul_u32_u24 v74, 38837, v73
    v_lshrrev_b32 v74, 20, v74
    v_mul_u32_u24 v76, 27, v74
    v_sub_u32 v75, v73, v76
    v_mul_u32_u24 v77, 116509, v75
    v_lshrrev_b32 v77, 20, v77
    v_mul_u32_u24 v76, 9, v77
    v_sub_u32 v78, v75, v76
    v_mul_u32_u24 v74, 3456, v74
    v_mul_u32_u24 v77, 1152, v77
    v_lshlrev_b32 v78, 4, v78
    v_add3_u32 v74, v74, v77, v78
    v_subrev_u32 v228, 0, v74
    v_add_u32 v73, 64, v0
    v_mul_u32_u24 v74, 38837, v73
    v_lshrrev_b32 v74, 20, v74
    v_mul_u32_u24 v76, 27, v74
    v_sub_u32 v75, v73, v76
    v_mul_u32_u24 v77, 116509, v75
    v_lshrrev_b32 v77, 20, v77
    v_mul_u32_u24 v76, 9, v77
    v_sub_u32 v78, v75, v76
    v_mul_u32_u24 v74, 3456, v74
    v_mul_u32_u24 v77, 1152, v77
    v_lshlrev_b32 v78, 4, v78
    v_add3_u32 v74, v74, v77, v78
    v_subrev_u32 v229, 1024, v74
    v_add_u32 v73, 128, v0
    v_mul_u32_u24 v74, 38837, v73
    v_lshrrev_b32 v74, 20, v74
    v_mul_u32_u24 v76, 27, v74
    v_sub_u32 v75, v73, v76
    v_mul_u32_u24 v77, 116509, v75
    v_lshrrev_b32 v77, 20, v77
    v_mul_u32_u24 v76, 9, v77
    v_sub_u32 v78, v75, v76
    v_mul_u32_u24 v74, 3456, v74
    v_mul_u32_u24 v77, 1152, v77
    v_lshlrev_b32 v78, 4, v78
    v_add3_u32 v74, v74, v77, v78
    v_subrev_u32 v230, 2048, v74
    v_add_u32 v73, 192, v0
    v_mul_u32_u24 v74, 38837, v73
    v_lshrrev_b32 v74, 20, v74
    v_mul_u32_u24 v76, 27, v74
    v_sub_u32 v75, v73, v76
    v_mul_u32_u24 v77, 116509, v75
    v_lshrrev_b32 v77, 20, v77
    v_mul_u32_u24 v76, 9, v77
    v_sub_u32 v78, v75, v76
    v_mul_u32_u24 v74, 3456, v74
    v_mul_u32_u24 v77, 1152, v77
    v_lshlrev_b32 v78, 4, v78
    v_add3_u32 v74, v74, v77, v78
    v_subrev_u32 v231, 3072, v74
    s_mul_i32 s28, s5, 144
    s_mul_i32 s3, s97, 27648
    s_add_u32 s28, s28, s3
    s_mul_i32 s99, s97, 3456
    s_add_u32 s99, s99, 16384
    s_branch L_att_pd
L_att_ph:
    v_lshrrev_b32 v73, 5, v0
    v_and_b32 v74, 31, v0
    v_xor_b32 v74, v74, v73
    v_mul_u32_u24 v75, 9216, v73
    v_lshl_add_u32 v228, v74, 4, v75
    v_add_u32 v229, 17408, v228
    v_add_u32 v230, 34816, v228
    v_add_u32 v231, 52224, v228
    s_lshl_b32 s28, s96, 2
    s_add_u32 s28, s28, s97
    s_mul_i32 s28, s28, 73728
    s_add_u32 s28, s28, 1048576
    s_lshl_b32 s99, s97, 12
L_att_pd:
    v_lshrrev_b32 v74, 2, v0
    v_lshlrev_b32 v74, 1, v74
    v_and_b32 v75, 3, v0
    s_mul_i32 s38, s98, 72
    s_add_u32 s3, s38, 16384
    v_mul_u32_u24 v76, 432, v74
    v_add_u32 v76, s3, v76
    v_lshl_add_u32 v224, v75, 3, v76
    v_min_u32 v77, 2, v75
    v_mul_u32_u24 v77, 144, v77
    v_add3_u32 v225, v76, v77, 64
    v_lshrrev_b32 v77, 1, v75
    v_xor_b32 v78, v74, v77
    v_lshlrev_b32 v78, 4, v78
    v_lshl_add_u32 v78, v77, 9, v78
    v_and_b32 v77, 1, v75
    v_lshl_add_u32 v78, v77, 3, v78
    s_lshl_b32 s3, s97, 12
    v_add_u32 v226, s3, v78
    v_xor_b32 v227, 16, v226
    v_lshlrev_b32 v252, 2, v71
    v_mov_b32 v74, 0
    v_add_u32 v75, 149504, v252
    ds_write_b32 v75, v74
    ds_write_b32 v75, v74 offset:64
    s_cmp_eq_u32 s4, 3
    s_cbranch_scc0 L_att_s7
    s_load_dwordx8 s[64:71], s[50:51], 0 glc
    s_load_dwordx8 s[72:79], s[50:51], 128 glc
    s_load_dwordx8 s[80:87], s[50:51], 256 glc
    s_load_dwordx8 s[88:95], s[50:51], 384 glc
L_att_s7:
    s_cmp_eq_u32 s4, 0
    s_cbranch_scc1 L_att_s1
    s_barrier
L_att_s1:
    s_and_b32 s3, s4, 3
    s_cmp_lg_u32 s3, 1
    s_cbranch_scc1 L_att_g0
    s_lshr_b32 s49, s4, 2
    s_lshl_b32 s3, s49, 11
    s_add_u32 m0, s3, 143360
    s_lshl_b32 s48, s5, 1
    s_add_u32 s48, s48, s49
    s_mul_i32 s48, s48, 1296
    buffer_load_dwordx4 v63, s[16:19], s48 offen lds
    buffer_load_dwordx4 v63, s[16:19], s48 offen offset:1024 lds
L_att_g0:
    s_cmp_lg_u32 s98, 1
    s_cbranch_scc1 on_39
    s_add_u32 m0, s99, 0
    s_nop 0
    buffer_load_dwordx4 v228, s[12:15], s28 offen offset:0 lds
    buffer_load_dwordx4 v229, s[12:15], s28 offen offset:1024 lds
    buffer_load_dwordx4 v230, s[12:15], s28 offen offset:2048 lds
    s_mov_b64 exec, 0xffffff
    buffer_load_dwordx4 v231, s[12:15], s28 offen offset:3072 lds
    s_mov_b64 exec, -1
    s_add_u32 s28, s28, 110592
    s_add_u32 m0, s99, 30720
    s_nop 0
    buffer_load_dwordx4 v228, s[12:15], s28 offen offset:0 lds
    buffer_load_dwordx4 v229, s[12:15], s28 offen offset:1024 lds
    buffer_load_dwordx4 v230, s[12:15], s28 offen offset:2048 lds
    s_mov_b64 exec, 0xffffff
    buffer_load_dwordx4 v231, s[12:15], s28 offen offset:3072 lds
    s_mov_b64 exec, -1
    s_add_u32 s28, s28, 110592
on_39:
    v_lshrrev_b32 v5, 4, v0
    v_and_b32 v6, 15, v0
    v_mov_b32 v7, 2147418112
    v_lshrrev_b32 v8, 5, v0
    v_and_b32 v10, 3, v0
    s_lshl_b32 s41, s98, 11
    s_add_u32 s41, s41, 143360
    v_lshl_add_u32 v11, v10, 1, s41
    v_bfe_u32 v12, v0, 2, 2
    v_mul_u32_u24 v12, 18, v12
    s_and_b32 s38, s97, 1
    s_lshl_b32 s38, s38, 1
    s_lshr_b32 s39, s97, 1
    s_lshl_b32 s41, s39, 4
    s_add_u32 s41, s41, s38
    v_lshl_add_u32 v13, v5, 2, s41
    v_sub_u32 v12, v13, v12
    v_cmp_gt_u32 vcc, 18, v12
    v_mul_u32_u24 v13, 36, v13
    v_add_u32 v13, v13, v11
    v_mov_b32 v14, 149504
    v_cndmask_b32 v253, v14, v13, vcc
    s_lshl_b32 s39, s39, 1
    s_add_u32 s39, s39, 5
    v_lshrrev_b32 v9, 2, v0
    v_cmp_eq_u32 vcc, s39, v9
    s_mul_i32 s38, s38, 36
    s_add_u32 s38, s38, 1152
    v_add_u32 v13, s38, v11
    v_cndmask_b32 v254, v14, v13, vcc
    s_mul_i32 s41, s98, 10240
    s_add_u32 s41, s41, 122880
    v_lshl_add_u32 v250, v0, 4, s41
    s_lshl_b32 s41, s97, 2
    v_add_u32 v15, s41, v250
    v_lshlrev_b32 v9, 1, v9
    s_mul_i32 s38, s98, 72
    v_lshlrev_b32 v251, 12, v5
    v_lshl_add_u32 v251, v6, 7, v251
    s_lshl_b32 s63, s96, 2
    s_add_u32 s63, s63, s97
    s_lshl_b32 s63, s63, 2
    s_lshr_b32 s42, s5, 1
    s_mul_i32 s42, s42, 4718592
    s_and_b32 s41, s5, 1
    s_lshl_b32 s41, s41, 11
    s_add_u32 s42, s42, s41
    v_lshlrev_b32 v249, 9, v0
    s_mul_i32 s41, s97, 30208
    v_mul_u32_u24 v11, 472, v6
    v_add_u32 v11, s41, v11
    s_add_u32 s41, s38, 320
    v_lshl_add_u32 v232, v5, 3, s41
    v_add_u32 v232, v232, v11
    s_add_u32 s41, s41, 64
    v_cmp_eq_u32 vcc, 3, v5
    v_mov_b32 v12, s41
    v_mov_b32 v13, 464
    v_cndmask_b32 v12, v12, v13, vcc
    v_add_u32 v233, v12, v11
    v_mov_b32 v1, v224
    v_mov_b32 v2, v225
    v_mov_b32 v3, v226
    v_mov_b32 v4, v227
    s_cmp_lg_u32 s4, 3
    s_cbranch_scc1 L_att_np
    s_mov_b32 s48, 65536
poll_40:
    s_waitcnt lgkmcnt(0)
    s_cmp_lg_u64 s[64:65], s[0:1]
    s_cselect_b32 s49, 1, 0
    s_cmp_lg_u64 s[66:67], s[0:1]
    s_cselect_b32 s49, 1, s49
    s_cmp_lg_u64 s[68:69], s[0:1]
    s_cselect_b32 s49, 1, s49
    s_cmp_lg_u64 s[70:71], s[0:1]
    s_cselect_b32 s49, 1, s49
    s_cmp_lg_u64 s[72:73], s[0:1]
    s_cselect_b32 s49, 1, s49
    s_cmp_lg_u64 s[74:75], s[0:1]
    s_cselect_b32 s49, 1, s49
    s_cmp_lg_u64 s[76:77], s[0:1]
    s_cselect_b32 s49, 1, s49
    s_cmp_lg_u64 s[78:79], s[0:1]
    s_cselect_b32 s49, 1, s49
    s_cmp_lg_u64 s[80:81], s[0:1]
    s_cselect_b32 s49, 1, s49
    s_cmp_lg_u64 s[82:83], s[0:1]
    s_cselect_b32 s49, 1, s49
    s_cmp_lg_u64 s[84:85], s[0:1]
    s_cselect_b32 s49, 1, s49
    s_cmp_lg_u64 s[86:87], s[0:1]
    s_cselect_b32 s49, 1, s49
    s_cmp_lg_u64 s[88:89], s[0:1]
    s_cselect_b32 s49, 1, s49
    s_cmp_lg_u64 s[90:91], s[0:1]
    s_cselect_b32 s49, 1, s49
    s_cmp_lg_u64 s[92:93], s[0:1]
    s_cselect_b32 s49, 1, s49
    s_cmp_lg_u64 s[94:95], s[0:1]
    s_cselect_b32 s49, 1, s49
    s_cmp_eq_u32 s49, 0
    s_cbranch_scc1 polld_41
    s_sub_u32 s48, s48, 1
    s_cmp_eq_u32 s48, 0
    s_cbranch_scc1 polld_41
    s_load_dwordx8 s[64:71], s[50:51], 0 glc
    s_load_dwordx8 s[72:79], s[50:51], 128 glc
    s_load_dwordx8 s[80:87], s[50:51], 256 glc
    s_load_dwordx8 s[88:95], s[50:51], 384 glc
    s_branch poll_40
polld_41:
L_att_np:
    s_barrier
    s_cmp_lg_u32 s98, 0
    s_cbranch_scc1 on_42
    s_add_u32 m0, s99, 0
    s_nop 0
    buffer_load_dwordx4 v228, s[44:47], s28 offen offset:0 sc1 lds
    buffer_load_dwordx4 v229, s[44:47], s28 offen offset:1024 sc1 lds
    buffer_load_dwordx4 v230, s[44:47], s28 offen offset:2048 sc1 lds
    buffer_load_dwordx4 v231, s[44:47], s28 offen offset:3072 sc1 lds
    s_add_u32 s28, s28, 0x200
    s_add_u32 m0, s99, 30720
    s_nop 0
    buffer_load_dwordx4 v228, s[44:47], s28 offen offset:0 sc1 lds
    buffer_load_dwordx4 v229, s[44:47], s28 offen offset:1024 sc1 lds
    buffer_load_dwordx4 v230, s[44:47], s28 offen offset:2048 sc1 lds
    buffer_load_dwordx4 v231, s[44:47], s28 offen offset:3072 sc1 lds
    s_add_u32 s28, s28, 0x200
on_42:
    s_lshl_b32 s3, s96, 2
    s_add_u32 s3, s3, s97
    s_lshl_b32 s3, s3, 8
    s_add_u32 s3, s3, 393216
    buffer_load_dword v16, v252, s[44:47], s3 offen offset:0 sc1
    buffer_load_dword v18, v252, s[44:47], s3 offen offset:64 sc1
    buffer_load_dword v20, v252, s[44:47], s3 offen offset:128 sc1
    buffer_load_dword v22, v252, s[44:47], s3 offen offset:192 sc1
    s_waitcnt vmcnt(8) lgkmcnt(0)
    s_barrier
    ds_read_b64_tr_b16 v[164:165], v3 offset:0
    ds_read_b64_tr_b16 v[166:167], v4 offset:0
    ds_read_b64_tr_b16 v[136:137], v1 offset:0
    ds_read_b64_tr_b16 v[138:139], v1 offset:432
    ds_read_b64_tr_b16 v[140:141], v1 offset:32
    ds_read_b64_tr_b16 v[142:143], v1 offset:464
    ds_read_b64_tr_b16 v[144:145], v1 offset:144
    ds_read_b64_tr_b16 v[146:147], v1 offset:576
    ds_read_b64_tr_b16 v[148:149], v1 offset:176
    ds_read_b64_tr_b16 v[150:151], v1 offset:608
    ds_read_b64_tr_b16 v[152:153], v2 offset:0
    ds_read_b64_tr_b16 v[154:155], v2 offset:432
    ds_read_b64_tr_b16 v[156:157], v1 offset:288
    ds_read_b64_tr_b16 v[158:159], v1 offset:720
    ds_read_b64_tr_b16 v[160:161], v1 offset:320
    ds_read_b64_tr_b16 v[162:163], v1 offset:752
    ds_read_b64_tr_b16 v[168:169], v3 offset:1024
    ds_read_b64_tr_b16 v[170:171], v4 offset:1024
    ds_read_b64_tr_b16 v[172:173], v3 offset:2048
    ds_read_b64_tr_b16 v[174:175], v4 offset:2048
    ds_read_b64_tr_b16 v[176:177], v3 offset:3072
    ds_read_b64_tr_b16 v[178:179], v4 offset:3072
    v_add_u32 v1, 30720, v224
    v_add_u32 v2, 30720, v225
    v_add_u32 v3, 30720, v226
    v_add_u32 v4, 30720, v227
    s_cmp_lg_u32 s98, 0
    s_cbranch_scc1 on_43
    s_add_u32 m0, s99, 61440
    s_nop 0
    buffer_load_dwordx4 v228, s[44:47], s28 offen offset:0 sc1 lds
    buffer_load_dwordx4 v229, s[44:47], s28 offen offset:1024 sc1 lds
    buffer_load_dwordx4 v230, s[44:47], s28 offen offset:2048 sc1 lds
    buffer_load_dwordx4 v231, s[44:47], s28 offen offset:3072 sc1 lds
    s_add_u32 s28, s28, 0x200
on_43:
    s_cmp_lg_u32 s98, 1
    s_cbranch_scc1 on_44
    s_add_u32 m0, s99, 61440
    s_nop 0
    buffer_load_dwordx4 v228, s[12:15], s28 offen offset:0 lds
    buffer_load_dwordx4 v229, s[12:15], s28 offen offset:1024 lds
    buffer_load_dwordx4 v230, s[12:15], s28 offen offset:2048 lds
    s_mov_b64 exec, 0xffffff
    buffer_load_dwordx4 v231, s[12:15], s28 offen offset:3072 lds
    s_mov_b64 exec, -1
    s_add_u32 s28, s28, 110592
on_44:
L_att_a:
    s_cmp_eq_u32 s98, 1
    s_cbranch_scc1 L_att_y
    s_waitcnt vmcnt(8) lgkmcnt(6)
    s_barrier
    v_mfma_f32_16x16x32_bf16 v[24:27], v[136:139], v[164:167], 0
    ds_read_b64_tr_b16 v[208:209], v3 offset:0
    v_mfma_f32_16x16x32_bf16 v[28:31], v[140:143], v[164:167], 0
    ds_read_b64_tr_b16 v[210:211], v4 offset:0
    v_mfma_f32_16x16x32_bf16 v[32:35], v[144:147], v[164:167], 0
    ds_read_b64_tr_b16 v[180:181], v1 offset:0
    v_mfma_f32_16x16x32_bf16 v[36:39], v[148:151], v[164:167], 0
    ds_read_b64_tr_b16 v[182:183], v1 offset:432
    v_mfma_f32_16x16x32_bf16 v[40:43], v[152:155], v[164:167], 0
    ds_read_b64_tr_b16 v[184:185], v1 offset:32
    v_mfma_f32_16x16x32_bf16 v[44:47], v[156:159], v[164:167], 0
    ds_read_b64_tr_b16 v[186:187], v1 offset:464
    v_mfma_f32_16x16x32_bf16 v[48:51], v[160:163], v[164:167], 0
    ds_read_b64_tr_b16 v[188:189], v1 offset:144
    s_waitcnt lgkmcnt(7)
    v_mfma_f32_16x16x32_bf16 v[76:79], v[160:163], v[168:171], 0
    ds_read_b64_tr_b16 v[190:191], v1 offset:576
    v_mfma_f32_16x16x32_bf16 v[72:75], v[156:159], v[168:171], 0
    ds_read_b64_tr_b16 v[192:193], v1 offset:176
    v_mfma_f32_16x16x32_bf16 v[68:71], v[152:155], v[168:171], 0
    ds_read_b64_tr_b16 v[194:195], v1 offset:608
    v_mfma_f32_16x16x32_bf16 v[64:67], v[148:151], v[168:171], 0
    ds_read_b64_tr_b16 v[196:197], v2 offset:0
    v_mfma_f32_16x16x32_bf16 v[60:63], v[144:147], v[168:171], 0
    ds_read_b64_tr_b16 v[198:199], v2 offset:432
    v_mfma_f32_16x16x32_bf16 v[56:59], v[140:143], v[168:171], 0
    ds_read_b64_tr_b16 v[200:201], v1 offset:288
    v_mfma_f32_16x16x32_bf16 v[52:55], v[136:139], v[168:171], 0
    ds_read_b64_tr_b16 v[202:203], v1 offset:720
    v_mfma_f32_16x16x32_bf16 v[80:83], v[136:139], v[172:175], 0
    ds_read_b64_tr_b16 v[204:205], v1 offset:320
    v_mfma_f32_16x16x32_bf16 v[84:87], v[140:143], v[172:175], 0
    ds_read_b64_tr_b16 v[206:207], v1 offset:752
    v_mfma_f32_16x16x32_bf16 v[88:91], v[144:147], v[172:175], 0
    ds_read_b64_tr_b16 v[212:213], v3 offset:1024
    v_mfma_f32_16x16x32_bf16 v[92:95], v[148:151], v[172:175], 0
    ds_read_b64_tr_b16 v[214:215], v4 offset:1024
    v_mfma_f32_16x16x32_bf16 v[96:99], v[152:155], v[172:175], 0
    ds_read_b64_tr_b16 v[216:217], v3 offset:2048
    v_mfma_f32_16x16x32_bf16 v[100:103], v[156:159], v[172:175], 0
    ds_read_b64_tr_b16 v[218:219], v4 offset:2048
    v_mfma_f32_16x16x32_bf16 v[104:107], v[160:163], v[172:175], 0
    ds_read_b64_tr_b16 v[220:221], v3 offset:3072
    v_mfma_f32_16x16x32_bf16 v[132:135], v[160:163], v[176:179], 0
    ds_read_b64_tr_b16 v[222:223], v4 offset:3072
    v_mfma_f32_16x16x32_bf16 v[128:131], v[156:159], v[176:179], 0
    v_add_u32 v1, 61440, v224
    v_mfma_f32_16x16x32_bf16 v[124:127], v[152:155], v[176:179], 0
    v_add_u32 v2, 61440, v225
    v_mfma_f32_16x16x32_bf16 v[120:123], v[148:151], v[176:179], 0
    v_add_u32 v3, 61440, v226
    v_mfma_f32_16x16x32_bf16 v[116:119], v[144:147], v[176:179], 0
    v_add_u32 v4, 61440, v227
    v_mfma_f32_16x16x32_bf16 v[112:115], v[140:143], v[176:179], 0
    v_mfma_f32_16x16x32_bf16 v[108:111], v[136:139], v[176:179], 0
    s_add_u32 m0, s99, 92160
    s_nop 0
    buffer_load_dwordx4 v228, s[44:47], s28 offen offset:0 sc1 lds
    buffer_load_dwordx4 v229, s[44:47], s28 offen offset:1024 sc1 lds
    buffer_load_dwordx4 v230, s[44:47], s28 offen offset:2048 sc1 lds
    buffer_load_dwordx4 v231, s[44:47], s28 offen offset:3072 sc1 lds
    s_add_u32 s28, s28, 0x200
    v_and_b32 v14, 1, v5
    v_mul_u32_u24 v12, 80, v14
    v_mul_u32_u24 v13, 7552, v8
    s_mul_i32 s41, s98, 160
    v_add3_u32 v234, v11, v12, v13
    v_add_u32 v234, s41, v234
    v_and_b32 v11, 14, v9
    v_add_u32 v11, v11, v8
    v_mul_u32_u24 v11, 944, v11
    s_lshr_b32 s39, s4, 1
    s_waitcnt vmcnt(4) lgkmcnt(6)
    s_barrier
    v_mfma_f32_16x16x32_bf16 v[24:27], v[180:183], v[208:211], v[24:27]
    ds_read_b64_tr_b16 v[164:165], v3 offset:0
    v_mfma_f32_16x16x32_bf16 v[28:31], v[184:187], v[208:211], v[28:31]
    ds_read_b64_tr_b16 v[166:167], v4 offset:0
    v_mfma_f32_16x16x32_bf16 v[32:35], v[188:191], v[208:211], v[32:35]
    ds_read_b64_tr_b16 v[136:137], v1 offset:0
    v_mfma_f32_16x16x32_bf16 v[36:39], v[192:195], v[208:211], v[36:39]
    ds_read_b64_tr_b16 v[138:139], v1 offset:432
    v_mfma_f32_16x16x32_bf16 v[40:43], v[196:199], v[208:211], v[40:43]
    ds_read_b64_tr_b16 v[140:141], v1 offset:32
    v_mfma_f32_16x16x32_bf16 v[44:47], v[200:203], v[208:211], v[44:47]
    ds_read_b64_tr_b16 v[142:143], v1 offset:464
    v_mfma_f32_16x16x32_bf16 v[48:51], v[204:207], v[208:211], v[48:51]
    ds_read_b64_tr_b16 v[144:145], v1 offset:144
    s_waitcnt lgkmcnt(7)
    v_mfma_f32_16x16x32_bf16 v[76:79], v[204:207], v[212:215], v[76:79]
    ds_read_b64_tr_b16 v[146:147], v1 offset:576
    v_mfma_f32_16x16x32_bf16 v[72:75], v[200:203], v[212:215], v[72:75]
    ds_read_b64_tr_b16 v[148:149], v1 offset:176
    v_mfma_f32_16x16x32_bf16 v[68:71], v[196:199], v[212:215], v[68:71]
    ds_read_b64_tr_b16 v[150:151], v1 offset:608
    v_mfma_f32_16x16x32_bf16 v[64:67], v[192:195], v[212:215], v[64:67]
    ds_read_b64_tr_b16 v[152:153], v2 offset:0
    v_mfma_f32_16x16x32_bf16 v[60:63], v[188:191], v[212:215], v[60:63]
    ds_read_b64_tr_b16 v[154:155], v2 offset:432
    v_mfma_f32_16x16x32_bf16 v[56:59], v[184:187], v[212:215], v[56:59]
    ds_read_b64_tr_b16 v[156:157], v1 offset:288
    v_mfma_f32_16x16x32_bf16 v[52:55], v[180:183], v[212:215], v[52:55]
    ds_read_b64_tr_b16 v[158:159], v1 offset:720
    v_mfma_f32_16x16x32_bf16 v[80:83], v[180:183], v[216:219], v[80:83]
    ds_read_b64_tr_b16 v[160:161], v1 offset:320
    v_mfma_f32_16x16x32_bf16 v[84:87], v[184:187], v[216:219], v[84:87]
    ds_read_b64_tr_b16 v[162:163], v1 offset:752
    v_mfma_f32_16x16x32_bf16 v[88:91], v[188:191], v[216:219], v[88:91]
    ds_read_b64_tr_b16 v[168:169], v3 offset:1024
    v_mfma_f32_16x16x32_bf16 v[92:95], v[192:195], v[216:219], v[92:95]
    ds_read_b64_tr_b16 v[170:171], v4 offset:1024
    v_mfma_f32_16x16x32_bf16 v[96:99], v[196:199], v[216:219], v[96:99]
    ds_read_b64_tr_b16 v[172:173], v3 offset:2048
    v_mfma_f32_16x16x32_bf16 v[100:103], v[200:203], v[216:219], v[100:103]
    ds_read_b64_tr_b16 v[174:175], v4 offset:2048
    v_mfma_f32_16x16x32_bf16 v[104:107], v[204:207], v[216:219], v[104:107]
    ds_read_b64_tr_b16 v[176:177], v3 offset:3072
    v_mfma_f32_16x16x32_bf16 v[132:135], v[204:207], v[220:223], v[132:135]
    ds_read_b64_tr_b16 v[178:179], v4 offset:3072
    v_mfma_f32_16x16x32_bf16 v[128:131], v[200:203], v[220:223], v[128:131]
    v_add_u32 v1, 92160, v224
    v_mfma_f32_16x16x32_bf16 v[124:127], v[196:199], v[220:223], v[124:127]
    v_add_u32 v2, 92160, v225
    v_mfma_f32_16x16x32_bf16 v[120:123], v[192:195], v[220:223], v[120:123]
    v_add_u32 v3, 92160, v226
    v_mfma_f32_16x16x32_bf16 v[116:119], v[188:191], v[220:223], v[116:119]
    v_add_u32 v4, 92160, v227
    v_mfma_f32_16x16x32_bf16 v[112:115], v[184:187], v[220:223], v[112:115]
    v_mfma_f32_16x16x32_bf16 v[108:111], v[180:183], v[220:223], v[108:111]
    s_add_u32 m0, s99, 0
    s_nop 0
    buffer_load_dwordx4 v228, s[44:47], s28 offen offset:0 sc1 lds
    buffer_load_dwordx4 v229, s[44:47], s28 offen offset:1024 sc1 lds
    buffer_load_dwordx4 v230, s[44:47], s28 offen offset:2048 sc1 lds
    buffer_load_dwordx4 v231, s[44:47], s28 offen offset:3072 sc1 lds
    s_add_u32 s28, s28, 0x200
    s_mul_i32 s41, s39, 80
    v_lshl_add_u32 v235, v10, 3, s41
    v_add_u32 v235, v235, v11
    s_add_u32 s38, s38, 320
    s_and_b32 s41, s39, 1
    s_mul_i32 s41, s41, 40
    s_add_u32 s41, s41, s38
    v_lshl_add_u32 v12, v10, 3, s41
    s_add_u32 s38, s38, 32
    v_cmp_eq_u32 vcc, 0, v10
    s_waitcnt vmcnt(4) lgkmcnt(6)
    s_barrier
    v_mfma_f32_16x16x32_bf16 v[24:27], v[136:139], v[164:167], v[24:27]
    ds_read_b64_tr_b16 v[208:209], v3 offset:0
    v_mfma_f32_16x16x32_bf16 v[28:31], v[140:143], v[164:167], v[28:31]
    ds_read_b64_tr_b16 v[210:211], v4 offset:0
    v_mfma_f32_16x16x32_bf16 v[32:35], v[144:147], v[164:167], v[32:35]
    ds_read_b64_tr_b16 v[180:181], v1 offset:0
    v_mfma_f32_16x16x32_bf16 v[36:39], v[148:151], v[164:167], v[36:39]
    ds_read_b64_tr_b16 v[182:183], v1 offset:432
    v_mfma_f32_16x16x32_bf16 v[40:43], v[152:155], v[164:167], v[40:43]
    ds_read_b64_tr_b16 v[184:185], v1 offset:32
    v_mfma_f32_16x16x32_bf16 v[44:47], v[156:159], v[164:167], v[44:47]
    ds_read_b64_tr_b16 v[186:187], v1 offset:464
    v_mfma_f32_16x16x32_bf16 v[48:51], v[160:163], v[164:167], v[48:51]
    ds_read_b64_tr_b16 v[188:189], v1 offset:144
    s_waitcnt lgkmcnt(7)
    v_mfma_f32_16x16x32_bf16 v[76:79], v[160:163], v[168:171], v[76:79]
    ds_read_b64_tr_b16 v[190:191], v1 offset:576
    v_mfma_f32_16x16x32_bf16 v[72:75], v[156:159], v[168:171], v[72:75]
    ds_read_b64_tr_b16 v[192:193], v1 offset:176
    v_mfma_f32_16x16x32_bf16 v[68:71], v[152:155], v[168:171], v[68:71]
    ds_read_b64_tr_b16 v[194:195], v1 offset:608
    v_mfma_f32_16x16x32_bf16 v[64:67], v[148:151], v[168:171], v[64:67]
    ds_read_b64_tr_b16 v[196:197], v2 offset:0
    v_mfma_f32_16x16x32_bf16 v[60:63], v[144:147], v[168:171], v[60:63]
    ds_read_b64_tr_b16 v[198:199], v2 offset:432
    v_mfma_f32_16x16x32_bf16 v[56:59], v[140:143], v[168:171], v[56:59]
    ds_read_b64_tr_b16 v[200:201], v1 offset:288
    v_mfma_f32_16x16x32_bf16 v[52:55], v[136:139], v[168:171], v[52:55]
    ds_read_b64_tr_b16 v[202:203], v1 offset:720
    v_mfma_f32_16x16x32_bf16 v[80:83], v[136:139], v[172:175], v[80:83]
    ds_read_b64_tr_b16 v[204:205], v1 offset:320
    v_mfma_f32_16x16x32_bf16 v[84:87], v[140:143], v[172:175], v[84:87]
    ds_read_b64_tr_b16 v[206:207], v1 offset:752
    v_mfma_f32_16x16x32_bf16 v[88:91], v[144:147], v[172:175], v[88:91]
    ds_read_b64_tr_b16 v[212:213], v3 offset:1024
    v_mfma_f32_16x16x32_bf16 v[92:95], v[148:151], v[172:175], v[92:95]
    ds_read_b64_tr_b16 v[214:215], v4 offset:1024
    v_mfma_f32_16x16x32_bf16 v[96:99], v[152:155], v[172:175], v[96:99]
    ds_read_b64_tr_b16 v[216:217], v3 offset:2048
    v_mfma_f32_16x16x32_bf16 v[100:103], v[156:159], v[172:175], v[100:103]
    ds_read_b64_tr_b16 v[218:219], v4 offset:2048
    v_mfma_f32_16x16x32_bf16 v[104:107], v[160:163], v[172:175], v[104:107]
    ds_read_b64_tr_b16 v[220:221], v3 offset:3072
    v_mfma_f32_16x16x32_bf16 v[132:135], v[160:163], v[176:179], v[132:135]
    ds_read_b64_tr_b16 v[222:223], v4 offset:3072
    v_mfma_f32_16x16x32_bf16 v[128:131], v[156:159], v[176:179], v[128:131]
    v_add_u32 v1, 0, v224
    v_mfma_f32_16x16x32_bf16 v[124:127], v[152:155], v[176:179], v[124:127]
    v_add_u32 v2, 0, v225
    v_mfma_f32_16x16x32_bf16 v[120:123], v[148:151], v[176:179], v[120:123]
    v_add_u32 v3, 0, v226
    v_mfma_f32_16x16x32_bf16 v[116:119], v[144:147], v[176:179], v[116:119]
    v_add_u32 v4, 0, v227
    v_mfma_f32_16x16x32_bf16 v[112:115], v[140:143], v[176:179], v[112:115]
    v_mfma_f32_16x16x32_bf16 v[108:111], v[136:139], v[176:179], v[108:111]
    s_add_u32 m0, s99, 30720
    s_nop 0
    buffer_load_dwordx4 v228, s[44:47], s28 offen offset:0 sc1 lds
    buffer_load_dwordx4 v229, s[44:47], s28 offen offset:1024 sc1 lds
    buffer_load_dwordx4 v230, s[44:47], s28 offen offset:2048 sc1 lds
    buffer_load_dwordx4 v231, s[44:47], s28 offen offset:3072 sc1 lds
    s_add_u32 s28, s28, 0x200
    v_mov_b32 v13, 464
    v_mov_b32 v236, s38
    v_cndmask_b32 v13, v13, v236, vcc
    s_bitcmp0_b32 s4, 0
    s_cselect_b64 vcc, -1, 0
    s_cselect_b32 s38, 16, 8
    v_cndmask_b32 v12, v13, v12, vcc
    v_add_u32 v236, v12, v11
    v_cmp_gt_u32 vcc, s38, v6
    v_mul_u32_u24 v11, s38, v5
    v_add_lshl_u32 v11, v11, v6, 4
    s_lshl_b32 s40, s38, 6
    s_waitcnt vmcnt(4) lgkmcnt(6)
    s_barrier
    v_mfma_f32_16x16x32_bf16 v[24:27], v[180:183], v[208:211], v[24:27]
    ds_read_b64_tr_b16 v[164:165], v3 offset:0
    v_mfma_f32_16x16x32_bf16 v[28:31], v[184:187], v[208:211], v[28:31]
    ds_read_b64_tr_b16 v[166:167], v4 offset:0
    v_mfma_f32_16x16x32_bf16 v[32:35], v[188:191], v[208:211], v[32:35]
    ds_read_b64_tr_b16 v[136:137], v1 offset:0
    v_mfma_f32_16x16x32_bf16 v[36:39], v[192:195], v[208:211], v[36:39]
    ds_read_b64_tr_b16 v[138:139], v1 offset:432
    v_mfma_f32_16x16x32_bf16 v[40:43], v[196:199], v[208:211], v[40:43]
    ds_read_b64_tr_b16 v[140:141], v1 offset:32
    v_mfma_f32_16x16x32_bf16 v[44:47], v[200:203], v[208:211], v[44:47]
    ds_read_b64_tr_b16 v[142:143], v1 offset:464
    v_mfma_f32_16x16x32_bf16 v[48:51], v[204:207], v[208:211], v[48:51]
    ds_read_b64_tr_b16 v[144:145], v1 offset:144
    s_waitcnt lgkmcnt(7)
    v_mfma_f32_16x16x32_bf16 v[76:79], v[204:207], v[212:215], v[76:79]
    ds_read_b64_tr_b16 v[146:147], v1 offset:576
    v_mfma_f32_16x16x32_bf16 v[72:75], v[200:203], v[212:215], v[72:75]
    ds_read_b64_tr_b16 v[148:149], v1 offset:176
    v_mfma_f32_16x16x32_bf16 v[68:71], v[196:199], v[212:215], v[68:71]
    ds_read_b64_tr_b16 v[150:151], v1 offset:608
    v_mfma_f32_16x16x32_bf16 v[64:67], v[192:195], v[212:215], v[64:67]
    ds_read_b64_tr_b16 v[152:153], v2 offset:0
    v_mfma_f32_16x16x32_bf16 v[60:63], v[188:191], v[212:215], v[60:63]
    ds_read_b64_tr_b16 v[154:155], v2 offset:432
    v_mfma_f32_16x16x32_bf16 v[56:59], v[184:187], v[212:215], v[56:59]
    ds_read_b64_tr_b16 v[156:157], v1 offset:288
    v_mfma_f32_16x16x32_bf16 v[52:55], v[180:183], v[212:215], v[52:55]
    ds_read_b64_tr_b16 v[158:159], v1 offset:720
    v_mfma_f32_16x16x32_bf16 v[80:83], v[180:183], v[216:219], v[80:83]
    ds_read_b64_tr_b16 v[160:161], v1 offset:320
    v_mfma_f32_16x16x32_bf16 v[84:87], v[184:187], v[216:219], v[84:87]
    ds_read_b64_tr_b16 v[162:163], v1 offset:752
    v_mfma_f32_16x16x32_bf16 v[88:91], v[188:191], v[216:219], v[88:91]
    ds_read_b64_tr_b16 v[168:169], v3 offset:1024
    v_mfma_f32_16x16x32_bf16 v[92:95], v[192:195], v[216:219], v[92:95]
    ds_read_b64_tr_b16 v[170:171], v4 offset:1024
    v_mfma_f32_16x16x32_bf16 v[96:99], v[196:199], v[216:219], v[96:99]
    ds_read_b64_tr_b16 v[172:173], v3 offset:2048
    v_mfma_f32_16x16x32_bf16 v[100:103], v[200:203], v[216:219], v[100:103]
    ds_read_b64_tr_b16 v[174:175], v4 offset:2048
    v_mfma_f32_16x16x32_bf16 v[104:107], v[204:207], v[216:219], v[104:107]
    ds_read_b64_tr_b16 v[176:177], v3 offset:3072
    v_mfma_f32_16x16x32_bf16 v[132:135], v[204:207], v[220:223], v[132:135]
    ds_read_b64_tr_b16 v[178:179], v4 offset:3072
    v_mfma_f32_16x16x32_bf16 v[128:131], v[200:203], v[220:223], v[128:131]
    v_add_u32 v1, 30720, v224
    v_mfma_f32_16x16x32_bf16 v[124:127], v[196:199], v[220:223], v[124:127]
    v_add_u32 v2, 30720, v225
    v_mfma_f32_16x16x32_bf16 v[120:123], v[192:195], v[220:223], v[120:123]
    v_add_u32 v3, 30720, v226
    v_mfma_f32_16x16x32_bf16 v[116:119], v[188:191], v[220:223], v[116:119]
    v_add_u32 v4, 30720, v227
    v_mfma_f32_16x16x32_bf16 v[112:115], v[184:187], v[220:223], v[112:115]
    v_mfma_f32_16x16x32_bf16 v[108:111], v[180:183], v[220:223], v[108:111]
    s_add_u32 m0, s99, 61440
    s_nop 0
    buffer_load_dwordx4 v228, s[44:47], s28 offen offset:0 sc1 lds
    buffer_load_dwordx4 v229, s[44:47], s28 offen offset:1024 sc1 lds
    buffer_load_dwordx4 v230, s[44:47], s28 offen offset:2048 sc1 lds
    buffer_load_dwordx4 v231, s[44:47], s28 offen offset:3072 sc1 lds
    s_add_u32 s28, s28, 0x200
    ds_read_u16 v17, v253 offset:0
    ds_read_u16 v19, v253 offset:36
    v_cndmask_b32 v237, v7, v11, vcc
    v_cmp_gt_u32 vcc, 2, v5
    s_lshl_b32 s30, s5, 3
    s_add_u32 s30, s30, s96
    v_cndmask_b32 v238, v7, v237, vcc
    s_mul_i32 s30, s30, 15360
    s_mul_i32 s41, s39, 3840
    s_add_u32 s30, s30, s41
    s_add_u32 s30, s30, 13631488
    s_lshl_b32 s36, s5, 12
    s_waitcnt vmcnt(4) lgkmcnt(6)
    s_barrier
    v_mfma_f32_16x16x32_bf16 v[24:27], v[136:139], v[164:167], v[24:27]
    ds_read_b64_tr_b16 v[208:209], v3 offset:0
    v_mfma_f32_16x16x32_bf16 v[28:31], v[140:143], v[164:167], v[28:31]
    ds_read_b64_tr_b16 v[210:211], v4 offset:0
    v_mfma_f32_16x16x32_bf16 v[32:35], v[144:147], v[164:167], v[32:35]
    ds_read_b64_tr_b16 v[180:181], v1 offset:0
    v_mfma_f32_16x16x32_bf16 v[36:39], v[148:151], v[164:167], v[36:39]
    ds_read_b64_tr_b16 v[182:183], v1 offset:432
    v_mfma_f32_16x16x32_bf16 v[40:43], v[152:155], v[164:167], v[40:43]
    ds_read_b64_tr_b16 v[184:185], v1 offset:32
    v_mfma_f32_16x16x32_bf16 v[44:47], v[156:159], v[164:167], v[44:47]
    ds_read_b64_tr_b16 v[186:187], v1 offset:464
    v_mfma_f32_16x16x32_bf16 v[48:51], v[160:163], v[164:167], v[48:51]
    ds_read_b64_tr_b16 v[188:189], v1 offset:144
    s_waitcnt lgkmcnt(7)
    v_mfma_f32_16x16x32_bf16 v[76:79], v[160:163], v[168:171], v[76:79]
    ds_read_b64_tr_b16 v[190:191], v1 offset:576
    v_mfma_f32_16x16x32_bf16 v[72:75], v[156:159], v[168:171], v[72:75]
    ds_read_b64_tr_b16 v[192:193], v1 offset:176
    v_mfma_f32_16x16x32_bf16 v[68:71], v[152:155], v[168:171], v[68:71]
    ds_read_b64_tr_b16 v[194:195], v1 offset:608
    v_mfma_f32_16x16x32_bf16 v[64:67], v[148:151], v[168:171], v[64:67]
    ds_read_b64_tr_b16 v[196:197], v2 offset:0
    v_mfma_f32_16x16x32_bf16 v[60:63], v[144:147], v[168:171], v[60:63]
    ds_read_b64_tr_b16 v[198:199], v2 offset:432
    v_mfma_f32_16x16x32_bf16 v[56:59], v[140:143], v[168:171], v[56:59]
    ds_read_b64_tr_b16 v[200:201], v1 offset:288
    v_mfma_f32_16x16x32_bf16 v[52:55], v[136:139], v[168:171], v[52:55]
    ds_read_b64_tr_b16 v[202:203], v1 offset:720
    v_mfma_f32_16x16x32_bf16 v[80:83], v[136:139], v[172:175], v[80:83]
    ds_read_b64_tr_b16 v[204:205], v1 offset:320
    v_mfma_f32_16x16x32_bf16 v[84:87], v[140:143], v[172:175], v[84:87]
    ds_read_b64_tr_b16 v[206:207], v1 offset:752
    v_mfma_f32_16x16x32_bf16 v[88:91], v[144:147], v[172:175], v[88:91]
    ds_read_b64_tr_b16 v[212:213], v3 offset:1024
    v_mfma_f32_16x16x32_bf16 v[92:95], v[148:151], v[172:175], v[92:95]
    ds_read_b64_tr_b16 v[214:215], v4 offset:1024
    v_mfma_f32_16x16x32_bf16 v[96:99], v[152:155], v[172:175], v[96:99]
    ds_read_b64_tr_b16 v[216:217], v3 offset:2048
    v_mfma_f32_16x16x32_bf16 v[100:103], v[156:159], v[172:175], v[100:103]
    ds_read_b64_tr_b16 v[218:219], v4 offset:2048
    v_mfma_f32_16x16x32_bf16 v[104:107], v[160:163], v[172:175], v[104:107]
    ds_read_b64_tr_b16 v[220:221], v3 offset:3072
    v_mfma_f32_16x16x32_bf16 v[132:135], v[160:163], v[176:179], v[132:135]
    ds_read_b64_tr_b16 v[222:223], v4 offset:3072
    v_mfma_f32_16x16x32_bf16 v[128:131], v[156:159], v[176:179], v[128:131]
    v_add_u32 v1, 61440, v224
    v_mfma_f32_16x16x32_bf16 v[124:127], v[152:155], v[176:179], v[124:127]
    v_add_u32 v2, 61440, v225
    v_mfma_f32_16x16x32_bf16 v[120:123], v[148:151], v[176:179], v[120:123]
    v_add_u32 v3, 61440, v226
    v_mfma_f32_16x16x32_bf16 v[116:119], v[144:147], v[176:179], v[116:119]
    v_add_u32 v4, 61440, v227
    v_mfma_f32_16x16x32_bf16 v[112:115], v[140:143], v[176:179], v[112:115]
    v_mfma_f32_16x16x32_bf16 v[108:111], v[136:139], v[176:179], v[108:111]
    s_add_u32 m0, s99, 92160
    s_nop 0
    buffer_load_dwordx4 v228, s[44:47], s28 offen offset:0 sc1 lds
    buffer_load_dwordx4 v229, s[44:47], s28 offen offset:1024 sc1 lds
    buffer_load_dwordx4 v230, s[44:47], s28 offen offset:2048 sc1 lds
    buffer_load_dwordx4 v231, s[44:47], s28 offen offset:3072 sc1 lds
    s_add_u32 s28, s28, 0x200
    v_lshl_or_b32 v21, v19, 16, v17
    ds_write_b32 v15, v21 offset:0
    ds_read_u16 v17, v253 offset:8
    ds_read_u16 v19, v253 offset:44
    s_add_u32 s36, s36, 49152
    s_lshl_b32 s41, s39, 7
    s_add_u32 s36, s36, s41
    s_lshl_b32 s31, s96, 1
    s_and_b32 s41, s4, 1
    s_add_u32 s31, s31, s41
    s_lshl_b32 s31, s31, 2
    s_add_u32 s31, s31, s36
    s_lshl_b32 s41, s96, 9
    s_add_u32 s36, s36, s41
    s_waitcnt vmcnt(4) lgkmcnt(6)
    s_barrier
    v_mfma_f32_16x16x32_bf16 v[24:27], v[180:183], v[208:211], v[24:27]
    ds_read_b64_tr_b16 v[164:165], v3 offset:0
    v_mfma_f32_16x16x32_bf16 v[28:31], v[184:187], v[208:211], v[28:31]
    ds_read_b64_tr_b16 v[166:167], v4 offset:0
    v_mfma_f32_16x16x32_bf16 v[32:35], v[188:191], v[208:211], v[32:35]
    ds_read_b64_tr_b16 v[136:137], v1 offset:0
    v_mfma_f32_16x16x32_bf16 v[36:39], v[192:195], v[208:211], v[36:39]
    ds_read_b64_tr_b16 v[138:139], v1 offset:432
    v_mfma_f32_16x16x32_bf16 v[40:43], v[196:199], v[208:211], v[40:43]
    ds_read_b64_tr_b16 v[140:141], v1 offset:32
    v_mfma_f32_16x16x32_bf16 v[44:47], v[200:203], v[208:211], v[44:47]
    ds_read_b64_tr_b16 v[142:143], v1 offset:464
    v_mfma_f32_16x16x32_bf16 v[48:51], v[204:207], v[208:211], v[48:51]
    ds_read_b64_tr_b16 v[144:145], v1 offset:144
    s_waitcnt lgkmcnt(7)
    v_mfma_f32_16x16x32_bf16 v[76:79], v[204:207], v[212:215], v[76:79]
    ds_read_b64_tr_b16 v[146:147], v1 offset:576
    v_mfma_f32_16x16x32_bf16 v[72:75], v[200:203], v[212:215], v[72:75]
    ds_read_b64_tr_b16 v[148:149], v1 offset:176
    v_mfma_f32_16x16x32_bf16 v[68:71], v[196:199], v[212:215], v[68:71]
    ds_read_b64_tr_b16 v[150:151], v1 offset:608
    v_mfma_f32_16x16x32_bf16 v[64:67], v[192:195], v[212:215], v[64:67]
    ds_read_b64_tr_b16 v[152:153], v2 offset:0
    v_mfma_f32_16x16x32_bf16 v[60:63], v[188:191], v[212:215], v[60:63]
    ds_read_b64_tr_b16 v[154:155], v2 offset:432
    v_mfma_f32_16x16x32_bf16 v[56:59], v[184:187], v[212:215], v[56:59]
    ds_read_b64_tr_b16 v[156:157], v1 offset:288
    v_mfma_f32_16x16x32_bf16 v[52:55], v[180:183], v[212:215], v[52:55]
    ds_read_b64_tr_b16 v[158:159], v1 offset:720
    v_mfma_f32_16x16x32_bf16 v[80:83], v[180:183], v[216:219], v[80:83]
    ds_read_b64_tr_b16 v[160:161], v1 offset:320
    v_mfma_f32_16x16x32_bf16 v[84:87], v[184:187], v[216:219], v[84:87]
    ds_read_b64_tr_b16 v[162:163], v1 offset:752
    v_mfma_f32_16x16x32_bf16 v[88:91], v[188:191], v[216:219], v[88:91]
    ds_read_b64_tr_b16 v[168:169], v3 offset:1024
    v_mfma_f32_16x16x32_bf16 v[92:95], v[192:195], v[216:219], v[92:95]
    ds_read_b64_tr_b16 v[170:171], v4 offset:1024
    v_mfma_f32_16x16x32_bf16 v[96:99], v[196:199], v[216:219], v[96:99]
    ds_read_b64_tr_b16 v[172:173], v3 offset:2048
    v_mfma_f32_16x16x32_bf16 v[100:103], v[200:203], v[216:219], v[100:103]
    ds_read_b64_tr_b16 v[174:175], v4 offset:2048
    v_mfma_f32_16x16x32_bf16 v[104:107], v[204:207], v[216:219], v[104:107]
    ds_read_b64_tr_b16 v[176:177], v3 offset:3072
    v_mfma_f32_16x16x32_bf16 v[132:135], v[204:207], v[220:223], v[132:135]
    ds_read_b64_tr_b16 v[178:179], v4 offset:3072
    v_mfma_f32_16x16x32_bf16 v[128:131], v[200:203], v[220:223], v[128:131]
    v_add_u32 v1, 92160, v224
    v_mfma_f32_16x16x32_bf16 v[124:127], v[196:199], v[220:223], v[124:127]
    v_add_u32 v2, 92160, v225
    v_mfma_f32_16x16x32_bf16 v[120:123], v[192:195], v[220:223], v[120:123]
    v_add_u32 v3, 92160, v226
    v_mfma_f32_16x16x32_bf16 v[116:119], v[188:191], v[220:223], v[116:119]
    v_add_u32 v4, 92160, v227
    v_mfma_f32_16x16x32_bf16 v[112:115], v[184:187], v[220:223], v[112:115]
    v_mfma_f32_16x16x32_bf16 v[108:111], v[180:183], v[220:223], v[108:111]
    s_add_u32 m0, s99, 0
    s_nop 0
    buffer_load_dwordx4 v228, s[44:47], s28 offen offset:0 sc1 lds
    buffer_load_dwordx4 v229, s[44:47], s28 offen offset:1024 sc1 lds
    buffer_load_dwordx4 v230, s[44:47], s28 offen offset:2048 sc1 lds
    buffer_load_dwordx4 v231, s[44:47], s28 offen offset:3072 sc1 lds
    s_add_u32 s28, s28, 0x200
    v_lshl_or_b32 v21, v19, 16, v17
    ds_write_b32 v15, v21 offset:1024
    ds_read_u16 v17, v253 offset:16
    ds_read_u16 v19, v253 offset:52
    s_and_b32 s41, s4, 1
    s_mul_i32 s41, s41, 120
    v_add_u32 v11, s41, v0
    s_mul_i32 s38, s39, 1920
    s_add_u32 s38, s38, 153600
    v_cmp_gt_u32 vcc, 160, v11
    v_lshrrev_b32 v12, 4, v11
    v_and_b32 v13, 15, v11
    v_lshrrev_b32 v9, 3, v11
    v_subrev_u32 v9, 20, v9
    s_waitcnt vmcnt(4) lgkmcnt(6)
    s_barrier
    v_mfma_f32_16x16x32_bf16 v[24:27], v[136:139], v[164:167], v[24:27]
    ds_read_b64_tr_b16 v[208:209], v3 offset:0
    v_mfma_f32_16x16x32_bf16 v[28:31], v[140:143], v[164:167], v[28:31]
    ds_read_b64_tr_b16 v[210:211], v4 offset:0
    v_mfma_f32_16x16x32_bf16 v[32:35], v[144:147], v[164:167], v[32:35]
    ds_read_b64_tr_b16 v[180:181], v1 offset:0
    v_mfma_f32_16x16x32_bf16 v[36:39], v[148:151], v[164:167], v[36:39]
    ds_read_b64_tr_b16 v[182:183], v1 offset:432
    v_mfma_f32_16x16x32_bf16 v[40:43], v[152:155], v[164:167], v[40:43]
    ds_read_b64_tr_b16 v[184:185], v1 offset:32
    v_mfma_f32_16x16x32_bf16 v[44:47], v[156:159], v[164:167], v[44:47]
    ds_read_b64_tr_b16 v[186:187], v1 offset:464
    v_mfma_f32_16x16x32_bf16 v[48:51], v[160:163], v[164:167], v[48:51]
    ds_read_b64_tr_b16 v[188:189], v1 offset:144
    s_waitcnt lgkmcnt(7)
    v_mfma_f32_16x16x32_bf16 v[76:79], v[160:163], v[168:171], v[76:79]
    ds_read_b64_tr_b16 v[190:191], v1 offset:576
    v_mfma_f32_16x16x32_bf16 v[72:75], v[156:159], v[168:171], v[72:75]
    ds_read_b64_tr_b16 v[192:193], v1 offset:176
    v_mfma_f32_16x16x32_bf16 v[68:71], v[152:155], v[168:171], v[68:71]
    ds_read_b64_tr_b16 v[194:195], v1 offset:608
    v_mfma_f32_16x16x32_bf16 v[64:67], v[148:151], v[168:171], v[64:67]
    ds_read_b64_tr_b16 v[196:197], v2 offset:0
    v_mfma_f32_16x16x32_bf16 v[60:63], v[144:147], v[168:171], v[60:63]
    ds_read_b64_tr_b16 v[198:199], v2 offset:432
    v_mfma_f32_16x16x32_bf16 v[56:59], v[140:143], v[168:171], v[56:59]
    ds_read_b64_tr_b16 v[200:201], v1 offset:288
    v_mfma_f32_16x16x32_bf16 v[52:55], v[136:139], v[168:171], v[52:55]
    ds_read_b64_tr_b16 v[202:203], v1 offset:720
    v_mfma_f32_16x16x32_bf16 v[80:83], v[136:139], v[172:175], v[80:83]
    ds_read_b64_tr_b16 v[204:205], v1 offset:320
    v_mfma_f32_16x16x32_bf16 v[84:87], v[140:143], v[172:175], v[84:87]
    ds_read_b64_tr_b16 v[206:207], v1 offset:752
    v_mfma_f32_16x16x32_bf16 v[88:91], v[144:147], v[172:175], v[88:91]
    ds_read_b64_tr_b16 v[212:213], v3 offset:1024
    v_mfma_f32_16x16x32_bf16 v[92:95], v[148:151], v[172:175], v[92:95]
    ds_read_b64_tr_b16 v[214:215], v4 offset:1024
    v_mfma_f32_16x16x32_bf16 v[96:99], v[152:155], v[172:175], v[96:99]
    ds_read_b64_tr_b16 v[216:217], v3 offset:2048
    v_mfma_f32_16x16x32_bf16 v[100:103], v[156:159], v[172:175], v[100:103]
    ds_read_b64_tr_b16 v[218:219], v4 offset:2048
    v_mfma_f32_16x16x32_bf16 v[104:107], v[160:163], v[172:175], v[104:107]
    ds_read_b64_tr_b16 v[220:221], v3 offset:3072
    v_mfma_f32_16x16x32_bf16 v[132:135], v[160:163], v[176:179], v[132:135]
    ds_read_b64_tr_b16 v[222:223], v4 offset:3072
    v_mfma_f32_16x16x32_bf16 v[128:131], v[156:159], v[176:179], v[128:131]
    v_add_u32 v1, 0, v224
    v_mfma_f32_16x16x32_bf16 v[124:127], v[152:155], v[176:179], v[124:127]
    v_add_u32 v2, 0, v225
    v_mfma_f32_16x16x32_bf16 v[120:123], v[148:151], v[176:179], v[120:123]
    v_add_u32 v3, 0, v226
    v_mfma_f32_16x16x32_bf16 v[116:119], v[144:147], v[176:179], v[116:119]
    v_add_u32 v4, 0, v227
    v_mfma_f32_16x16x32_bf16 v[112:115], v[140:143], v[176:179], v[112:115]
    v_mfma_f32_16x16x32_bf16 v[108:111], v[136:139], v[176:179], v[108:111]
    s_add_u32 m0, s99, 30720
    s_nop 0
    buffer_load_dwordx4 v228, s[44:47], s28 offen offset:0 sc1 lds
    buffer_load_dwordx4 v229, s[44:47], s28 offen offset:1024 sc1 lds
    buffer_load_dwordx4 v230, s[44:47], s28 offen offset:2048 sc1 lds
    buffer_load_dwordx4 v231, s[44:47], s28 offen offset:3072 sc1 lds
    s_add_u32 s28, s28, 0x200
    v_lshl_or_b32 v21, v19, 16, v17
    ds_write_b32 v15, v21 offset:2048
    ds_read_u16 v17, v253 offset:24
    ds_read_u16 v19, v253 offset:60
    v_and_or_b32 v10, v11, 7, 16
    v_cndmask_b32 v12, v9, v12, vcc
    v_cndmask_b32 v13, v10, v13, vcc
    v_mul_u32_u24 v13, 80, v13
    v_lshlrev_b32 v12, 3, v12
    v_add3_u32 v241, v13, v12, s38
    v_lshlrev_b32 v239, 4, v11
    v_add_u32 v11, 64, v11
    v_cmp_gt_u32 vcc, 160, v11
    v_lshrrev_b32 v12, 4, v11
    s_waitcnt vmcnt(4) lgkmcnt(6)
    s_barrier
    v_mfma_f32_16x16x32_bf16 v[24:27], v[180:183], v[208:211], v[24:27]
    ds_read_b64_tr_b16 v[164:165], v3 offset:0
    v_mfma_f32_16x16x32_bf16 v[28:31], v[184:187], v[208:211], v[28:31]
    ds_read_b64_tr_b16 v[166:167], v4 offset:0
    v_mfma_f32_16x16x32_bf16 v[32:35], v[188:191], v[208:211], v[32:35]
    ds_read_b64_tr_b16 v[136:137], v1 offset:0
    v_mfma_f32_16x16x32_bf16 v[36:39], v[192:195], v[208:211], v[36:39]
    ds_read_b64_tr_b16 v[138:139], v1 offset:432
    v_mfma_f32_16x16x32_bf16 v[40:43], v[196:199], v[208:211], v[40:43]
    ds_read_b64_tr_b16 v[140:141], v1 offset:32
    v_mfma_f32_16x16x32_bf16 v[44:47], v[200:203], v[208:211], v[44:47]
    ds_read_b64_tr_b16 v[142:143], v1 offset:464
    v_mfma_f32_16x16x32_bf16 v[48:51], v[204:207], v[208:211], v[48:51]
    ds_read_b64_tr_b16 v[144:145], v1 offset:144
    s_waitcnt lgkmcnt(7)
    v_mfma_f32_16x16x32_bf16 v[76:79], v[204:207], v[212:215], v[76:79]
    ds_read_b64_tr_b16 v[146:147], v1 offset:576
    v_mfma_f32_16x16x32_bf16 v[72:75], v[200:203], v[212:215], v[72:75]
    ds_read_b64_tr_b16 v[148:149], v1 offset:176
    v_mfma_f32_16x16x32_bf16 v[68:71], v[196:199], v[212:215], v[68:71]
    ds_read_b64_tr_b16 v[150:151], v1 offset:608
    v_mfma_f32_16x16x32_bf16 v[64:67], v[192:195], v[212:215], v[64:67]
    ds_read_b64_tr_b16 v[152:153], v2 offset:0
    v_mfma_f32_16x16x32_bf16 v[60:63], v[188:191], v[212:215], v[60:63]
    ds_read_b64_tr_b16 v[154:155], v2 offset:432
    v_mfma_f32_16x16x32_bf16 v[56:59], v[184:187], v[212:215], v[56:59]
    ds_read_b64_tr_b16 v[156:157], v1 offset:288
    v_mfma_f32_16x16x32_bf16 v[52:55], v[180:183], v[212:215], v[52:55]
    ds_read_b64_tr_b16 v[158:159], v1 offset:720
    v_mfma_f32_16x16x32_bf16 v[80:83], v[180:183], v[216:219], v[80:83]
    ds_read_b64_tr_b16 v[160:161], v1 offset:320
    v_mfma_f32_16x16x32_bf16 v[84:87], v[184:187], v[216:219], v[84:87]
    ds_read_b64_tr_b16 v[162:163], v1 offset:752
    v_mfma_f32_16x16x32_bf16 v[88:91], v[188:191], v[216:219], v[88:91]
    ds_read_b64_tr_b16 v[168:169], v3 offset:1024
    v_mfma_f32_16x16x32_bf16 v[92:95], v[192:195], v[216:219], v[92:95]
    ds_read_b64_tr_b16 v[170:171], v4 offset:1024
    v_mfma_f32_16x16x32_bf16 v[96:99], v[196:199], v[216:219], v[96:99]
    ds_read_b64_tr_b16 v[172:173], v3 offset:2048
    v_mfma_f32_16x16x32_bf16 v[100:103], v[200:203], v[216:219], v[100:103]
    ds_read_b64_tr_b16 v[174:175], v4 offset:2048
    v_mfma_f32_16x16x32_bf16 v[104:107], v[204:207], v[216:219], v[104:107]
    ds_read_b64_tr_b16 v[176:177], v3 offset:3072
    v_mfma_f32_16x16x32_bf16 v[132:135], v[204:207], v[220:223], v[132:135]
    ds_read_b64_tr_b16 v[178:179], v4 offset:3072
    v_mfma_f32_16x16x32_bf16 v[128:131], v[200:203], v[220:223], v[128:131]
    v_add_u32 v1, 30720, v224
    v_mfma_f32_16x16x32_bf16 v[124:127], v[196:199], v[220:223], v[124:127]
    v_add_u32 v2, 30720, v225
    v_mfma_f32_16x16x32_bf16 v[120:123], v[192:195], v[220:223], v[120:123]
    v_add_u32 v3, 30720, v226
    v_mfma_f32_16x16x32_bf16 v[116:119], v[188:191], v[220:223], v[116:119]
    v_add_u32 v4, 30720, v227
    v_mfma_f32_16x16x32_bf16 v[112:115], v[184:187], v[220:223], v[112:115]
    v_mfma_f32_16x16x32_bf16 v[108:111], v[180:183], v[220:223], v[108:111]
    s_add_u32 m0, s99, 61440
    s_nop 0
    buffer_load_dwordx4 v228, s[44:47], s28 offen offset:0 sc1 lds
    buffer_load_dwordx4 v229, s[44:47], s28 offen offset:1024 sc1 lds
    buffer_load_dwordx4 v230, s[44:47], s28 offen offset:2048 sc1 lds
    buffer_load_dwordx4 v231, s[44:47], s28 offen offset:3072 sc1 lds
    s_add_u32 s28, s28, 0x200
    v_lshl_or_b32 v21, v19, 16, v17
    ds_write_b32 v15, v21 offset:3072
    ds_read_u16 v17, v253 offset:32
    ds_read_u16 v19, v253 offset:68
    v_and_b32 v13, 15, v11
    v_lshrrev_b32 v9, 3, v11
    v_subrev_u32 v9, 20, v9
    v_and_or_b32 v10, v11, 7, 16
    v_cndmask_b32 v12, v9, v12, vcc
    v_cndmask_b32 v13, v10, v13, vcc
    v_mul_u32_u24 v13, 80, v13
    v_lshlrev_b32 v12, 3, v12
    v_add3_u32 v242, v13, v12, s38
    v_lshlrev_b32 v240, 4, v11
    s_waitcnt vmcnt(4) lgkmcnt(6)
    s_barrier
    v_mfma_f32_16x16x32_bf16 v[24:27], v[136:139], v[164:167], v[24:27]
    ds_read_b64_tr_b16 v[208:209], v3 offset:0
    v_mfma_f32_16x16x32_bf16 v[28:31], v[140:143], v[164:167], v[28:31]
    ds_read_b64_tr_b16 v[210:211], v4 offset:0
    v_mfma_f32_16x16x32_bf16 v[32:35], v[144:147], v[164:167], v[32:35]
    ds_read_b64_tr_b16 v[180:181], v1 offset:0
    v_mfma_f32_16x16x32_bf16 v[36:39], v[148:151], v[164:167], v[36:39]
    ds_read_b64_tr_b16 v[182:183], v1 offset:432
    v_mfma_f32_16x16x32_bf16 v[40:43], v[152:155], v[164:167], v[40:43]
    ds_read_b64_tr_b16 v[184:185], v1 offset:32
    v_mfma_f32_16x16x32_bf16 v[44:47], v[156:159], v[164:167], v[44:47]
    ds_read_b64_tr_b16 v[186:187], v1 offset:464
    v_mfma_f32_16x16x32_bf16 v[48:51], v[160:163], v[164:167], v[48:51]
    ds_read_b64_tr_b16 v[188:189], v1 offset:144
    s_waitcnt lgkmcnt(7)
    v_mfma_f32_16x16x32_bf16 v[76:79], v[160:163], v[168:171], v[76:79]
    ds_read_b64_tr_b16 v[190:191], v1 offset:576
    v_mfma_f32_16x16x32_bf16 v[72:75], v[156:159], v[168:171], v[72:75]
    ds_read_b64_tr_b16 v[192:193], v1 offset:176
    v_mfma_f32_16x16x32_bf16 v[68:71], v[152:155], v[168:171], v[68:71]
    ds_read_b64_tr_b16 v[194:195], v1 offset:608
    v_mfma_f32_16x16x32_bf16 v[64:67], v[148:151], v[168:171], v[64:67]
    ds_read_b64_tr_b16 v[196:197], v2 offset:0
    v_mfma_f32_16x16x32_bf16 v[60:63], v[144:147], v[168:171], v[60:63]
    ds_read_b64_tr_b16 v[198:199], v2 offset:432
    v_mfma_f32_16x16x32_bf16 v[56:59], v[140:143], v[168:171], v[56:59]
    ds_read_b64_tr_b16 v[200:201], v1 offset:288
    v_mfma_f32_16x16x32_bf16 v[52:55], v[136:139], v[168:171], v[52:55]
    ds_read_b64_tr_b16 v[202:203], v1 offset:720
    v_mfma_f32_16x16x32_bf16 v[80:83], v[136:139], v[172:175], v[80:83]
    ds_read_b64_tr_b16 v[204:205], v1 offset:320
    v_mfma_f32_16x16x32_bf16 v[84:87], v[140:143], v[172:175], v[84:87]
    ds_read_b64_tr_b16 v[206:207], v1 offset:752
    v_mfma_f32_16x16x32_bf16 v[88:91], v[144:147], v[172:175], v[88:91]
    ds_read_b64_tr_b16 v[212:213], v3 offset:1024
    v_mfma_f32_16x16x32_bf16 v[92:95], v[148:151], v[172:175], v[92:95]
    ds_read_b64_tr_b16 v[214:215], v4 offset:1024
    v_mfma_f32_16x16x32_bf16 v[96:99], v[152:155], v[172:175], v[96:99]
    ds_read_b64_tr_b16 v[216:217], v3 offset:2048
    v_mfma_f32_16x16x32_bf16 v[100:103], v[156:159], v[172:175], v[100:103]
    ds_read_b64_tr_b16 v[218:219], v4 offset:2048
    v_mfma_f32_16x16x32_bf16 v[104:107], v[160:163], v[172:175], v[104:107]
    ds_read_b64_tr_b16 v[220:221], v3 offset:3072
    v_mfma_f32_16x16x32_bf16 v[132:135], v[160:163], v[176:179], v[132:135]
    ds_read_b64_tr_b16 v[222:223], v4 offset:3072
    v_mfma_f32_16x16x32_bf16 v[128:131], v[156:159], v[176:179], v[128:131]
    v_add_u32 v1, 61440, v224
    v_mfma_f32_16x16x32_bf16 v[124:127], v[152:155], v[176:179], v[124:127]
    v_add_u32 v2, 61440, v225
    v_mfma_f32_16x16x32_bf16 v[120:123], v[148:151], v[176:179], v[120:123]
    v_add_u32 v3, 61440, v226
    v_mfma_f32_16x16x32_bf16 v[116:119], v[144:147], v[176:179], v[116:119]
    v_add_u32 v4, 61440, v227
    v_mfma_f32_16x16x32_bf16 v[112:115], v[140:143], v[176:179], v[112:115]
    v_mfma_f32_16x16x32_bf16 v[108:111], v[136:139], v[176:179], v[108:111]
    s_add_u32 m0, s99, 92160
    s_nop 0
    buffer_load_dwordx4 v228, s[44:47], s28 offen offset:0 sc1 lds
    buffer_load_dwordx4 v229, s[44:47], s28 offen offset:1024 sc1 lds
    buffer_load_dwordx4 v230, s[44:47], s28 offen offset:2048 sc1 lds
    buffer_load_dwordx4 v231, s[44:47], s28 offen offset:3072 sc1 lds
    s_add_u32 s28, s28, 0x200
    v_lshl_or_b32 v21, v19, 16, v17
    ds_write_b32 v15, v21 offset:4096
    ds_read_u16 v17, v254 offset:0
    ds_read_u16 v19, v254 offset:36
    v_cmp_gt_u32 vcc, 56, v0
    v_mov_b32 v12, 149632
    s_nop 0
    v_cndmask_b32 v240, v7, v240, vcc
    v_cndmask_b32 v242, v12, v242, vcc
    v_lshrrev_b32 v11, 3, v6
    v_and_b32 v12, 7, v0
    v_cmp_eq_u32 vcc, v11, v14
    s_mul_i32 s41, s98, 3840
    s_add_u32 s41, s41, 153600
    s_waitcnt vmcnt(4) lgkmcnt(6)
    s_barrier
    v_mfma_f32_16x16x32_bf16 v[24:27], v[180:183], v[208:211], v[24:27]
    ds_read_b64_tr_b16 v[164:165], v3 offset:0
    v_mfma_f32_16x16x32_bf16 v[28:31], v[184:187], v[208:211], v[28:31]
    ds_read_b64_tr_b16 v[166:167], v4 offset:0
    v_mfma_f32_16x16x32_bf16 v[32:35], v[188:191], v[208:211], v[32:35]
    ds_read_b64_tr_b16 v[136:137], v1 offset:0
    v_mfma_f32_16x16x32_bf16 v[36:39], v[192:195], v[208:211], v[36:39]
    ds_read_b64_tr_b16 v[138:139], v1 offset:432
    v_mfma_f32_16x16x32_bf16 v[40:43], v[196:199], v[208:211], v[40:43]
    ds_read_b64_tr_b16 v[140:141], v1 offset:32
    v_mfma_f32_16x16x32_bf16 v[44:47], v[200:203], v[208:211], v[44:47]
    ds_read_b64_tr_b16 v[142:143], v1 offset:464
    v_mfma_f32_16x16x32_bf16 v[48:51], v[204:207], v[208:211], v[48:51]
    ds_read_b64_tr_b16 v[144:145], v1 offset:144
    s_waitcnt lgkmcnt(7)
    v_mfma_f32_16x16x32_bf16 v[76:79], v[204:207], v[212:215], v[76:79]
    ds_read_b64_tr_b16 v[146:147], v1 offset:576
    v_mfma_f32_16x16x32_bf16 v[72:75], v[200:203], v[212:215], v[72:75]
    ds_read_b64_tr_b16 v[148:149], v1 offset:176
    v_mfma_f32_16x16x32_bf16 v[68:71], v[196:199], v[212:215], v[68:71]
    ds_read_b64_tr_b16 v[150:151], v1 offset:608
    v_mfma_f32_16x16x32_bf16 v[64:67], v[192:195], v[212:215], v[64:67]
    ds_read_b64_tr_b16 v[152:153], v2 offset:0
    v_mfma_f32_16x16x32_bf16 v[60:63], v[188:191], v[212:215], v[60:63]
    ds_read_b64_tr_b16 v[154:155], v2 offset:432
    v_mfma_f32_16x16x32_bf16 v[56:59], v[184:187], v[212:215], v[56:59]
    ds_read_b64_tr_b16 v[156:157], v1 offset:288
    v_mfma_f32_16x16x32_bf16 v[52:55], v[180:183], v[212:215], v[52:55]
    ds_read_b64_tr_b16 v[158:159], v1 offset:720
    v_mfma_f32_16x16x32_bf16 v[80:83], v[180:183], v[216:219], v[80:83]
    ds_read_b64_tr_b16 v[160:161], v1 offset:320
    v_mfma_f32_16x16x32_bf16 v[84:87], v[184:187], v[216:219], v[84:87]
    ds_read_b64_tr_b16 v[162:163], v1 offset:752
    v_mfma_f32_16x16x32_bf16 v[88:91], v[188:191], v[216:219], v[88:91]
    ds_read_b64_tr_b16 v[168:169], v3 offset:1024
    v_mfma_f32_16x16x32_bf16 v[92:95], v[192:195], v[216:219], v[92:95]
    ds_read_b64_tr_b16 v[170:171], v4 offset:1024
    v_mfma_f32_16x16x32_bf16 v[96:99], v[196:199], v[216:219], v[96:99]
    ds_read_b64_tr_b16 v[172:173], v3 offset:2048
    v_mfma_f32_16x16x32_bf16 v[100:103], v[200:203], v[216:219], v[100:103]
    ds_read_b64_tr_b16 v[174:175], v4 offset:2048
    v_mfma_f32_16x16x32_bf16 v[104:107], v[204:207], v[216:219], v[104:107]
    ds_read_b64_tr_b16 v[176:177], v3 offset:3072
    v_mfma_f32_16x16x32_bf16 v[132:135], v[204:207], v[220:223], v[132:135]
    ds_read_b64_tr_b16 v[178:179], v4 offset:3072
    v_mfma_f32_16x16x32_bf16 v[128:131], v[200:203], v[220:223], v[128:131]
    v_add_u32 v1, 92160, v224
    v_mfma_f32_16x16x32_bf16 v[124:127], v[196:199], v[220:223], v[124:127]
    v_add_u32 v2, 92160, v225
    v_mfma_f32_16x16x32_bf16 v[120:123], v[192:195], v[220:223], v[120:123]
    v_add_u32 v3, 92160, v226
    v_mfma_f32_16x16x32_bf16 v[116:119], v[188:191], v[220:223], v[116:119]
    v_add_u32 v4, 92160, v227
    v_mfma_f32_16x16x32_bf16 v[112:115], v[184:187], v[220:223], v[112:115]
    v_mfma_f32_16x16x32_bf16 v[108:111], v[180:183], v[220:223], v[108:111]
    s_add_u32 m0, s99, 0
    s_nop 0
    buffer_load_dwordx4 v228, s[44:47], s28 offen offset:0 sc1 lds
    buffer_load_dwordx4 v229, s[44:47], s28 offen offset:1024 sc1 lds
    buffer_load_dwordx4 v230, s[44:47], s28 offen offset:2048 sc1 lds
    buffer_load_dwordx4 v231, s[44:47], s28 offen offset:3072 sc1 lds
    s_add_u32 s28, s28, 0x200
    v_lshl_or_b32 v21, v19, 16, v17
    ds_write_b32 v15, v21 offset:5120
    ds_read_u16 v17, v254 offset:8
    ds_read_u16 v19, v254 offset:44
    v_mul_u32_u24 v9, 1920, v11
    v_mul_u32_u24 v10, 40, v8
    v_add3_u32 v9, v9, v10, s41
    v_lshlrev_b32 v10, 1, v11
    v_sub_u32 v10, v12, v10
    v_mov_b32 v247, 149504
    v_add_u32 v13, 20, v10
    v_add_u32 v243, 0, v10
    v_min_u32 v13, v13, v243
    v_min_u32 v13, 20, v13
    s_waitcnt vmcnt(4) lgkmcnt(6)
    s_barrier
    v_mfma_f32_16x16x32_bf16 v[24:27], v[136:139], v[164:167], v[24:27]
    ds_read_b64_tr_b16 v[208:209], v3 offset:0
    v_mfma_f32_16x16x32_bf16 v[28:31], v[140:143], v[164:167], v[28:31]
    ds_read_b64_tr_b16 v[210:211], v4 offset:0
    v_mfma_f32_16x16x32_bf16 v[32:35], v[144:147], v[164:167], v[32:35]
    ds_read_b64_tr_b16 v[180:181], v1 offset:0
    v_mfma_f32_16x16x32_bf16 v[36:39], v[148:151], v[164:167], v[36:39]
    ds_read_b64_tr_b16 v[182:183], v1 offset:432
    v_mfma_f32_16x16x32_bf16 v[40:43], v[152:155], v[164:167], v[40:43]
    ds_read_b64_tr_b16 v[184:185], v1 offset:32
    v_mfma_f32_16x16x32_bf16 v[44:47], v[156:159], v[164:167], v[44:47]
    ds_read_b64_tr_b16 v[186:187], v1 offset:464
    v_mfma_f32_16x16x32_bf16 v[48:51], v[160:163], v[164:167], v[48:51]
    ds_read_b64_tr_b16 v[188:189], v1 offset:144
    s_waitcnt lgkmcnt(7)
    v_mfma_f32_16x16x32_bf16 v[76:79], v[160:163], v[168:171], v[76:79]
    ds_read_b64_tr_b16 v[190:191], v1 offset:576
    v_mfma_f32_16x16x32_bf16 v[72:75], v[156:159], v[168:171], v[72:75]
    ds_read_b64_tr_b16 v[192:193], v1 offset:176
    v_mfma_f32_16x16x32_bf16 v[68:71], v[152:155], v[168:171], v[68:71]
    ds_read_b64_tr_b16 v[194:195], v1 offset:608
    v_mfma_f32_16x16x32_bf16 v[64:67], v[148:151], v[168:171], v[64:67]
    ds_read_b64_tr_b16 v[196:197], v2 offset:0
    v_mfma_f32_16x16x32_bf16 v[60:63], v[144:147], v[168:171], v[60:63]
    ds_read_b64_tr_b16 v[198:199], v2 offset:432
    v_mfma_f32_16x16x32_bf16 v[56:59], v[140:143], v[168:171], v[56:59]
    ds_read_b64_tr_b16 v[200:201], v1 offset:288
    v_mfma_f32_16x16x32_bf16 v[52:55], v[136:139], v[168:171], v[52:55]
    ds_read_b64_tr_b16 v[202:203], v1 offset:720
    v_mfma_f32_16x16x32_bf16 v[80:83], v[136:139], v[172:175], v[80:83]
    ds_read_b64_tr_b16 v[204:205], v1 offset:320
    v_mfma_f32_16x16x32_bf16 v[84:87], v[140:143], v[172:175], v[84:87]
    ds_read_b64_tr_b16 v[206:207], v1 offset:752
    v_mfma_f32_16x16x32_bf16 v[88:91], v[144:147], v[172:175], v[88:91]
    ds_read_b64_tr_b16 v[212:213], v3 offset:1024
    v_mfma_f32_16x16x32_bf16 v[92:95], v[148:151], v[172:175], v[92:95]
    ds_read_b64_tr_b16 v[214:215], v4 offset:1024
    v_mfma_f32_16x16x32_bf16 v[96:99], v[152:155], v[172:175], v[96:99]
    ds_read_b64_tr_b16 v[216:217], v3 offset:2048
    v_mfma_f32_16x16x32_bf16 v[100:103], v[156:159], v[172:175], v[100:103]
    ds_read_b64_tr_b16 v[218:219], v4 offset:2048
    v_mfma_f32_16x16x32_bf16 v[104:107], v[160:163], v[172:175], v[104:107]
    ds_read_b64_tr_b16 v[220:221], v3 offset:3072
    v_mfma_f32_16x16x32_bf16 v[132:135], v[160:163], v[176:179], v[132:135]
    ds_read_b64_tr_b16 v[222:223], v4 offset:3072
    v_mfma_f32_16x16x32_bf16 v[128:131], v[156:159], v[176:179], v[128:131]
    v_add_u32 v1, 0, v224
    v_mfma_f32_16x16x32_bf16 v[124:127], v[152:155], v[176:179], v[124:127]
    v_add_u32 v2, 0, v225
    v_mfma_f32_16x16x32_bf16 v[120:123], v[148:151], v[176:179], v[120:123]
    v_add_u32 v3, 0, v226
    v_mfma_f32_16x16x32_bf16 v[116:119], v[144:147], v[176:179], v[116:119]
    v_add_u32 v4, 0, v227
    v_mfma_f32_16x16x32_bf16 v[112:115], v[140:143], v[176:179], v[112:115]
    v_mfma_f32_16x16x32_bf16 v[108:111], v[136:139], v[176:179], v[108:111]
    s_add_u32 m0, s99, 30720
    s_nop 0
    buffer_load_dwordx4 v228, s[44:47], s28 offen offset:0 sc1 lds
    buffer_load_dwordx4 v229, s[44:47], s28 offen offset:1024 sc1 lds
    buffer_load_dwordx4 v230, s[44:47], s28 offen offset:2048 sc1 lds
    buffer_load_dwordx4 v231, s[44:47], s28 offen offset:3072 sc1 lds
    s_add_u32 s28, s28, 0x200
    v_lshl_or_b32 v21, v19, 16, v17
    ds_write_b32 v15, v21 offset:6144
    ds_read_u16 v17, v254 offset:16
    ds_read_u16 v19, v254 offset:52
    v_mul_u32_u24 v13, 80, v13
    v_add_u32 v13, v13, v9
    v_cndmask_b32 v243, v247, v13, vcc
    v_add_u32 v13, 28, v10
    v_add_u32 v244, 8, v10
    v_min_u32 v13, v13, v244
    v_min_u32 v13, 20, v13
    v_mul_u32_u24 v13, 80, v13
    v_add_u32 v13, v13, v9
    v_cndmask_b32 v244, v247, v13, vcc
    s_waitcnt vmcnt(4) lgkmcnt(6)
    s_barrier
    v_mfma_f32_16x16x32_bf16 v[24:27], v[180:183], v[208:211], v[24:27]
    ds_read_b64_tr_b16 v[164:165], v3 offset:0
    v_mfma_f32_16x16x32_bf16 v[28:31], v[184:187], v[208:211], v[28:31]
    ds_read_b64_tr_b16 v[166:167], v4 offset:0
    v_mfma_f32_16x16x32_bf16 v[32:35], v[188:191], v[208:211], v[32:35]
    ds_read_b64_tr_b16 v[136:137], v1 offset:0
    v_mfma_f32_16x16x32_bf16 v[36:39], v[192:195], v[208:211], v[36:39]
    ds_read_b64_tr_b16 v[138:139], v1 offset:432
    v_mfma_f32_16x16x32_bf16 v[40:43], v[196:199], v[208:211], v[40:43]
    ds_read_b64_tr_b16 v[140:141], v1 offset:32
    v_mfma_f32_16x16x32_bf16 v[44:47], v[200:203], v[208:211], v[44:47]
    ds_read_b64_tr_b16 v[142:143], v1 offset:464
    v_mfma_f32_16x16x32_bf16 v[48:51], v[204:207], v[208:211], v[48:51]
    ds_read_b64_tr_b16 v[144:145], v1 offset:144
    s_waitcnt lgkmcnt(7)
    v_mfma_f32_16x16x32_bf16 v[76:79], v[204:207], v[212:215], v[76:79]
    ds_read_b64_tr_b16 v[146:147], v1 offset:576
    v_mfma_f32_16x16x32_bf16 v[72:75], v[200:203], v[212:215], v[72:75]
    ds_read_b64_tr_b16 v[148:149], v1 offset:176
    v_mfma_f32_16x16x32_bf16 v[68:71], v[196:199], v[212:215], v[68:71]
    ds_read_b64_tr_b16 v[150:151], v1 offset:608
    v_mfma_f32_16x16x32_bf16 v[64:67], v[192:195], v[212:215], v[64:67]
    ds_read_b64_tr_b16 v[152:153], v2 offset:0
    v_mfma_f32_16x16x32_bf16 v[60:63], v[188:191], v[212:215], v[60:63]
    ds_read_b64_tr_b16 v[154:155], v2 offset:432
    v_mfma_f32_16x16x32_bf16 v[56:59], v[184:187], v[212:215], v[56:59]
    ds_read_b64_tr_b16 v[156:157], v1 offset:288
    v_mfma_f32_16x16x32_bf16 v[52:55], v[180:183], v[212:215], v[52:55]
    ds_read_b64_tr_b16 v[158:159], v1 offset:720
    v_mfma_f32_16x16x32_bf16 v[80:83], v[180:183], v[216:219], v[80:83]
    ds_read_b64_tr_b16 v[160:161], v1 offset:320
    v_mfma_f32_16x16x32_bf16 v[84:87], v[184:187], v[216:219], v[84:87]
    ds_read_b64_tr_b16 v[162:163], v1 offset:752
    v_mfma_f32_16x16x32_bf16 v[88:91], v[188:191], v[216:219], v[88:91]
    ds_read_b64_tr_b16 v[168:169], v3 offset:1024
    v_mfma_f32_16x16x32_bf16 v[92:95], v[192:195], v[216:219], v[92:95]
    ds_read_b64_tr_b16 v[170:171], v4 offset:1024
    v_mfma_f32_16x16x32_bf16 v[96:99], v[196:199], v[216:219], v[96:99]
    ds_read_b64_tr_b16 v[172:173], v3 offset:2048
    v_mfma_f32_16x16x32_bf16 v[100:103], v[200:203], v[216:219], v[100:103]
    ds_read_b64_tr_b16 v[174:175], v4 offset:2048
    v_mfma_f32_16x16x32_bf16 v[104:107], v[204:207], v[216:219], v[104:107]
    ds_read_b64_tr_b16 v[176:177], v3 offset:3072
    v_mfma_f32_16x16x32_bf16 v[132:135], v[204:207], v[220:223], v[132:135]
    ds_read_b64_tr_b16 v[178:179], v4 offset:3072
    v_mfma_f32_16x16x32_bf16 v[128:131], v[200:203], v[220:223], v[128:131]
    v_add_u32 v1, 30720, v224
    v_mfma_f32_16x16x32_bf16 v[124:127], v[196:199], v[220:223], v[124:127]
    v_add_u32 v2, 30720, v225
    v_mfma_f32_16x16x32_bf16 v[120:123], v[192:195], v[220:223], v[120:123]
    v_add_u32 v3, 30720, v226
    v_mfma_f32_16x16x32_bf16 v[116:119], v[188:191], v[220:223], v[116:119]
    v_add_u32 v4, 30720, v227
    v_mfma_f32_16x16x32_bf16 v[112:115], v[184:187], v[220:223], v[112:115]
    v_mfma_f32_16x16x32_bf16 v[108:111], v[180:183], v[220:223], v[108:111]
    s_add_u32 m0, s99, 61440
    s_nop 0
    buffer_load_dwordx4 v228, s[44:47], s28 offen offset:0 sc1 lds
    buffer_load_dwordx4 v229, s[44:47], s28 offen offset:1024 sc1 lds
    buffer_load_dwordx4 v230, s[44:47], s28 offen offset:2048 sc1 lds
    buffer_load_dwordx4 v231, s[44:47], s28 offen offset:3072 sc1 lds
    s_add_u32 s28, s28, 0x200
    v_lshl_or_b32 v21, v19, 16, v17
    ds_write_b32 v15, v21 offset:7168
    ds_read_u16 v17, v254 offset:24
    ds_read_u16 v19, v254 offset:60
    v_add_u32 v13, 36, v10
    v_add_u32 v245, 16, v10
    v_min_u32 v13, v13, v245
    v_min_u32 v13, 20, v13
    v_mul_u32_u24 v13, 80, v13
    v_add_u32 v13, v13, v9
    v_cndmask_b32 v245, v247, v13, vcc
    v_add_u32 v13, 1600, v9
    v_cndmask_b32 v246, v247, v13, vcc
    v_mul_u32_u24 v11, 18, v11
    s_waitcnt vmcnt(4) lgkmcnt(6)
    s_barrier
    v_mfma_f32_16x16x32_bf16 v[24:27], v[136:139], v[164:167], v[24:27]
    ds_read_b64_tr_b16 v[208:209], v3 offset:0
    v_mfma_f32_16x16x32_bf16 v[28:31], v[140:143], v[164:167], v[28:31]
    ds_read_b64_tr_b16 v[210:211], v4 offset:0
    v_mfma_f32_16x16x32_bf16 v[32:35], v[144:147], v[164:167], v[32:35]
    ds_read_b64_tr_b16 v[180:181], v1 offset:0
    v_mfma_f32_16x16x32_bf16 v[36:39], v[148:151], v[164:167], v[36:39]
    ds_read_b64_tr_b16 v[182:183], v1 offset:432
    v_mfma_f32_16x16x32_bf16 v[40:43], v[152:155], v[164:167], v[40:43]
    ds_read_b64_tr_b16 v[184:185], v1 offset:32
    v_mfma_f32_16x16x32_bf16 v[44:47], v[156:159], v[164:167], v[44:47]
    ds_read_b64_tr_b16 v[186:187], v1 offset:464
    v_mfma_f32_16x16x32_bf16 v[48:51], v[160:163], v[164:167], v[48:51]
    ds_read_b64_tr_b16 v[188:189], v1 offset:144
    s_waitcnt lgkmcnt(7)
    v_mfma_f32_16x16x32_bf16 v[76:79], v[160:163], v[168:171], v[76:79]
    ds_read_b64_tr_b16 v[190:191], v1 offset:576
    v_mfma_f32_16x16x32_bf16 v[72:75], v[156:159], v[168:171], v[72:75]
    ds_read_b64_tr_b16 v[192:193], v1 offset:176
    v_mfma_f32_16x16x32_bf16 v[68:71], v[152:155], v[168:171], v[68:71]
    ds_read_b64_tr_b16 v[194:195], v1 offset:608
    v_mfma_f32_16x16x32_bf16 v[64:67], v[148:151], v[168:171], v[64:67]
    ds_read_b64_tr_b16 v[196:197], v2 offset:0
    v_mfma_f32_16x16x32_bf16 v[60:63], v[144:147], v[168:171], v[60:63]
    ds_read_b64_tr_b16 v[198:199], v2 offset:432
    v_mfma_f32_16x16x32_bf16 v[56:59], v[140:143], v[168:171], v[56:59]
    ds_read_b64_tr_b16 v[200:201], v1 offset:288
    v_mfma_f32_16x16x32_bf16 v[52:55], v[136:139], v[168:171], v[52:55]
    ds_read_b64_tr_b16 v[202:203], v1 offset:720
    v_mfma_f32_16x16x32_bf16 v[80:83], v[136:139], v[172:175], v[80:83]
    ds_read_b64_tr_b16 v[204:205], v1 offset:320
    v_mfma_f32_16x16x32_bf16 v[84:87], v[140:143], v[172:175], v[84:87]
    ds_read_b64_tr_b16 v[206:207], v1 offset:752
    v_mfma_f32_16x16x32_bf16 v[88:91], v[144:147], v[172:175], v[88:91]
    ds_read_b64_tr_b16 v[212:213], v3 offset:1024
    v_mfma_f32_16x16x32_bf16 v[92:95], v[148:151], v[172:175], v[92:95]
    ds_read_b64_tr_b16 v[214:215], v4 offset:1024
    v_mfma_f32_16x16x32_bf16 v[96:99], v[152:155], v[172:175], v[96:99]
    ds_read_b64_tr_b16 v[216:217], v3 offset:2048
    v_mfma_f32_16x16x32_bf16 v[100:103], v[156:159], v[172:175], v[100:103]
    ds_read_b64_tr_b16 v[218:219], v4 offset:2048
    v_mfma_f32_16x16x32_bf16 v[104:107], v[160:163], v[172:175], v[104:107]
    ds_read_b64_tr_b16 v[220:221], v3 offset:3072
    v_mfma_f32_16x16x32_bf16 v[132:135], v[160:163], v[176:179], v[132:135]
    ds_read_b64_tr_b16 v[222:223], v4 offset:3072
    v_mfma_f32_16x16x32_bf16 v[128:131], v[156:159], v[176:179], v[128:131]
    v_add_u32 v1, 61440, v224
    v_mfma_f32_16x16x32_bf16 v[124:127], v[152:155], v[176:179], v[124:127]
    v_add_u32 v2, 61440, v225
    v_mfma_f32_16x16x32_bf16 v[120:123], v[148:151], v[176:179], v[120:123]
    v_add_u32 v3, 61440, v226
    v_mfma_f32_16x16x32_bf16 v[116:119], v[144:147], v[176:179], v[116:119]
    v_add_u32 v4, 61440, v227
    v_mfma_f32_16x16x32_bf16 v[112:115], v[140:143], v[176:179], v[112:115]
    v_mfma_f32_16x16x32_bf16 v[108:111], v[136:139], v[176:179], v[108:111]
    s_add_u32 m0, s99, 92160
    s_nop 0
    buffer_load_dwordx4 v228, s[44:47], s28 offen offset:0 sc1 lds
    buffer_load_dwordx4 v229, s[44:47], s28 offen offset:1024 sc1 lds
    buffer_load_dwordx4 v230, s[44:47], s28 offen offset:2048 sc1 lds
    buffer_load_dwordx4 v231, s[44:47], s28 offen offset:3072 sc1 lds
    s_add_u32 s28, s28, 0x200
    v_lshl_or_b32 v21, v19, 16, v17
    ds_write_b32 v15, v21 offset:8192
    ds_read_u16 v17, v254 offset:32
    ds_read_u16 v19, v254 offset:68
    v_add_lshl_u32 v11, v11, v12, 4
    v_lshl_add_u32 v13, v14, 1, v8
    v_cmp_gt_u32 vcc, 2, v12
    s_mul_i32 s41, s4, 4608
    v_mul_u32_u24 v13, 576, v13
    v_add3_u32 v247, v13, v11, s41
    v_mov_b32 v13, 40960
    v_cndmask_b32 v248, v13, v247, vcc
    s_lshl_b32 s37, s96, 2
    s_add_u32 s37, s37, s97
    s_waitcnt vmcnt(4) lgkmcnt(6)
    s_barrier
    v_mfma_f32_16x16x32_bf16 v[24:27], v[180:183], v[208:211], v[24:27]
    ds_read_b64_tr_b16 v[164:165], v3 offset:0
    v_mfma_f32_16x16x32_bf16 v[28:31], v[184:187], v[208:211], v[28:31]
    ds_read_b64_tr_b16 v[166:167], v4 offset:0
    v_mfma_f32_16x16x32_bf16 v[32:35], v[188:191], v[208:211], v[32:35]
    ds_read_b64_tr_b16 v[136:137], v1 offset:0
    v_mfma_f32_16x16x32_bf16 v[36:39], v[192:195], v[208:211], v[36:39]
    ds_read_b64_tr_b16 v[138:139], v1 offset:432
    v_mfma_f32_16x16x32_bf16 v[40:43], v[196:199], v[208:211], v[40:43]
    ds_read_b64_tr_b16 v[140:141], v1 offset:32
    v_mfma_f32_16x16x32_bf16 v[44:47], v[200:203], v[208:211], v[44:47]
    ds_read_b64_tr_b16 v[142:143], v1 offset:464
    v_mfma_f32_16x16x32_bf16 v[48:51], v[204:207], v[208:211], v[48:51]
    ds_read_b64_tr_b16 v[144:145], v1 offset:144
    s_waitcnt lgkmcnt(7)
    v_mfma_f32_16x16x32_bf16 v[76:79], v[204:207], v[212:215], v[76:79]
    ds_read_b64_tr_b16 v[146:147], v1 offset:576
    v_mfma_f32_16x16x32_bf16 v[72:75], v[200:203], v[212:215], v[72:75]
    ds_read_b64_tr_b16 v[148:149], v1 offset:176
    v_mfma_f32_16x16x32_bf16 v[68:71], v[196:199], v[212:215], v[68:71]
    ds_read_b64_tr_b16 v[150:151], v1 offset:608
    v_mfma_f32_16x16x32_bf16 v[64:67], v[192:195], v[212:215], v[64:67]
    ds_read_b64_tr_b16 v[152:153], v2 offset:0
    v_mfma_f32_16x16x32_bf16 v[60:63], v[188:191], v[212:215], v[60:63]
    ds_read_b64_tr_b16 v[154:155], v2 offset:432
    v_mfma_f32_16x16x32_bf16 v[56:59], v[184:187], v[212:215], v[56:59]
    ds_read_b64_tr_b16 v[156:157], v1 offset:288
    v_mfma_f32_16x16x32_bf16 v[52:55], v[180:183], v[212:215], v[52:55]
    ds_read_b64_tr_b16 v[158:159], v1 offset:720
    v_mfma_f32_16x16x32_bf16 v[80:83], v[180:183], v[216:219], v[80:83]
    ds_read_b64_tr_b16 v[160:161], v1 offset:320
    v_mfma_f32_16x16x32_bf16 v[84:87], v[184:187], v[216:219], v[84:87]
    ds_read_b64_tr_b16 v[162:163], v1 offset:752
    v_mfma_f32_16x16x32_bf16 v[88:91], v[188:191], v[216:219], v[88:91]
    ds_read_b64_tr_b16 v[168:169], v3 offset:1024
    v_mfma_f32_16x16x32_bf16 v[92:95], v[192:195], v[216:219], v[92:95]
    ds_read_b64_tr_b16 v[170:171], v4 offset:1024
    v_mfma_f32_16x16x32_bf16 v[96:99], v[196:199], v[216:219], v[96:99]
    ds_read_b64_tr_b16 v[172:173], v3 offset:2048
    v_mfma_f32_16x16x32_bf16 v[100:103], v[200:203], v[216:219], v[100:103]
    ds_read_b64_tr_b16 v[174:175], v4 offset:2048
    v_mfma_f32_16x16x32_bf16 v[104:107], v[204:207], v[216:219], v[104:107]
    ds_read_b64_tr_b16 v[176:177], v3 offset:3072
    v_mfma_f32_16x16x32_bf16 v[132:135], v[204:207], v[220:223], v[132:135]
    ds_read_b64_tr_b16 v[178:179], v4 offset:3072
    v_mfma_f32_16x16x32_bf16 v[128:131], v[200:203], v[220:223], v[128:131]
    v_add_u32 v1, 92160, v224
    v_mfma_f32_16x16x32_bf16 v[124:127], v[196:199], v[220:223], v[124:127]
    v_add_u32 v2, 92160, v225
    v_mfma_f32_16x16x32_bf16 v[120:123], v[192:195], v[220:223], v[120:123]
    v_add_u32 v3, 92160, v226
    v_mfma_f32_16x16x32_bf16 v[116:119], v[188:191], v[220:223], v[116:119]
    v_add_u32 v4, 92160, v227
    v_mfma_f32_16x16x32_bf16 v[112:115], v[184:187], v[220:223], v[112:115]
    v_mfma_f32_16x16x32_bf16 v[108:111], v[180:183], v[220:223], v[108:111]
    s_add_u32 m0, s99, 0
    s_nop 0
    buffer_load_dwordx4 v228, s[44:47], s28 offen offset:0 sc1 lds
    buffer_load_dwordx4 v229, s[44:47], s28 offen offset:1024 sc1 lds
    buffer_load_dwordx4 v230, s[44:47], s28 offen offset:2048 sc1 lds
    buffer_load_dwordx4 v231, s[44:47], s28 offen offset:3072 sc1 lds
    s_add_u32 s28, s28, 0x200
    v_lshl_or_b32 v21, v19, 16, v17
    ds_write_b32 v15, v21 offset:9216
    s_mul_i32 s37, s37, 73728
    s_mul_i32 s41, s5, 1152
    s_add_u32 s37, s37, s41
    s_mul_i32 s41, s98, 576
    s_add_u32 s37, s37, s41
    s_add_u32 s37, s37, 10485760
    s_waitcnt vmcnt(4) lgkmcnt(6)
    s_barrier
    v_mfma_f32_16x16x32_bf16 v[24:27], v[136:139], v[164:167], v[24:27]
    ds_read_b64_tr_b16 v[208:209], v3 offset:0
    v_mfma_f32_16x16x32_bf16 v[28:31], v[140:143], v[164:167], v[28:31]
    ds_read_b64_tr_b16 v[210:211], v4 offset:0
    v_mfma_f32_16x16x32_bf16 v[32:35], v[144:147], v[164:167], v[32:35]
    ds_read_b64_tr_b16 v[180:181], v1 offset:0
    v_mfma_f32_16x16x32_bf16 v[36:39], v[148:151], v[164:167], v[36:39]
    ds_read_b64_tr_b16 v[182:183], v1 offset:432
    v_mfma_f32_16x16x32_bf16 v[40:43], v[152:155], v[164:167], v[40:43]
    ds_read_b64_tr_b16 v[184:185], v1 offset:32
    v_mfma_f32_16x16x32_bf16 v[44:47], v[156:159], v[164:167], v[44:47]
    ds_read_b64_tr_b16 v[186:187], v1 offset:464
    v_mfma_f32_16x16x32_bf16 v[48:51], v[160:163], v[164:167], v[48:51]
    ds_read_b64_tr_b16 v[188:189], v1 offset:144
    s_waitcnt lgkmcnt(7)
    v_mfma_f32_16x16x32_bf16 v[76:79], v[160:163], v[168:171], v[76:79]
    ds_read_b64_tr_b16 v[190:191], v1 offset:576
    v_mfma_f32_16x16x32_bf16 v[72:75], v[156:159], v[168:171], v[72:75]
    ds_read_b64_tr_b16 v[192:193], v1 offset:176
    v_mfma_f32_16x16x32_bf16 v[68:71], v[152:155], v[168:171], v[68:71]
    ds_read_b64_tr_b16 v[194:195], v1 offset:608
    v_mfma_f32_16x16x32_bf16 v[64:67], v[148:151], v[168:171], v[64:67]
    ds_read_b64_tr_b16 v[196:197], v2 offset:0
    v_mfma_f32_16x16x32_bf16 v[60:63], v[144:147], v[168:171], v[60:63]
    ds_read_b64_tr_b16 v[198:199], v2 offset:432
    v_mfma_f32_16x16x32_bf16 v[56:59], v[140:143], v[168:171], v[56:59]
    ds_read_b64_tr_b16 v[200:201], v1 offset:288
    v_mfma_f32_16x16x32_bf16 v[52:55], v[136:139], v[168:171], v[52:55]
    ds_read_b64_tr_b16 v[202:203], v1 offset:720
    v_mfma_f32_16x16x32_bf16 v[80:83], v[136:139], v[172:175], v[80:83]
    ds_read_b64_tr_b16 v[204:205], v1 offset:320
    v_mfma_f32_16x16x32_bf16 v[84:87], v[140:143], v[172:175], v[84:87]
    ds_read_b64_tr_b16 v[206:207], v1 offset:752
    v_mfma_f32_16x16x32_bf16 v[88:91], v[144:147], v[172:175], v[88:91]
    ds_read_b64_tr_b16 v[212:213], v3 offset:1024
    v_mfma_f32_16x16x32_bf16 v[92:95], v[148:151], v[172:175], v[92:95]
    ds_read_b64_tr_b16 v[214:215], v4 offset:1024
    v_mfma_f32_16x16x32_bf16 v[96:99], v[152:155], v[172:175], v[96:99]
    ds_read_b64_tr_b16 v[216:217], v3 offset:2048
    v_mfma_f32_16x16x32_bf16 v[100:103], v[156:159], v[172:175], v[100:103]
    ds_read_b64_tr_b16 v[218:219], v4 offset:2048
    v_mfma_f32_16x16x32_bf16 v[104:107], v[160:163], v[172:175], v[104:107]
    ds_read_b64_tr_b16 v[220:221], v3 offset:3072
    v_mfma_f32_16x16x32_bf16 v[132:135], v[160:163], v[176:179], v[132:135]
    ds_read_b64_tr_b16 v[222:223], v4 offset:3072
    v_mfma_f32_16x16x32_bf16 v[128:131], v[156:159], v[176:179], v[128:131]
    v_add_u32 v1, 0, v224
    v_mfma_f32_16x16x32_bf16 v[124:127], v[152:155], v[176:179], v[124:127]
    v_add_u32 v2, 0, v225
    v_mfma_f32_16x16x32_bf16 v[120:123], v[148:151], v[176:179], v[120:123]
    v_add_u32 v3, 0, v226
    v_mfma_f32_16x16x32_bf16 v[116:119], v[144:147], v[176:179], v[116:119]
    v_add_u32 v4, 0, v227
    v_mfma_f32_16x16x32_bf16 v[112:115], v[140:143], v[176:179], v[112:115]
    v_mfma_f32_16x16x32_bf16 v[108:111], v[136:139], v[176:179], v[108:111]
    s_add_u32 m0, s99, 30720
    s_nop 0
    buffer_load_dwordx4 v228, s[44:47], s28 offen offset:0 sc1 lds
    buffer_load_dwordx4 v229, s[44:47], s28 offen offset:1024 sc1 lds
    buffer_load_dwordx4 v230, s[44:47], s28 offen offset:2048 sc1 lds
    buffer_load_dwordx4 v231, s[44:47], s28 offen offset:3072 sc1 lds
    s_add_u32 s28, s28, 0x200
    s_add_u32 s43, s63, 0
    s_mul_i32 s3, s43, 683
    s_lshr_b32 s3, s3, 16
    s_lshl_b32 s48, s3, 2
    s_lshr_b64 s[48:49], s[100:101], s48
    s_and_b32 s48, s48, 15
    s_sub_i32 s3, s48, s3
    s_mul_i32 s3, s3, 96
    s_add_i32 s3, s3, s43
    s_lshl_b32 s3, s3, 12
    s_add_u32 s3, s3, s42
    buffer_load_dword v255, v251, s[32:35], s3 offen
    s_waitcnt vmcnt(5) lgkmcnt(6)
    s_barrier
    v_mfma_f32_16x16x32_bf16 v[24:27], v[180:183], v[208:211], v[24:27]
    ds_read_b64_tr_b16 v[164:165], v3 offset:0
    v_mfma_f32_16x16x32_bf16 v[28:31], v[184:187], v[208:211], v[28:31]
    ds_read_b64_tr_b16 v[166:167], v4 offset:0
    v_mfma_f32_16x16x32_bf16 v[32:35], v[188:191], v[208:211], v[32:35]
    ds_read_b64_tr_b16 v[136:137], v1 offset:0
    v_mfma_f32_16x16x32_bf16 v[36:39], v[192:195], v[208:211], v[36:39]
    ds_read_b64_tr_b16 v[138:139], v1 offset:432
    v_mfma_f32_16x16x32_bf16 v[40:43], v[196:199], v[208:211], v[40:43]
    ds_read_b64_tr_b16 v[140:141], v1 offset:32
    v_mfma_f32_16x16x32_bf16 v[44:47], v[200:203], v[208:211], v[44:47]
    ds_read_b64_tr_b16 v[142:143], v1 offset:464
    v_mfma_f32_16x16x32_bf16 v[48:51], v[204:207], v[208:211], v[48:51]
    ds_read_b64_tr_b16 v[144:145], v1 offset:144
    s_waitcnt lgkmcnt(7)
    v_mfma_f32_16x16x32_bf16 v[76:79], v[204:207], v[212:215], v[76:79]
    ds_read_b64_tr_b16 v[146:147], v1 offset:576
    v_mfma_f32_16x16x32_bf16 v[72:75], v[200:203], v[212:215], v[72:75]
    ds_read_b64_tr_b16 v[148:149], v1 offset:176
    v_mfma_f32_16x16x32_bf16 v[68:71], v[196:199], v[212:215], v[68:71]
    ds_read_b64_tr_b16 v[150:151], v1 offset:608
    v_mfma_f32_16x16x32_bf16 v[64:67], v[192:195], v[212:215], v[64:67]
    ds_read_b64_tr_b16 v[152:153], v2 offset:0
    v_mfma_f32_16x16x32_bf16 v[60:63], v[188:191], v[212:215], v[60:63]
    ds_read_b64_tr_b16 v[154:155], v2 offset:432
    v_mfma_f32_16x16x32_bf16 v[56:59], v[184:187], v[212:215], v[56:59]
    ds_read_b64_tr_b16 v[156:157], v1 offset:288
    v_mfma_f32_16x16x32_bf16 v[52:55], v[180:183], v[212:215], v[52:55]
    ds_read_b64_tr_b16 v[158:159], v1 offset:720
    v_mfma_f32_16x16x32_bf16 v[80:83], v[180:183], v[216:219], v[80:83]
    ds_read_b64_tr_b16 v[160:161], v1 offset:320
    v_mfma_f32_16x16x32_bf16 v[84:87], v[184:187], v[216:219], v[84:87]
    ds_read_b64_tr_b16 v[162:163], v1 offset:752
    v_mfma_f32_16x16x32_bf16 v[88:91], v[188:191], v[216:219], v[88:91]
    ds_read_b64_tr_b16 v[168:169], v3 offset:1024
    v_mfma_f32_16x16x32_bf16 v[92:95], v[192:195], v[216:219], v[92:95]
    ds_read_b64_tr_b16 v[170:171], v4 offset:1024
    v_mfma_f32_16x16x32_bf16 v[96:99], v[196:199], v[216:219], v[96:99]
    ds_read_b64_tr_b16 v[172:173], v3 offset:2048
    v_mfma_f32_16x16x32_bf16 v[100:103], v[200:203], v[216:219], v[100:103]
    ds_read_b64_tr_b16 v[174:175], v4 offset:2048
    v_mfma_f32_16x16x32_bf16 v[104:107], v[204:207], v[216:219], v[104:107]
    ds_read_b64_tr_b16 v[176:177], v3 offset:3072
    v_mfma_f32_16x16x32_bf16 v[132:135], v[204:207], v[220:223], v[132:135]
    ds_read_b64_tr_b16 v[178:179], v4 offset:3072
    v_mfma_f32_16x16x32_bf16 v[128:131], v[200:203], v[220:223], v[128:131]
    v_add_u32 v1, 30720, v224
    v_mfma_f32_16x16x32_bf16 v[124:127], v[196:199], v[220:223], v[124:127]
    v_add_u32 v2, 30720, v225
    v_mfma_f32_16x16x32_bf16 v[120:123], v[192:195], v[220:223], v[120:123]
    v_add_u32 v3, 30720, v226
    v_mfma_f32_16x16x32_bf16 v[116:119], v[188:191], v[220:223], v[116:119]
    v_add_u32 v4, 30720, v227
    v_mfma_f32_16x16x32_bf16 v[112:115], v[184:187], v[220:223], v[112:115]
    v_mfma_f32_16x16x32_bf16 v[108:111], v[180:183], v[220:223], v[108:111]
    s_add_u32 s43, s63, 128
    s_mul_i32 s3, s43, 683
    s_lshr_b32 s3, s3, 16
    s_lshl_b32 s48, s3, 2
    s_lshr_b64 s[48:49], s[100:101], s48
    s_and_b32 s48, s48, 15
    s_sub_i32 s3, s48, s3
    s_mul_i32 s3, s3, 96
    s_add_i32 s3, s3, s43
    s_lshl_b32 s3, s3, 12
    s_add_u32 s3, s3, s42
    buffer_load_dword v255, v251, s[32:35], s3 offen
    s_waitcnt vmcnt(2) lgkmcnt(6)
    s_barrier
    v_mfma_f32_16x16x32_bf16 v[24:27], v[136:139], v[164:167], v[24:27]
    ds_read_b64_tr_b16 v[208:209], v3 offset:0
    v_mfma_f32_16x16x32_bf16 v[28:31], v[140:143], v[164:167], v[28:31]
    ds_read_b64_tr_b16 v[210:211], v4 offset:0
    v_mfma_f32_16x16x32_bf16 v[32:35], v[144:147], v[164:167], v[32:35]
    ds_read_b64_tr_b16 v[180:181], v1 offset:0
    v_mfma_f32_16x16x32_bf16 v[36:39], v[148:151], v[164:167], v[36:39]
    ds_read_b64_tr_b16 v[182:183], v1 offset:432
    v_mfma_f32_16x16x32_bf16 v[40:43], v[152:155], v[164:167], v[40:43]
    ds_read_b64_tr_b16 v[184:185], v1 offset:32
    v_mfma_f32_16x16x32_bf16 v[44:47], v[156:159], v[164:167], v[44:47]
    ds_read_b64_tr_b16 v[186:187], v1 offset:464
    v_mfma_f32_16x16x32_bf16 v[48:51], v[160:163], v[164:167], v[48:51]
    ds_read_b64_tr_b16 v[188:189], v1 offset:144
    s_waitcnt lgkmcnt(7)
    v_mfma_f32_16x16x32_bf16 v[76:79], v[160:163], v[168:171], v[76:79]
    ds_read_b64_tr_b16 v[190:191], v1 offset:576
    v_mfma_f32_16x16x32_bf16 v[72:75], v[156:159], v[168:171], v[72:75]
    ds_read_b64_tr_b16 v[192:193], v1 offset:176
    v_mfma_f32_16x16x32_bf16 v[68:71], v[152:155], v[168:171], v[68:71]
    ds_read_b64_tr_b16 v[194:195], v1 offset:608
    v_mfma_f32_16x16x32_bf16 v[64:67], v[148:151], v[168:171], v[64:67]
    ds_read_b64_tr_b16 v[196:197], v2 offset:0
    v_mfma_f32_16x16x32_bf16 v[60:63], v[144:147], v[168:171], v[60:63]
    ds_read_b64_tr_b16 v[198:199], v2 offset:432
    v_mfma_f32_16x16x32_bf16 v[56:59], v[140:143], v[168:171], v[56:59]
    ds_read_b64_tr_b16 v[200:201], v1 offset:288
    v_mfma_f32_16x16x32_bf16 v[52:55], v[136:139], v[168:171], v[52:55]
    ds_read_b64_tr_b16 v[202:203], v1 offset:720
    v_mfma_f32_16x16x32_bf16 v[80:83], v[136:139], v[172:175], v[80:83]
    ds_read_b64_tr_b16 v[204:205], v1 offset:320
    v_mfma_f32_16x16x32_bf16 v[84:87], v[140:143], v[172:175], v[84:87]
    ds_read_b64_tr_b16 v[206:207], v1 offset:752
    v_mfma_f32_16x16x32_bf16 v[88:91], v[144:147], v[172:175], v[88:91]
    ds_read_b64_tr_b16 v[212:213], v3 offset:1024
    v_mfma_f32_16x16x32_bf16 v[92:95], v[148:151], v[172:175], v[92:95]
    ds_read_b64_tr_b16 v[214:215], v4 offset:1024
    v_mfma_f32_16x16x32_bf16 v[96:99], v[152:155], v[172:175], v[96:99]
    ds_read_b64_tr_b16 v[216:217], v3 offset:2048
    v_mfma_f32_16x16x32_bf16 v[100:103], v[156:159], v[172:175], v[100:103]
    ds_read_b64_tr_b16 v[218:219], v4 offset:2048
    v_mfma_f32_16x16x32_bf16 v[104:107], v[160:163], v[172:175], v[104:107]
    ds_read_b64_tr_b16 v[220:221], v3 offset:3072
    v_mfma_f32_16x16x32_bf16 v[132:135], v[160:163], v[176:179], v[132:135]
    ds_read_b64_tr_b16 v[222:223], v4 offset:3072
    v_mfma_f32_16x16x32_bf16 v[128:131], v[156:159], v[176:179], v[128:131]
    v_mfma_f32_16x16x32_bf16 v[124:127], v[152:155], v[176:179], v[124:127]
    v_mfma_f32_16x16x32_bf16 v[120:123], v[148:151], v[176:179], v[120:123]
    v_mfma_f32_16x16x32_bf16 v[116:119], v[144:147], v[176:179], v[116:119]
    v_mfma_f32_16x16x32_bf16 v[112:115], v[140:143], v[176:179], v[112:115]
    v_mfma_f32_16x16x32_bf16 v[108:111], v[136:139], v[176:179], v[108:111]
    s_add_u32 s43, s63, 256
    s_mul_i32 s3, s43, 683
    s_lshr_b32 s3, s3, 16
    s_lshl_b32 s48, s3, 2
    s_lshr_b64 s[48:49], s[100:101], s48
    s_and_b32 s48, s48, 15
    s_sub_i32 s3, s48, s3
    s_mul_i32 s3, s3, 96
    s_add_i32 s3, s3, s43
    s_lshl_b32 s3, s3, 12
    s_add_u32 s3, s3, s42
    buffer_load_dword v255, v251, s[32:35], s3 offen
    s_branch L_att_z
L_att_y:
    s_waitcnt vmcnt(8) lgkmcnt(6)
    s_barrier
    s_add_u32 m0, s99, 92160
    s_nop 0
    buffer_load_dwordx4 v228, s[12:15], s28 offen offset:0 lds
    buffer_load_dwordx4 v229, s[12:15], s28 offen offset:1024 lds
    buffer_load_dwordx4 v230, s[12:15], s28 offen offset:2048 lds
    s_mov_b64 exec, 0xffffff
    buffer_load_dwordx4 v231, s[12:15], s28 offen offset:3072 lds
    s_mov_b64 exec, -1
    s_add_u32 s28, s28, 110592
    v_and_b32 v14, 1, v5
    v_mul_u32_u24 v12, 80, v14
    v_mul_u32_u24 v13, 7552, v8
    s_mul_i32 s41, s98, 160
    v_add3_u32 v234, v11, v12, v13
    v_add_u32 v234, s41, v234
    v_and_b32 v11, 14, v9
    v_add_u32 v11, v11, v8
    v_mul_u32_u24 v11, 944, v11
    s_lshr_b32 s39, s4, 1
    v_mfma_f32_16x16x32_bf16 v[24:27], v[136:139], v[164:167], 0
    ds_read_b64_tr_b16 v[208:209], v3 offset:0
    v_mfma_f32_16x16x32_bf16 v[28:31], v[140:143], v[164:167], 0
    ds_read_b64_tr_b16 v[210:211], v4 offset:0
    v_mfma_f32_16x16x32_bf16 v[32:35], v[144:147], v[164:167], 0
    ds_read_b64_tr_b16 v[180:181], v1 offset:0
    v_mfma_f32_16x16x32_bf16 v[36:39], v[148:151], v[164:167], 0
    ds_read_b64_tr_b16 v[182:183], v1 offset:432
    v_mfma_f32_16x16x32_bf16 v[40:43], v[152:155], v[164:167], 0
    ds_read_b64_tr_b16 v[184:185], v1 offset:32
    v_mfma_f32_16x16x32_bf16 v[44:47], v[156:159], v[164:167], 0
    ds_read_b64_tr_b16 v[186:187], v1 offset:464
    v_mfma_f32_16x16x32_bf16 v[48:51], v[160:163], v[164:167], 0
    ds_read_b64_tr_b16 v[188:189], v1 offset:144
    s_waitcnt lgkmcnt(7)
    v_mfma_f32_16x16x32_bf16 v[76:79], v[160:163], v[168:171], 0
    ds_read_b64_tr_b16 v[190:191], v1 offset:576
    v_mfma_f32_16x16x32_bf16 v[72:75], v[156:159], v[168:171], 0
    ds_read_b64_tr_b16 v[192:193], v1 offset:176
    v_mfma_f32_16x16x32_bf16 v[68:71], v[152:155], v[168:171], 0
    ds_read_b64_tr_b16 v[194:195], v1 offset:608
    v_mfma_f32_16x16x32_bf16 v[64:67], v[148:151], v[168:171], 0
    ds_read_b64_tr_b16 v[196:197], v2 offset:0
    v_mfma_f32_16x16x32_bf16 v[60:63], v[144:147], v[168:171], 0
    ds_read_b64_tr_b16 v[198:199], v2 offset:432
    v_mfma_f32_16x16x32_bf16 v[56:59], v[140:143], v[168:171], 0
    ds_read_b64_tr_b16 v[200:201], v1 offset:288
    v_mfma_f32_16x16x32_bf16 v[52:55], v[136:139], v[168:171], 0
    ds_read_b64_tr_b16 v[202:203], v1 offset:720
    v_mfma_f32_16x16x32_bf16 v[80:83], v[136:139], v[172:175], 0
    ds_read_b64_tr_b16 v[204:205], v1 offset:320
    v_mfma_f32_16x16x32_bf16 v[84:87], v[140:143], v[172:175], 0
    ds_read_b64_tr_b16 v[206:207], v1 offset:752
    v_mfma_f32_16x16x32_bf16 v[88:91], v[144:147], v[172:175], 0
    ds_read_b64_tr_b16 v[212:213], v3 offset:1024
    v_mfma_f32_16x16x32_bf16 v[92:95], v[148:151], v[172:175], 0
    ds_read_b64_tr_b16 v[214:215], v4 offset:1024
    v_mfma_f32_16x16x32_bf16 v[96:99], v[152:155], v[172:175], 0
    ds_read_b64_tr_b16 v[216:217], v3 offset:2048
    v_mfma_f32_16x16x32_bf16 v[100:103], v[156:159], v[172:175], 0
    ds_read_b64_tr_b16 v[218:219], v4 offset:2048
    v_mfma_f32_16x16x32_bf16 v[104:107], v[160:163], v[172:175], 0
    ds_read_b64_tr_b16 v[220:221], v3 offset:3072
    v_mfma_f32_16x16x32_bf16 v[132:135], v[160:163], v[176:179], 0
    ds_read_b64_tr_b16 v[222:223], v4 offset:3072
    v_mfma_f32_16x16x32_bf16 v[128:131], v[156:159], v[176:179], 0
    v_add_u32 v1, 61440, v224
    v_mfma_f32_16x16x32_bf16 v[124:127], v[152:155], v[176:179], 0
    v_add_u32 v2, 61440, v225
    v_mfma_f32_16x16x32_bf16 v[120:123], v[148:151], v[176:179], 0
    v_add_u32 v3, 61440, v226
    v_mfma_f32_16x16x32_bf16 v[116:119], v[144:147], v[176:179], 0
    v_add_u32 v4, 61440, v227
    v_mfma_f32_16x16x32_bf16 v[112:115], v[140:143], v[176:179], 0
    v_mfma_f32_16x16x32_bf16 v[108:111], v[136:139], v[176:179], 0
    s_waitcnt vmcnt(4) lgkmcnt(6)
    s_barrier
    s_add_u32 m0, s99, 0
    s_nop 0
    buffer_load_dwordx4 v228, s[12:15], s28 offen offset:0 lds
    buffer_load_dwordx4 v229, s[12:15], s28 offen offset:1024 lds
    buffer_load_dwordx4 v230, s[12:15], s28 offen offset:2048 lds
    s_mov_b64 exec, 0xffffff
    buffer_load_dwordx4 v231, s[12:15], s28 offen offset:3072 lds
    s_mov_b64 exec, -1
    s_add_u32 s28, s28, 110592
    s_mul_i32 s41, s39, 80
    v_lshl_add_u32 v235, v10, 3, s41
    v_add_u32 v235, v235, v11
    s_add_u32 s38, s38, 320
    s_and_b32 s41, s39, 1
    s_mul_i32 s41, s41, 40
    s_add_u32 s41, s41, s38
    v_lshl_add_u32 v12, v10, 3, s41
    s_add_u32 s38, s38, 32
    v_cmp_eq_u32 vcc, 0, v10
    v_mfma_f32_16x16x32_bf16 v[24:27], v[180:183], v[208:211], v[24:27]
    ds_read_b64_tr_b16 v[164:165], v3 offset:0
    v_mfma_f32_16x16x32_bf16 v[28:31], v[184:187], v[208:211], v[28:31]
    ds_read_b64_tr_b16 v[166:167], v4 offset:0
    v_mfma_f32_16x16x32_bf16 v[32:35], v[188:191], v[208:211], v[32:35]
    ds_read_b64_tr_b16 v[136:137], v1 offset:0
    v_mfma_f32_16x16x32_bf16 v[36:39], v[192:195], v[208:211], v[36:39]
    ds_read_b64_tr_b16 v[138:139], v1 offset:432
    v_mfma_f32_16x16x32_bf16 v[40:43], v[196:199], v[208:211], v[40:43]
    ds_read_b64_tr_b16 v[140:141], v1 offset:32
    v_mfma_f32_16x16x32_bf16 v[44:47], v[200:203], v[208:211], v[44:47]
    ds_read_b64_tr_b16 v[142:143], v1 offset:464
    v_mfma_f32_16x16x32_bf16 v[48:51], v[204:207], v[208:211], v[48:51]
    ds_read_b64_tr_b16 v[144:145], v1 offset:144
    s_waitcnt lgkmcnt(7)
    v_mfma_f32_16x16x32_bf16 v[76:79], v[204:207], v[212:215], v[76:79]
    ds_read_b64_tr_b16 v[146:147], v1 offset:576
    v_mfma_f32_16x16x32_bf16 v[72:75], v[200:203], v[212:215], v[72:75]
    ds_read_b64_tr_b16 v[148:149], v1 offset:176
    v_mfma_f32_16x16x32_bf16 v[68:71], v[196:199], v[212:215], v[68:71]
    ds_read_b64_tr_b16 v[150:151], v1 offset:608
    v_mfma_f32_16x16x32_bf16 v[64:67], v[192:195], v[212:215], v[64:67]
    ds_read_b64_tr_b16 v[152:153], v2 offset:0
    v_mfma_f32_16x16x32_bf16 v[60:63], v[188:191], v[212:215], v[60:63]
    ds_read_b64_tr_b16 v[154:155], v2 offset:432
    v_mfma_f32_16x16x32_bf16 v[56:59], v[184:187], v[212:215], v[56:59]
    ds_read_b64_tr_b16 v[156:157], v1 offset:288
    v_mfma_f32_16x16x32_bf16 v[52:55], v[180:183], v[212:215], v[52:55]
    ds_read_b64_tr_b16 v[158:159], v1 offset:720
    v_mfma_f32_16x16x32_bf16 v[80:83], v[180:183], v[216:219], v[80:83]
    ds_read_b64_tr_b16 v[160:161], v1 offset:320
    v_mfma_f32_16x16x32_bf16 v[84:87], v[184:187], v[216:219], v[84:87]
    ds_read_b64_tr_b16 v[162:163], v1 offset:752
    v_mfma_f32_16x16x32_bf16 v[88:91], v[188:191], v[216:219], v[88:91]
    ds_read_b64_tr_b16 v[168:169], v3 offset:1024
    v_mfma_f32_16x16x32_bf16 v[92:95], v[192:195], v[216:219], v[92:95]
    ds_read_b64_tr_b16 v[170:171], v4 offset:1024
    v_mfma_f32_16x16x32_bf16 v[96:99], v[196:199], v[216:219], v[96:99]
    ds_read_b64_tr_b16 v[172:173], v3 offset:2048
    v_mfma_f32_16x16x32_bf16 v[100:103], v[200:203], v[216:219], v[100:103]
    ds_read_b64_tr_b16 v[174:175], v4 offset:2048
    v_mfma_f32_16x16x32_bf16 v[104:107], v[204:207], v[216:219], v[104:107]
    ds_read_b64_tr_b16 v[176:177], v3 offset:3072
    v_mfma_f32_16x16x32_bf16 v[132:135], v[204:207], v[220:223], v[132:135]
    ds_read_b64_tr_b16 v[178:179], v4 offset:3072
    v_mfma_f32_16x16x32_bf16 v[128:131], v[200:203], v[220:223], v[128:131]
    v_add_u32 v1, 92160, v224
    v_mfma_f32_16x16x32_bf16 v[124:127], v[196:199], v[220:223], v[124:127]
    v_add_u32 v2, 92160, v225
    v_mfma_f32_16x16x32_bf16 v[120:123], v[192:195], v[220:223], v[120:123]
    v_add_u32 v3, 92160, v226
    v_mfma_f32_16x16x32_bf16 v[116:119], v[188:191], v[220:223], v[116:119]
    v_add_u32 v4, 92160, v227
    v_mfma_f32_16x16x32_bf16 v[112:115], v[184:187], v[220:223], v[112:115]
    v_mfma_f32_16x16x32_bf16 v[108:111], v[180:183], v[220:223], v[108:111]
    s_waitcnt vmcnt(4) lgkmcnt(6)
    s_barrier
    s_add_u32 m0, s99, 30720
    s_nop 0
    buffer_load_dwordx4 v228, s[12:15], s28 offen offset:0 lds
    buffer_load_dwordx4 v229, s[12:15], s28 offen offset:1024 lds
    buffer_load_dwordx4 v230, s[12:15], s28 offen offset:2048 lds
    s_mov_b64 exec, 0xffffff
    buffer_load_dwordx4 v231, s[12:15], s28 offen offset:3072 lds
    s_mov_b64 exec, -1
    s_add_u32 s28, s28, 110592
    v_mov_b32 v13, 464
    v_mov_b32 v236, s38
    v_cndmask_b32 v13, v13, v236, vcc
    s_bitcmp0_b32 s4, 0
    s_cselect_b64 vcc, -1, 0
    s_cselect_b32 s38, 16, 8
    v_cndmask_b32 v12, v13, v12, vcc
    v_add_u32 v236, v12, v11
    v_cmp_gt_u32 vcc, s38, v6
    v_mul_u32_u24 v11, s38, v5
    v_add_lshl_u32 v11, v11, v6, 4
    s_lshl_b32 s40, s38, 6
    v_mfma_f32_16x16x32_bf16 v[24:27], v[136:139], v[164:167], v[24:27]
    ds_read_b64_tr_b16 v[208:209], v3 offset:0
    v_mfma_f32_16x16x32_bf16 v[28:31], v[140:143], v[164:167], v[28:31]
    ds_read_b64_tr_b16 v[210:211], v4 offset:0
    v_mfma_f32_16x16x32_bf16 v[32:35], v[144:147], v[164:167], v[32:35]
    ds_read_b64_tr_b16 v[180:181], v1 offset:0
    v_mfma_f32_16x16x32_bf16 v[36:39], v[148:151], v[164:167], v[36:39]
    ds_read_b64_tr_b16 v[182:183], v1 offset:432
    v_mfma_f32_16x16x32_bf16 v[40:43], v[152:155], v[164:167], v[40:43]
    ds_read_b64_tr_b16 v[184:185], v1 offset:32
    v_mfma_f32_16x16x32_bf16 v[44:47], v[156:159], v[164:167], v[44:47]
    ds_read_b64_tr_b16 v[186:187], v1 offset:464
    v_mfma_f32_16x16x32_bf16 v[48:51], v[160:163], v[164:167], v[48:51]
    ds_read_b64_tr_b16 v[188:189], v1 offset:144
    s_waitcnt lgkmcnt(7)
    v_mfma_f32_16x16x32_bf16 v[76:79], v[160:163], v[168:171], v[76:79]
    ds_read_b64_tr_b16 v[190:191], v1 offset:576
    v_mfma_f32_16x16x32_bf16 v[72:75], v[156:159], v[168:171], v[72:75]
    ds_read_b64_tr_b16 v[192:193], v1 offset:176
    v_mfma_f32_16x16x32_bf16 v[68:71], v[152:155], v[168:171], v[68:71]
    ds_read_b64_tr_b16 v[194:195], v1 offset:608
    v_mfma_f32_16x16x32_bf16 v[64:67], v[148:151], v[168:171], v[64:67]
    ds_read_b64_tr_b16 v[196:197], v2 offset:0
    v_mfma_f32_16x16x32_bf16 v[60:63], v[144:147], v[168:171], v[60:63]
    ds_read_b64_tr_b16 v[198:199], v2 offset:432
    v_mfma_f32_16x16x32_bf16 v[56:59], v[140:143], v[168:171], v[56:59]
    ds_read_b64_tr_b16 v[200:201], v1 offset:288
    v_mfma_f32_16x16x32_bf16 v[52:55], v[136:139], v[168:171], v[52:55]
    ds_read_b64_tr_b16 v[202:203], v1 offset:720
    v_mfma_f32_16x16x32_bf16 v[80:83], v[136:139], v[172:175], v[80:83]
    ds_read_b64_tr_b16 v[204:205], v1 offset:320
    v_mfma_f32_16x16x32_bf16 v[84:87], v[140:143], v[172:175], v[84:87]
    ds_read_b64_tr_b16 v[206:207], v1 offset:752
    v_mfma_f32_16x16x32_bf16 v[88:91], v[144:147], v[172:175], v[88:91]
    ds_read_b64_tr_b16 v[212:213], v3 offset:1024
    v_mfma_f32_16x16x32_bf16 v[92:95], v[148:151], v[172:175], v[92:95]
    ds_read_b64_tr_b16 v[214:215], v4 offset:1024
    v_mfma_f32_16x16x32_bf16 v[96:99], v[152:155], v[172:175], v[96:99]
    ds_read_b64_tr_b16 v[216:217], v3 offset:2048
    v_mfma_f32_16x16x32_bf16 v[100:103], v[156:159], v[172:175], v[100:103]
    ds_read_b64_tr_b16 v[218:219], v4 offset:2048
    v_mfma_f32_16x16x32_bf16 v[104:107], v[160:163], v[172:175], v[104:107]
    ds_read_b64_tr_b16 v[220:221], v3 offset:3072
    v_mfma_f32_16x16x32_bf16 v[132:135], v[160:163], v[176:179], v[132:135]
    ds_read_b64_tr_b16 v[222:223], v4 offset:3072
    v_mfma_f32_16x16x32_bf16 v[128:131], v[156:159], v[176:179], v[128:131]
    v_add_u32 v1, 0, v224
    v_mfma_f32_16x16x32_bf16 v[124:127], v[152:155], v[176:179], v[124:127]
    v_add_u32 v2, 0, v225
    v_mfma_f32_16x16x32_bf16 v[120:123], v[148:151], v[176:179], v[120:123]
    v_add_u32 v3, 0, v226
    v_mfma_f32_16x16x32_bf16 v[116:119], v[144:147], v[176:179], v[116:119]
    v_add_u32 v4, 0, v227
    v_mfma_f32_16x16x32_bf16 v[112:115], v[140:143], v[176:179], v[112:115]
    v_mfma_f32_16x16x32_bf16 v[108:111], v[136:139], v[176:179], v[108:111]
    s_waitcnt vmcnt(4) lgkmcnt(6)
    s_barrier
    s_add_u32 m0, s99, 61440
    s_nop 0
    buffer_load_dwordx4 v228, s[12:15], s28 offen offset:0 lds
    buffer_load_dwordx4 v229, s[12:15], s28 offen offset:1024 lds
    buffer_load_dwordx4 v230, s[12:15], s28 offen offset:2048 lds
    s_mov_b64 exec, 0xffffff
    buffer_load_dwordx4 v231, s[12:15], s28 offen offset:3072 lds
    s_mov_b64 exec, -1
    s_add_u32 s28, s28, 110592
    ds_read_u16 v17, v253 offset:0
    ds_read_u16 v19, v253 offset:36
    v_cndmask_b32 v237, v7, v11, vcc
    v_cmp_gt_u32 vcc, 2, v5
    s_lshl_b32 s30, s5, 3
    s_add_u32 s30, s30, s96
    v_cndmask_b32 v238, v7, v237, vcc
    s_mul_i32 s30, s30, 15360
    s_mul_i32 s41, s39, 3840
    s_add_u32 s30, s30, s41
    s_add_u32 s30, s30, 13631488
    s_lshl_b32 s36, s5, 12
    v_mfma_f32_16x16x32_bf16 v[24:27], v[180:183], v[208:211], v[24:27]
    ds_read_b64_tr_b16 v[164:165], v3 offset:0
    v_mfma_f32_16x16x32_bf16 v[28:31], v[184:187], v[208:211], v[28:31]
    ds_read_b64_tr_b16 v[166:167], v4 offset:0
    v_mfma_f32_16x16x32_bf16 v[32:35], v[188:191], v[208:211], v[32:35]
    ds_read_b64_tr_b16 v[136:137], v1 offset:0
    v_mfma_f32_16x16x32_bf16 v[36:39], v[192:195], v[208:211], v[36:39]
    ds_read_b64_tr_b16 v[138:139], v1 offset:432
    v_mfma_f32_16x16x32_bf16 v[40:43], v[196:199], v[208:211], v[40:43]
    ds_read_b64_tr_b16 v[140:141], v1 offset:32
    v_mfma_f32_16x16x32_bf16 v[44:47], v[200:203], v[208:211], v[44:47]
    ds_read_b64_tr_b16 v[142:143], v1 offset:464
    v_mfma_f32_16x16x32_bf16 v[48:51], v[204:207], v[208:211], v[48:51]
    ds_read_b64_tr_b16 v[144:145], v1 offset:144
    s_waitcnt lgkmcnt(7)
    v_mfma_f32_16x16x32_bf16 v[76:79], v[204:207], v[212:215], v[76:79]
    ds_read_b64_tr_b16 v[146:147], v1 offset:576
    v_mfma_f32_16x16x32_bf16 v[72:75], v[200:203], v[212:215], v[72:75]
    ds_read_b64_tr_b16 v[148:149], v1 offset:176
    v_mfma_f32_16x16x32_bf16 v[68:71], v[196:199], v[212:215], v[68:71]
    ds_read_b64_tr_b16 v[150:151], v1 offset:608
    v_mfma_f32_16x16x32_bf16 v[64:67], v[192:195], v[212:215], v[64:67]
    ds_read_b64_tr_b16 v[152:153], v2 offset:0
    v_mfma_f32_16x16x32_bf16 v[60:63], v[188:191], v[212:215], v[60:63]
    ds_read_b64_tr_b16 v[154:155], v2 offset:432
    v_mfma_f32_16x16x32_bf16 v[56:59], v[184:187], v[212:215], v[56:59]
    ds_read_b64_tr_b16 v[156:157], v1 offset:288
    v_mfma_f32_16x16x32_bf16 v[52:55], v[180:183], v[212:215], v[52:55]
    ds_read_b64_tr_b16 v[158:159], v1 offset:720
    v_mfma_f32_16x16x32_bf16 v[80:83], v[180:183], v[216:219], v[80:83]
    ds_read_b64_tr_b16 v[160:161], v1 offset:320
    v_mfma_f32_16x16x32_bf16 v[84:87], v[184:187], v[216:219], v[84:87]
    ds_read_b64_tr_b16 v[162:163], v1 offset:752
    v_mfma_f32_16x16x32_bf16 v[88:91], v[188:191], v[216:219], v[88:91]
    ds_read_b64_tr_b16 v[168:169], v3 offset:1024
    v_mfma_f32_16x16x32_bf16 v[92:95], v[192:195], v[216:219], v[92:95]
    ds_read_b64_tr_b16 v[170:171], v4 offset:1024
    v_mfma_f32_16x16x32_bf16 v[96:99], v[196:199], v[216:219], v[96:99]
    ds_read_b64_tr_b16 v[172:173], v3 offset:2048
    v_mfma_f32_16x16x32_bf16 v[100:103], v[200:203], v[216:219], v[100:103]
    ds_read_b64_tr_b16 v[174:175], v4 offset:2048
    v_mfma_f32_16x16x32_bf16 v[104:107], v[204:207], v[216:219], v[104:107]
    ds_read_b64_tr_b16 v[176:177], v3 offset:3072
    v_mfma_f32_16x16x32_bf16 v[132:135], v[204:207], v[220:223], v[132:135]
    ds_read_b64_tr_b16 v[178:179], v4 offset:3072
    v_mfma_f32_16x16x32_bf16 v[128:131], v[200:203], v[220:223], v[128:131]
    v_add_u32 v1, 30720, v224
    v_mfma_f32_16x16x32_bf16 v[124:127], v[196:199], v[220:223], v[124:127]
    v_add_u32 v2, 30720, v225
    v_mfma_f32_16x16x32_bf16 v[120:123], v[192:195], v[220:223], v[120:123]
    v_add_u32 v3, 30720, v226
    v_mfma_f32_16x16x32_bf16 v[116:119], v[188:191], v[220:223], v[116:119]
    v_add_u32 v4, 30720, v227
    v_mfma_f32_16x16x32_bf16 v[112:115], v[184:187], v[220:223], v[112:115]
    v_mfma_f32_16x16x32_bf16 v[108:111], v[180:183], v[220:223], v[108:111]
    s_waitcnt vmcnt(4) lgkmcnt(6)
    s_barrier
    s_add_u32 m0, s99, 92160
    s_nop 0
    buffer_load_dwordx4 v228, s[12:15], s28 offen offset:0 lds
    buffer_load_dwordx4 v229, s[12:15], s28 offen offset:1024 lds
    buffer_load_dwordx4 v230, s[12:15], s28 offen offset:2048 lds
    s_mov_b64 exec, 0xffffff
    buffer_load_dwordx4 v231, s[12:15], s28 offen offset:3072 lds
    s_mov_b64 exec, -1
    s_add_u32 s28, s28, 110592
    v_lshl_or_b32 v21, v19, 16, v17
    ds_write_b32 v15, v21 offset:0
    ds_read_u16 v17, v253 offset:8
    ds_read_u16 v19, v253 offset:44
    s_add_u32 s36, s36, 49152
    s_lshl_b32 s41, s39, 7
    s_add_u32 s36, s36, s41
    s_lshl_b32 s31, s96, 1
    s_and_b32 s41, s4, 1
    s_add_u32 s31, s31, s41
    s_lshl_b32 s31, s31, 2
    s_add_u32 s31, s31, s36
    s_lshl_b32 s41, s96, 9
    s_add_u32 s36, s36, s41
    v_mfma_f32_16x16x32_bf16 v[24:27], v[136:139], v[164:167], v[24:27]
    ds_read_b64_tr_b16 v[208:209], v3 offset:0
    v_mfma_f32_16x16x32_bf16 v[28:31], v[140:143], v[164:167], v[28:31]
    ds_read_b64_tr_b16 v[210:211], v4 offset:0
    v_mfma_f32_16x16x32_bf16 v[32:35], v[144:147], v[164:167], v[32:35]
    ds_read_b64_tr_b16 v[180:181], v1 offset:0
    v_mfma_f32_16x16x32_bf16 v[36:39], v[148:151], v[164:167], v[36:39]
    ds_read_b64_tr_b16 v[182:183], v1 offset:432
    v_mfma_f32_16x16x32_bf16 v[40:43], v[152:155], v[164:167], v[40:43]
    ds_read_b64_tr_b16 v[184:185], v1 offset:32
    v_mfma_f32_16x16x32_bf16 v[44:47], v[156:159], v[164:167], v[44:47]
    ds_read_b64_tr_b16 v[186:187], v1 offset:464
    v_mfma_f32_16x16x32_bf16 v[48:51], v[160:163], v[164:167], v[48:51]
    ds_read_b64_tr_b16 v[188:189], v1 offset:144
    s_waitcnt lgkmcnt(7)
    v_mfma_f32_16x16x32_bf16 v[76:79], v[160:163], v[168:171], v[76:79]
    ds_read_b64_tr_b16 v[190:191], v1 offset:576
    v_mfma_f32_16x16x32_bf16 v[72:75], v[156:159], v[168:171], v[72:75]
    ds_read_b64_tr_b16 v[192:193], v1 offset:176
    v_mfma_f32_16x16x32_bf16 v[68:71], v[152:155], v[168:171], v[68:71]
    ds_read_b64_tr_b16 v[194:195], v1 offset:608
    v_mfma_f32_16x16x32_bf16 v[64:67], v[148:151], v[168:171], v[64:67]
    ds_read_b64_tr_b16 v[196:197], v2 offset:0
    v_mfma_f32_16x16x32_bf16 v[60:63], v[144:147], v[168:171], v[60:63]
    ds_read_b64_tr_b16 v[198:199], v2 offset:432
    v_mfma_f32_16x16x32_bf16 v[56:59], v[140:143], v[168:171], v[56:59]
    ds_read_b64_tr_b16 v[200:201], v1 offset:288
    v_mfma_f32_16x16x32_bf16 v[52:55], v[136:139], v[168:171], v[52:55]
    ds_read_b64_tr_b16 v[202:203], v1 offset:720
    v_mfma_f32_16x16x32_bf16 v[80:83], v[136:139], v[172:175], v[80:83]
    ds_read_b64_tr_b16 v[204:205], v1 offset:320
    v_mfma_f32_16x16x32_bf16 v[84:87], v[140:143], v[172:175], v[84:87]
    ds_read_b64_tr_b16 v[206:207], v1 offset:752
    v_mfma_f32_16x16x32_bf16 v[88:91], v[144:147], v[172:175], v[88:91]
    ds_read_b64_tr_b16 v[212:213], v3 offset:1024
    v_mfma_f32_16x16x32_bf16 v[92:95], v[148:151], v[172:175], v[92:95]
    ds_read_b64_tr_b16 v[214:215], v4 offset:1024
    v_mfma_f32_16x16x32_bf16 v[96:99], v[152:155], v[172:175], v[96:99]
    ds_read_b64_tr_b16 v[216:217], v3 offset:2048
    v_mfma_f32_16x16x32_bf16 v[100:103], v[156:159], v[172:175], v[100:103]
    ds_read_b64_tr_b16 v[218:219], v4 offset:2048
    v_mfma_f32_16x16x32_bf16 v[104:107], v[160:163], v[172:175], v[104:107]
    ds_read_b64_tr_b16 v[220:221], v3 offset:3072
    v_mfma_f32_16x16x32_bf16 v[132:135], v[160:163], v[176:179], v[132:135]
    ds_read_b64_tr_b16 v[222:223], v4 offset:3072
    v_mfma_f32_16x16x32_bf16 v[128:131], v[156:159], v[176:179], v[128:131]
    v_add_u32 v1, 61440, v224
    v_mfma_f32_16x16x32_bf16 v[124:127], v[152:155], v[176:179], v[124:127]
    v_add_u32 v2, 61440, v225
    v_mfma_f32_16x16x32_bf16 v[120:123], v[148:151], v[176:179], v[120:123]
    v_add_u32 v3, 61440, v226
    v_mfma_f32_16x16x32_bf16 v[116:119], v[144:147], v[176:179], v[116:119]
    v_add_u32 v4, 61440, v227
    v_mfma_f32_16x16x32_bf16 v[112:115], v[140:143], v[176:179], v[112:115]
    v_mfma_f32_16x16x32_bf16 v[108:111], v[136:139], v[176:179], v[108:111]
    s_waitcnt vmcnt(4) lgkmcnt(6)
    s_barrier
    s_add_u32 m0, s99, 0
    s_nop 0
    buffer_load_dwordx4 v228, s[12:15], s28 offen offset:0 lds
    buffer_load_dwordx4 v229, s[12:15], s28 offen offset:1024 lds
    buffer_load_dwordx4 v230, s[12:15], s28 offen offset:2048 lds
    s_mov_b64 exec, 0xffffff
    buffer_load_dwordx4 v231, s[12:15], s28 offen offset:3072 lds
    s_mov_b64 exec, -1
    s_add_u32 s28, s28, 110592
    v_lshl_or_b32 v21, v19, 16, v17
    ds_write_b32 v15, v21 offset:1024
    ds_read_u16 v17, v253 offset:16
    ds_read_u16 v19, v253 offset:52
    s_and_b32 s41, s4, 1
    s_mul_i32 s41, s41, 120
    v_add_u32 v11, s41, v0
    s_mul_i32 s38, s39, 1920
    s_add_u32 s38, s38, 153600
    v_cmp_gt_u32 vcc, 160, v11
    v_lshrrev_b32 v12, 4, v11
    v_and_b32 v13, 15, v11
    v_lshrrev_b32 v9, 3, v11
    v_subrev_u32 v9, 20, v9
    v_mfma_f32_16x16x32_bf16 v[24:27], v[180:183], v[208:211], v[24:27]
    ds_read_b64_tr_b16 v[164:165], v3 offset:0
    v_mfma_f32_16x16x32_bf16 v[28:31], v[184:187], v[208:211], v[28:31]
    ds_read_b64_tr_b16 v[166:167], v4 offset:0
    v_mfma_f32_16x16x32_bf16 v[32:35], v[188:191], v[208:211], v[32:35]
    ds_read_b64_tr_b16 v[136:137], v1 offset:0
    v_mfma_f32_16x16x32_bf16 v[36:39], v[192:195], v[208:211], v[36:39]
    ds_read_b64_tr_b16 v[138:139], v1 offset:432
    v_mfma_f32_16x16x32_bf16 v[40:43], v[196:199], v[208:211], v[40:43]
    ds_read_b64_tr_b16 v[140:141], v1 offset:32
    v_mfma_f32_16x16x32_bf16 v[44:47], v[200:203], v[208:211], v[44:47]
    ds_read_b64_tr_b16 v[142:143], v1 offset:464
    v_mfma_f32_16x16x32_bf16 v[48:51], v[204:207], v[208:211], v[48:51]
    ds_read_b64_tr_b16 v[144:145], v1 offset:144
    s_waitcnt lgkmcnt(7)
    v_mfma_f32_16x16x32_bf16 v[76:79], v[204:207], v[212:215], v[76:79]
    ds_read_b64_tr_b16 v[146:147], v1 offset:576
    v_mfma_f32_16x16x32_bf16 v[72:75], v[200:203], v[212:215], v[72:75]
    ds_read_b64_tr_b16 v[148:149], v1 offset:176
    v_mfma_f32_16x16x32_bf16 v[68:71], v[196:199], v[212:215], v[68:71]
    ds_read_b64_tr_b16 v[150:151], v1 offset:608
    v_mfma_f32_16x16x32_bf16 v[64:67], v[192:195], v[212:215], v[64:67]
    ds_read_b64_tr_b16 v[152:153], v2 offset:0
    v_mfma_f32_16x16x32_bf16 v[60:63], v[188:191], v[212:215], v[60:63]
    ds_read_b64_tr_b16 v[154:155], v2 offset:432
    v_mfma_f32_16x16x32_bf16 v[56:59], v[184:187], v[212:215], v[56:59]
    ds_read_b64_tr_b16 v[156:157], v1 offset:288
    v_mfma_f32_16x16x32_bf16 v[52:55], v[180:183], v[212:215], v[52:55]
    ds_read_b64_tr_b16 v[158:159], v1 offset:720
    v_mfma_f32_16x16x32_bf16 v[80:83], v[180:183], v[216:219], v[80:83]
    ds_read_b64_tr_b16 v[160:161], v1 offset:320
    v_mfma_f32_16x16x32_bf16 v[84:87], v[184:187], v[216:219], v[84:87]
    ds_read_b64_tr_b16 v[162:163], v1 offset:752
    v_mfma_f32_16x16x32_bf16 v[88:91], v[188:191], v[216:219], v[88:91]
    ds_read_b64_tr_b16 v[168:169], v3 offset:1024
    v_mfma_f32_16x16x32_bf16 v[92:95], v[192:195], v[216:219], v[92:95]
    ds_read_b64_tr_b16 v[170:171], v4 offset:1024
    v_mfma_f32_16x16x32_bf16 v[96:99], v[196:199], v[216:219], v[96:99]
    ds_read_b64_tr_b16 v[172:173], v3 offset:2048
    v_mfma_f32_16x16x32_bf16 v[100:103], v[200:203], v[216:219], v[100:103]
    ds_read_b64_tr_b16 v[174:175], v4 offset:2048
    v_mfma_f32_16x16x32_bf16 v[104:107], v[204:207], v[216:219], v[104:107]
    ds_read_b64_tr_b16 v[176:177], v3 offset:3072
    v_mfma_f32_16x16x32_bf16 v[132:135], v[204:207], v[220:223], v[132:135]
    ds_read_b64_tr_b16 v[178:179], v4 offset:3072
    v_mfma_f32_16x16x32_bf16 v[128:131], v[200:203], v[220:223], v[128:131]
    v_add_u32 v1, 92160, v224
    v_mfma_f32_16x16x32_bf16 v[124:127], v[196:199], v[220:223], v[124:127]
    v_add_u32 v2, 92160, v225
    v_mfma_f32_16x16x32_bf16 v[120:123], v[192:195], v[220:223], v[120:123]
    v_add_u32 v3, 92160, v226
    v_mfma_f32_16x16x32_bf16 v[116:119], v[188:191], v[220:223], v[116:119]
    v_add_u32 v4, 92160, v227
    v_mfma_f32_16x16x32_bf16 v[112:115], v[184:187], v[220:223], v[112:115]
    v_mfma_f32_16x16x32_bf16 v[108:111], v[180:183], v[220:223], v[108:111]
    s_waitcnt vmcnt(4) lgkmcnt(6)
    s_barrier
    s_add_u32 m0, s99, 30720
    s_nop 0
    buffer_load_dwordx4 v228, s[12:15], s28 offen offset:0 lds
    buffer_load_dwordx4 v229, s[12:15], s28 offen offset:1024 lds
    buffer_load_dwordx4 v230, s[12:15], s28 offen offset:2048 lds
    s_mov_b64 exec, 0xffffff
    buffer_load_dwordx4 v231, s[12:15], s28 offen offset:3072 lds
    s_mov_b64 exec, -1
    s_add_u32 s28, s28, 110592
    v_lshl_or_b32 v21, v19, 16, v17
    ds_write_b32 v15, v21 offset:2048
    ds_read_u16 v17, v253 offset:24
    ds_read_u16 v19, v253 offset:60
    v_and_or_b32 v10, v11, 7, 16
    v_cndmask_b32 v12, v9, v12, vcc
    v_cndmask_b32 v13, v10, v13, vcc
    v_mul_u32_u24 v13, 80, v13
    v_lshlrev_b32 v12, 3, v12
    v_add3_u32 v241, v13, v12, s38
    v_lshlrev_b32 v239, 4, v11
    v_add_u32 v11, 64, v11
    v_cmp_gt_u32 vcc, 160, v11
    v_lshrrev_b32 v12, 4, v11
    v_mfma_f32_16x16x32_bf16 v[24:27], v[136:139], v[164:167], v[24:27]
    ds_read_b64_tr_b16 v[208:209], v3 offset:0
    v_mfma_f32_16x16x32_bf16 v[28:31], v[140:143], v[164:167], v[28:31]
    ds_read_b64_tr_b16 v[210:211], v4 offset:0
    v_mfma_f32_16x16x32_bf16 v[32:35], v[144:147], v[164:167], v[32:35]
    ds_read_b64_tr_b16 v[180:181], v1 offset:0
    v_mfma_f32_16x16x32_bf16 v[36:39], v[148:151], v[164:167], v[36:39]
    ds_read_b64_tr_b16 v[182:183], v1 offset:432
    v_mfma_f32_16x16x32_bf16 v[40:43], v[152:155], v[164:167], v[40:43]
    ds_read_b64_tr_b16 v[184:185], v1 offset:32
    v_mfma_f32_16x16x32_bf16 v[44:47], v[156:159], v[164:167], v[44:47]
    ds_read_b64_tr_b16 v[186:187], v1 offset:464
    v_mfma_f32_16x16x32_bf16 v[48:51], v[160:163], v[164:167], v[48:51]
    ds_read_b64_tr_b16 v[188:189], v1 offset:144
    s_waitcnt lgkmcnt(7)
    v_mfma_f32_16x16x32_bf16 v[76:79], v[160:163], v[168:171], v[76:79]
    ds_read_b64_tr_b16 v[190:191], v1 offset:576
    v_mfma_f32_16x16x32_bf16 v[72:75], v[156:159], v[168:171], v[72:75]
    ds_read_b64_tr_b16 v[192:193], v1 offset:176
    v_mfma_f32_16x16x32_bf16 v[68:71], v[152:155], v[168:171], v[68:71]
    ds_read_b64_tr_b16 v[194:195], v1 offset:608
    v_mfma_f32_16x16x32_bf16 v[64:67], v[148:151], v[168:171], v[64:67]
    ds_read_b64_tr_b16 v[196:197], v2 offset:0
    v_mfma_f32_16x16x32_bf16 v[60:63], v[144:147], v[168:171], v[60:63]
    ds_read_b64_tr_b16 v[198:199], v2 offset:432
    v_mfma_f32_16x16x32_bf16 v[56:59], v[140:143], v[168:171], v[56:59]
    ds_read_b64_tr_b16 v[200:201], v1 offset:288
    v_mfma_f32_16x16x32_bf16 v[52:55], v[136:139], v[168:171], v[52:55]
    ds_read_b64_tr_b16 v[202:203], v1 offset:720
    v_mfma_f32_16x16x32_bf16 v[80:83], v[136:139], v[172:175], v[80:83]
    ds_read_b64_tr_b16 v[204:205], v1 offset:320
    v_mfma_f32_16x16x32_bf16 v[84:87], v[140:143], v[172:175], v[84:87]
    ds_read_b64_tr_b16 v[206:207], v1 offset:752
    v_mfma_f32_16x16x32_bf16 v[88:91], v[144:147], v[172:175], v[88:91]
    ds_read_b64_tr_b16 v[212:213], v3 offset:1024
    v_mfma_f32_16x16x32_bf16 v[92:95], v[148:151], v[172:175], v[92:95]
    ds_read_b64_tr_b16 v[214:215], v4 offset:1024
    v_mfma_f32_16x16x32_bf16 v[96:99], v[152:155], v[172:175], v[96:99]
    ds_read_b64_tr_b16 v[216:217], v3 offset:2048
    v_mfma_f32_16x16x32_bf16 v[100:103], v[156:159], v[172:175], v[100:103]
    ds_read_b64_tr_b16 v[218:219], v4 offset:2048
    v_mfma_f32_16x16x32_bf16 v[104:107], v[160:163], v[172:175], v[104:107]
    ds_read_b64_tr_b16 v[220:221], v3 offset:3072
    v_mfma_f32_16x16x32_bf16 v[132:135], v[160:163], v[176:179], v[132:135]
    ds_read_b64_tr_b16 v[222:223], v4 offset:3072
    v_mfma_f32_16x16x32_bf16 v[128:131], v[156:159], v[176:179], v[128:131]
    v_add_u32 v1, 0, v224
    v_mfma_f32_16x16x32_bf16 v[124:127], v[152:155], v[176:179], v[124:127]
    v_add_u32 v2, 0, v225
    v_mfma_f32_16x16x32_bf16 v[120:123], v[148:151], v[176:179], v[120:123]
    v_add_u32 v3, 0, v226
    v_mfma_f32_16x16x32_bf16 v[116:119], v[144:147], v[176:179], v[116:119]
    v_add_u32 v4, 0, v227
    v_mfma_f32_16x16x32_bf16 v[112:115], v[140:143], v[176:179], v[112:115]
    v_mfma_f32_16x16x32_bf16 v[108:111], v[136:139], v[176:179], v[108:111]
    s_waitcnt vmcnt(4) lgkmcnt(6)
    s_barrier
    s_add_u32 m0, s99, 61440
    s_nop 0
    buffer_load_dwordx4 v228, s[12:15], s28 offen offset:0 lds
    buffer_load_dwordx4 v229, s[12:15], s28 offen offset:1024 lds
    buffer_load_dwordx4 v230, s[12:15], s28 offen offset:2048 lds
    s_mov_b64 exec, 0xffffff
    buffer_load_dwordx4 v231, s[12:15], s28 offen offset:3072 lds
    s_mov_b64 exec, -1
    s_add_u32 s28, s28, 110592
    v_lshl_or_b32 v21, v19, 16, v17
    ds_write_b32 v15, v21 offset:3072
    ds_read_u16 v17, v253 offset:32
    ds_read_u16 v19, v253 offset:68
    v_and_b32 v13, 15, v11
    v_lshrrev_b32 v9, 3, v11
    v_subrev_u32 v9, 20, v9
    v_and_or_b32 v10, v11, 7, 16
    v_cndmask_b32 v12, v9, v12, vcc
    v_cndmask_b32 v13, v10, v13, vcc
    v_mul_u32_u24 v13, 80, v13
    v_lshlrev_b32 v12, 3, v12
    v_add3_u32 v242, v13, v12, s38
    v_lshlrev_b32 v240, 4, v11
    v_mfma_f32_16x16x32_bf16 v[24:27], v[180:183], v[208:211], v[24:27]
    ds_read_b64_tr_b16 v[164:165], v3 offset:0
    v_mfma_f32_16x16x32_bf16 v[28:31], v[184:187], v[208:211], v[28:31]
    ds_read_b64_tr_b16 v[166:167], v4 offset:0
    v_mfma_f32_16x16x32_bf16 v[32:35], v[188:191], v[208:211], v[32:35]
    ds_read_b64_tr_b16 v[136:137], v1 offset:0
    v_mfma_f32_16x16x32_bf16 v[36:39], v[192:195], v[208:211], v[36:39]
    ds_read_b64_tr_b16 v[138:139], v1 offset:432
    v_mfma_f32_16x16x32_bf16 v[40:43], v[196:199], v[208:211], v[40:43]
    ds_read_b64_tr_b16 v[140:141], v1 offset:32
    v_mfma_f32_16x16x32_bf16 v[44:47], v[200:203], v[208:211], v[44:47]
    ds_read_b64_tr_b16 v[142:143], v1 offset:464
    v_mfma_f32_16x16x32_bf16 v[48:51], v[204:207], v[208:211], v[48:51]
    ds_read_b64_tr_b16 v[144:145], v1 offset:144
    s_waitcnt lgkmcnt(7)
    v_mfma_f32_16x16x32_bf16 v[76:79], v[204:207], v[212:215], v[76:79]
    ds_read_b64_tr_b16 v[146:147], v1 offset:576
    v_mfma_f32_16x16x32_bf16 v[72:75], v[200:203], v[212:215], v[72:75]
    ds_read_b64_tr_b16 v[148:149], v1 offset:176
    v_mfma_f32_16x16x32_bf16 v[68:71], v[196:199], v[212:215], v[68:71]
    ds_read_b64_tr_b16 v[150:151], v1 offset:608
    v_mfma_f32_16x16x32_bf16 v[64:67], v[192:195], v[212:215], v[64:67]
    ds_read_b64_tr_b16 v[152:153], v2 offset:0
    v_mfma_f32_16x16x32_bf16 v[60:63], v[188:191], v[212:215], v[60:63]
    ds_read_b64_tr_b16 v[154:155], v2 offset:432
    v_mfma_f32_16x16x32_bf16 v[56:59], v[184:187], v[212:215], v[56:59]
    ds_read_b64_tr_b16 v[156:157], v1 offset:288
    v_mfma_f32_16x16x32_bf16 v[52:55], v[180:183], v[212:215], v[52:55]
    ds_read_b64_tr_b16 v[158:159], v1 offset:720
    v_mfma_f32_16x16x32_bf16 v[80:83], v[180:183], v[216:219], v[80:83]
    ds_read_b64_tr_b16 v[160:161], v1 offset:320
    v_mfma_f32_16x16x32_bf16 v[84:87], v[184:187], v[216:219], v[84:87]
    ds_read_b64_tr_b16 v[162:163], v1 offset:752
    v_mfma_f32_16x16x32_bf16 v[88:91], v[188:191], v[216:219], v[88:91]
    ds_read_b64_tr_b16 v[168:169], v3 offset:1024
    v_mfma_f32_16x16x32_bf16 v[92:95], v[192:195], v[216:219], v[92:95]
    ds_read_b64_tr_b16 v[170:171], v4 offset:1024
    v_mfma_f32_16x16x32_bf16 v[96:99], v[196:199], v[216:219], v[96:99]
    ds_read_b64_tr_b16 v[172:173], v3 offset:2048
    v_mfma_f32_16x16x32_bf16 v[100:103], v[200:203], v[216:219], v[100:103]
    ds_read_b64_tr_b16 v[174:175], v4 offset:2048
    v_mfma_f32_16x16x32_bf16 v[104:107], v[204:207], v[216:219], v[104:107]
    ds_read_b64_tr_b16 v[176:177], v3 offset:3072
    v_mfma_f32_16x16x32_bf16 v[132:135], v[204:207], v[220:223], v[132:135]
    ds_read_b64_tr_b16 v[178:179], v4 offset:3072
    v_mfma_f32_16x16x32_bf16 v[128:131], v[200:203], v[220:223], v[128:131]
    v_add_u32 v1, 30720, v224
    v_mfma_f32_16x16x32_bf16 v[124:127], v[196:199], v[220:223], v[124:127]
    v_add_u32 v2, 30720, v225
    v_mfma_f32_16x16x32_bf16 v[120:123], v[192:195], v[220:223], v[120:123]
    v_add_u32 v3, 30720, v226
    v_mfma_f32_16x16x32_bf16 v[116:119], v[188:191], v[220:223], v[116:119]
    v_add_u32 v4, 30720, v227
    v_mfma_f32_16x16x32_bf16 v[112:115], v[184:187], v[220:223], v[112:115]
    v_mfma_f32_16x16x32_bf16 v[108:111], v[180:183], v[220:223], v[108:111]
    s_waitcnt vmcnt(4) lgkmcnt(6)
    s_barrier
    s_add_u32 m0, s99, 92160
    s_nop 0
    buffer_load_dwordx4 v228, s[12:15], s28 offen offset:0 lds
    buffer_load_dwordx4 v229, s[12:15], s28 offen offset:1024 lds
    buffer_load_dwordx4 v230, s[12:15], s28 offen offset:2048 lds
    s_mov_b64 exec, 0xffffff
    buffer_load_dwordx4 v231, s[12:15], s28 offen offset:3072 lds
    s_mov_b64 exec, -1
    s_add_u32 s28, s28, 110592
    v_lshl_or_b32 v21, v19, 16, v17
    ds_write_b32 v15, v21 offset:4096
    ds_read_u16 v17, v254 offset:0
    ds_read_u16 v19, v254 offset:36
    v_cmp_gt_u32 vcc, 56, v0
    v_mov_b32 v12, 149632
    s_nop 0
    v_cndmask_b32 v240, v7, v240, vcc
    v_cndmask_b32 v242, v12, v242, vcc
    v_lshrrev_b32 v11, 3, v6
    v_and_b32 v12, 7, v0
    v_cmp_eq_u32 vcc, v11, v14
    s_mul_i32 s41, s98, 3840
    s_add_u32 s41, s41, 153600
    v_mfma_f32_16x16x32_bf16 v[24:27], v[136:139], v[164:167], v[24:27]
    ds_read_b64_tr_b16 v[208:209], v3 offset:0
    v_mfma_f32_16x16x32_bf16 v[28:31], v[140:143], v[164:167], v[28:31]
    ds_read_b64_tr_b16 v[210:211], v4 offset:0
    v_mfma_f32_16x16x32_bf16 v[32:35], v[144:147], v[164:167], v[32:35]
    ds_read_b64_tr_b16 v[180:181], v1 offset:0
    v_mfma_f32_16x16x32_bf16 v[36:39], v[148:151], v[164:167], v[36:39]
    ds_read_b64_tr_b16 v[182:183], v1 offset:432
    v_mfma_f32_16x16x32_bf16 v[40:43], v[152:155], v[164:167], v[40:43]
    ds_read_b64_tr_b16 v[184:185], v1 offset:32
    v_mfma_f32_16x16x32_bf16 v[44:47], v[156:159], v[164:167], v[44:47]
    ds_read_b64_tr_b16 v[186:187], v1 offset:464
    v_mfma_f32_16x16x32_bf16 v[48:51], v[160:163], v[164:167], v[48:51]
    ds_read_b64_tr_b16 v[188:189], v1 offset:144
    s_waitcnt lgkmcnt(7)
    v_mfma_f32_16x16x32_bf16 v[76:79], v[160:163], v[168:171], v[76:79]
    ds_read_b64_tr_b16 v[190:191], v1 offset:576
    v_mfma_f32_16x16x32_bf16 v[72:75], v[156:159], v[168:171], v[72:75]
    ds_read_b64_tr_b16 v[192:193], v1 offset:176
    v_mfma_f32_16x16x32_bf16 v[68:71], v[152:155], v[168:171], v[68:71]
    ds_read_b64_tr_b16 v[194:195], v1 offset:608
    v_mfma_f32_16x16x32_bf16 v[64:67], v[148:151], v[168:171], v[64:67]
    ds_read_b64_tr_b16 v[196:197], v2 offset:0
    v_mfma_f32_16x16x32_bf16 v[60:63], v[144:147], v[168:171], v[60:63]
    ds_read_b64_tr_b16 v[198:199], v2 offset:432
    v_mfma_f32_16x16x32_bf16 v[56:59], v[140:143], v[168:171], v[56:59]
    ds_read_b64_tr_b16 v[200:201], v1 offset:288
    v_mfma_f32_16x16x32_bf16 v[52:55], v[136:139], v[168:171], v[52:55]
    ds_read_b64_tr_b16 v[202:203], v1 offset:720
    v_mfma_f32_16x16x32_bf16 v[80:83], v[136:139], v[172:175], v[80:83]
    ds_read_b64_tr_b16 v[204:205], v1 offset:320
    v_mfma_f32_16x16x32_bf16 v[84:87], v[140:143], v[172:175], v[84:87]
    ds_read_b64_tr_b16 v[206:207], v1 offset:752
    v_mfma_f32_16x16x32_bf16 v[88:91], v[144:147], v[172:175], v[88:91]
    ds_read_b64_tr_b16 v[212:213], v3 offset:1024
    v_mfma_f32_16x16x32_bf16 v[92:95], v[148:151], v[172:175], v[92:95]
    ds_read_b64_tr_b16 v[214:215], v4 offset:1024
    v_mfma_f32_16x16x32_bf16 v[96:99], v[152:155], v[172:175], v[96:99]
    ds_read_b64_tr_b16 v[216:217], v3 offset:2048
    v_mfma_f32_16x16x32_bf16 v[100:103], v[156:159], v[172:175], v[100:103]
    ds_read_b64_tr_b16 v[218:219], v4 offset:2048
    v_mfma_f32_16x16x32_bf16 v[104:107], v[160:163], v[172:175], v[104:107]
    ds_read_b64_tr_b16 v[220:221], v3 offset:3072
    v_mfma_f32_16x16x32_bf16 v[132:135], v[160:163], v[176:179], v[132:135]
    ds_read_b64_tr_b16 v[222:223], v4 offset:3072
    v_mfma_f32_16x16x32_bf16 v[128:131], v[156:159], v[176:179], v[128:131]
    v_add_u32 v1, 61440, v224
    v_mfma_f32_16x16x32_bf16 v[124:127], v[152:155], v[176:179], v[124:127]
    v_add_u32 v2, 61440, v225
    v_mfma_f32_16x16x32_bf16 v[120:123], v[148:151], v[176:179], v[120:123]
    v_add_u32 v3, 61440, v226
    v_mfma_f32_16x16x32_bf16 v[116:119], v[144:147], v[176:179], v[116:119]
    v_add_u32 v4, 61440, v227
    v_mfma_f32_16x16x32_bf16 v[112:115], v[140:143], v[176:179], v[112:115]
    v_mfma_f32_16x16x32_bf16 v[108:111], v[136:139], v[176:179], v[108:111]
    s_waitcnt vmcnt(4) lgkmcnt(6)
    s_barrier
    s_add_u32 m0, s99, 0
    s_nop 0
    buffer_load_dwordx4 v228, s[12:15], s28 offen offset:0 lds
    buffer_load_dwordx4 v229, s[12:15], s28 offen offset:1024 lds
    buffer_load_dwordx4 v230, s[12:15], s28 offen offset:2048 lds
    s_mov_b64 exec, 0xffffff
    buffer_load_dwordx4 v231, s[12:15], s28 offen offset:3072 lds
    s_mov_b64 exec, -1
    s_add_u32 s28, s28, 110592
    v_lshl_or_b32 v21, v19, 16, v17
    ds_write_b32 v15, v21 offset:5120
    ds_read_u16 v17, v254 offset:8
    ds_read_u16 v19, v254 offset:44
    v_mul_u32_u24 v9, 1920, v11
    v_mul_u32_u24 v10, 40, v8
    v_add3_u32 v9, v9, v10, s41
    v_lshlrev_b32 v10, 1, v11
    v_sub_u32 v10, v12, v10
    v_mov_b32 v247, 149504
    v_add_u32 v13, 20, v10
    v_add_u32 v243, 0, v10
    v_min_u32 v13, v13, v243
    v_min_u32 v13, 20, v13
    v_mfma_f32_16x16x32_bf16 v[24:27], v[180:183], v[208:211], v[24:27]
    ds_read_b64_tr_b16 v[164:165], v3 offset:0
    v_mfma_f32_16x16x32_bf16 v[28:31], v[184:187], v[208:211], v[28:31]
    ds_read_b64_tr_b16 v[166:167], v4 offset:0
    v_mfma_f32_16x16x32_bf16 v[32:35], v[188:191], v[208:211], v[32:35]
    ds_read_b64_tr_b16 v[136:137], v1 offset:0
    v_mfma_f32_16x16x32_bf16 v[36:39], v[192:195], v[208:211], v[36:39]
    ds_read_b64_tr_b16 v[138:139], v1 offset:432
    v_mfma_f32_16x16x32_bf16 v[40:43], v[196:199], v[208:211], v[40:43]
    ds_read_b64_tr_b16 v[140:141], v1 offset:32
    v_mfma_f32_16x16x32_bf16 v[44:47], v[200:203], v[208:211], v[44:47]
    ds_read_b64_tr_b16 v[142:143], v1 offset:464
    v_mfma_f32_16x16x32_bf16 v[48:51], v[204:207], v[208:211], v[48:51]
    ds_read_b64_tr_b16 v[144:145], v1 offset:144
    s_waitcnt lgkmcnt(7)
    v_mfma_f32_16x16x32_bf16 v[76:79], v[204:207], v[212:215], v[76:79]
    ds_read_b64_tr_b16 v[146:147], v1 offset:576
    v_mfma_f32_16x16x32_bf16 v[72:75], v[200:203], v[212:215], v[72:75]
    ds_read_b64_tr_b16 v[148:149], v1 offset:176
    v_mfma_f32_16x16x32_bf16 v[68:71], v[196:199], v[212:215], v[68:71]
    ds_read_b64_tr_b16 v[150:151], v1 offset:608
    v_mfma_f32_16x16x32_bf16 v[64:67], v[192:195], v[212:215], v[64:67]
    ds_read_b64_tr_b16 v[152:153], v2 offset:0
    v_mfma_f32_16x16x32_bf16 v[60:63], v[188:191], v[212:215], v[60:63]
    ds_read_b64_tr_b16 v[154:155], v2 offset:432
    v_mfma_f32_16x16x32_bf16 v[56:59], v[184:187], v[212:215], v[56:59]
    ds_read_b64_tr_b16 v[156:157], v1 offset:288
    v_mfma_f32_16x16x32_bf16 v[52:55], v[180:183], v[212:215], v[52:55]
    ds_read_b64_tr_b16 v[158:159], v1 offset:720
    v_mfma_f32_16x16x32_bf16 v[80:83], v[180:183], v[216:219], v[80:83]
    ds_read_b64_tr_b16 v[160:161], v1 offset:320
    v_mfma_f32_16x16x32_bf16 v[84:87], v[184:187], v[216:219], v[84:87]
    ds_read_b64_tr_b16 v[162:163], v1 offset:752
    v_mfma_f32_16x16x32_bf16 v[88:91], v[188:191], v[216:219], v[88:91]
    ds_read_b64_tr_b16 v[168:169], v3 offset:1024
    v_mfma_f32_16x16x32_bf16 v[92:95], v[192:195], v[216:219], v[92:95]
    ds_read_b64_tr_b16 v[170:171], v4 offset:1024
    v_mfma_f32_16x16x32_bf16 v[96:99], v[196:199], v[216:219], v[96:99]
    ds_read_b64_tr_b16 v[172:173], v3 offset:2048
    v_mfma_f32_16x16x32_bf16 v[100:103], v[200:203], v[216:219], v[100:103]
    ds_read_b64_tr_b16 v[174:175], v4 offset:2048
    v_mfma_f32_16x16x32_bf16 v[104:107], v[204:207], v[216:219], v[104:107]
    ds_read_b64_tr_b16 v[176:177], v3 offset:3072
    v_mfma_f32_16x16x32_bf16 v[132:135], v[204:207], v[220:223], v[132:135]
    ds_read_b64_tr_b16 v[178:179], v4 offset:3072
    v_mfma_f32_16x16x32_bf16 v[128:131], v[200:203], v[220:223], v[128:131]
    v_add_u32 v1, 92160, v224
    v_mfma_f32_16x16x32_bf16 v[124:127], v[196:199], v[220:223], v[124:127]
    v_add_u32 v2, 92160, v225
    v_mfma_f32_16x16x32_bf16 v[120:123], v[192:195], v[220:223], v[120:123]
    v_add_u32 v3, 92160, v226
    v_mfma_f32_16x16x32_bf16 v[116:119], v[188:191], v[220:223], v[116:119]
    v_add_u32 v4, 92160, v227
    v_mfma_f32_16x16x32_bf16 v[112:115], v[184:187], v[220:223], v[112:115]
    v_mfma_f32_16x16x32_bf16 v[108:111], v[180:183], v[220:223], v[108:111]
    s_waitcnt vmcnt(4) lgkmcnt(6)
    s_barrier
    s_add_u32 m0, s99, 30720
    s_nop 0
    buffer_load_dwordx4 v228, s[12:15], s28 offen offset:0 lds
    buffer_load_dwordx4 v229, s[12:15], s28 offen offset:1024 lds
    buffer_load_dwordx4 v230, s[12:15], s28 offen offset:2048 lds
    s_mov_b64 exec, 0xffffff
    buffer_load_dwordx4 v231, s[12:15], s28 offen offset:3072 lds
    s_mov_b64 exec, -1
    s_add_u32 s28, s28, 110592
    v_lshl_or_b32 v21, v19, 16, v17
    ds_write_b32 v15, v21 offset:6144
    ds_read_u16 v17, v254 offset:16
    ds_read_u16 v19, v254 offset:52
    v_mul_u32_u24 v13, 80, v13
    v_add_u32 v13, v13, v9
    v_cndmask_b32 v243, v247, v13, vcc
    v_add_u32 v13, 28, v10
    v_add_u32 v244, 8, v10
    v_min_u32 v13, v13, v244
    v_min_u32 v13, 20, v13
    v_mul_u32_u24 v13, 80, v13
    v_add_u32 v13, v13, v9
    v_cndmask_b32 v244, v247, v13, vcc
    v_mfma_f32_16x16x32_bf16 v[24:27], v[136:139], v[164:167], v[24:27]
    ds_read_b64_tr_b16 v[208:209], v3 offset:0
    v_mfma_f32_16x16x32_bf16 v[28:31], v[140:143], v[164:167], v[28:31]
    ds_read_b64_tr_b16 v[210:211], v4 offset:0
    v_mfma_f32_16x16x32_bf16 v[32:35], v[144:147], v[164:167], v[32:35]
    ds_read_b64_tr_b16 v[180:181], v1 offset:0
    v_mfma_f32_16x16x32_bf16 v[36:39], v[148:151], v[164:167], v[36:39]
    ds_read_b64_tr_b16 v[182:183], v1 offset:432
    v_mfma_f32_16x16x32_bf16 v[40:43], v[152:155], v[164:167], v[40:43]
    ds_read_b64_tr_b16 v[184:185], v1 offset:32
    v_mfma_f32_16x16x32_bf16 v[44:47], v[156:159], v[164:167], v[44:47]
    ds_read_b64_tr_b16 v[186:187], v1 offset:464
    v_mfma_f32_16x16x32_bf16 v[48:51], v[160:163], v[164:167], v[48:51]
    ds_read_b64_tr_b16 v[188:189], v1 offset:144
    s_waitcnt lgkmcnt(7)
    v_mfma_f32_16x16x32_bf16 v[76:79], v[160:163], v[168:171], v[76:79]
    ds_read_b64_tr_b16 v[190:191], v1 offset:576
    v_mfma_f32_16x16x32_bf16 v[72:75], v[156:159], v[168:171], v[72:75]
    ds_read_b64_tr_b16 v[192:193], v1 offset:176
    v_mfma_f32_16x16x32_bf16 v[68:71], v[152:155], v[168:171], v[68:71]
    ds_read_b64_tr_b16 v[194:195], v1 offset:608
    v_mfma_f32_16x16x32_bf16 v[64:67], v[148:151], v[168:171], v[64:67]
    ds_read_b64_tr_b16 v[196:197], v2 offset:0
    v_mfma_f32_16x16x32_bf16 v[60:63], v[144:147], v[168:171], v[60:63]
    ds_read_b64_tr_b16 v[198:199], v2 offset:432
    v_mfma_f32_16x16x32_bf16 v[56:59], v[140:143], v[168:171], v[56:59]
    ds_read_b64_tr_b16 v[200:201], v1 offset:288
    v_mfma_f32_16x16x32_bf16 v[52:55], v[136:139], v[168:171], v[52:55]
    ds_read_b64_tr_b16 v[202:203], v1 offset:720
    v_mfma_f32_16x16x32_bf16 v[80:83], v[136:139], v[172:175], v[80:83]
    ds_read_b64_tr_b16 v[204:205], v1 offset:320
    v_mfma_f32_16x16x32_bf16 v[84:87], v[140:143], v[172:175], v[84:87]
    ds_read_b64_tr_b16 v[206:207], v1 offset:752
    v_mfma_f32_16x16x32_bf16 v[88:91], v[144:147], v[172:175], v[88:91]
    ds_read_b64_tr_b16 v[212:213], v3 offset:1024
    v_mfma_f32_16x16x32_bf16 v[92:95], v[148:151], v[172:175], v[92:95]
    ds_read_b64_tr_b16 v[214:215], v4 offset:1024
    v_mfma_f32_16x16x32_bf16 v[96:99], v[152:155], v[172:175], v[96:99]
    ds_read_b64_tr_b16 v[216:217], v3 offset:2048
    v_mfma_f32_16x16x32_bf16 v[100:103], v[156:159], v[172:175], v[100:103]
    ds_read_b64_tr_b16 v[218:219], v4 offset:2048
    v_mfma_f32_16x16x32_bf16 v[104:107], v[160:163], v[172:175], v[104:107]
    ds_read_b64_tr_b16 v[220:221], v3 offset:3072
    v_mfma_f32_16x16x32_bf16 v[132:135], v[160:163], v[176:179], v[132:135]
    ds_read_b64_tr_b16 v[222:223], v4 offset:3072
    v_mfma_f32_16x16x32_bf16 v[128:131], v[156:159], v[176:179], v[128:131]
    v_add_u32 v1, 0, v224
    v_mfma_f32_16x16x32_bf16 v[124:127], v[152:155], v[176:179], v[124:127]
    v_add_u32 v2, 0, v225
    v_mfma_f32_16x16x32_bf16 v[120:123], v[148:151], v[176:179], v[120:123]
    v_add_u32 v3, 0, v226
    v_mfma_f32_16x16x32_bf16 v[116:119], v[144:147], v[176:179], v[116:119]
    v_add_u32 v4, 0, v227
    v_mfma_f32_16x16x32_bf16 v[112:115], v[140:143], v[176:179], v[112:115]
    v_mfma_f32_16x16x32_bf16 v[108:111], v[136:139], v[176:179], v[108:111]
    s_waitcnt vmcnt(4) lgkmcnt(6)
    s_barrier
    s_add_u32 m0, s99, 61440
    s_nop 0
    buffer_load_dwordx4 v228, s[12:15], s28 offen offset:0 lds
    buffer_load_dwordx4 v229, s[12:15], s28 offen offset:1024 lds
    buffer_load_dwordx4 v230, s[12:15], s28 offen offset:2048 lds
    s_mov_b64 exec, 0xffffff
    buffer_load_dwordx4 v231, s[12:15], s28 offen offset:3072 lds
    s_mov_b64 exec, -1
    s_add_u32 s28, s28, 110592
    v_lshl_or_b32 v21, v19, 16, v17
    ds_write_b32 v15, v21 offset:7168
    ds_read_u16 v17, v254 offset:24
    ds_read_u16 v19, v254 offset:60
    v_add_u32 v13, 36, v10
    v_add_u32 v245, 16, v10
    v_min_u32 v13, v13, v245
    v_min_u32 v13, 20, v13
    v_mul_u32_u24 v13, 80, v13
    v_add_u32 v13, v13, v9
    v_cndmask_b32 v245, v247, v13, vcc
    v_add_u32 v13, 1600, v9
    v_cndmask_b32 v246, v247, v13, vcc
    v_mul_u32_u24 v11, 18, v11
    v_mfma_f32_16x16x32_bf16 v[24:27], v[180:183], v[208:211], v[24:27]
    ds_read_b64_tr_b16 v[164:165], v3 offset:0
    v_mfma_f32_16x16x32_bf16 v[28:31], v[184:187], v[208:211], v[28:31]
    ds_read_b64_tr_b16 v[166:167], v4 offset:0
    v_mfma_f32_16x16x32_bf16 v[32:35], v[188:191], v[208:211], v[32:35]
    ds_read_b64_tr_b16 v[136:137], v1 offset:0
    v_mfma_f32_16x16x32_bf16 v[36:39], v[192:195], v[208:211], v[36:39]
    ds_read_b64_tr_b16 v[138:139], v1 offset:432
    v_mfma_f32_16x16x32_bf16 v[40:43], v[196:199], v[208:211], v[40:43]
    ds_read_b64_tr_b16 v[140:141], v1 offset:32
    v_mfma_f32_16x16x32_bf16 v[44:47], v[200:203], v[208:211], v[44:47]
    ds_read_b64_tr_b16 v[142:143], v1 offset:464
    v_mfma_f32_16x16x32_bf16 v[48:51], v[204:207], v[208:211], v[48:51]
    ds_read_b64_tr_b16 v[144:145], v1 offset:144
    s_waitcnt lgkmcnt(7)
    v_mfma_f32_16x16x32_bf16 v[76:79], v[204:207], v[212:215], v[76:79]
    ds_read_b64_tr_b16 v[146:147], v1 offset:576
    v_mfma_f32_16x16x32_bf16 v[72:75], v[200:203], v[212:215], v[72:75]
    ds_read_b64_tr_b16 v[148:149], v1 offset:176
    v_mfma_f32_16x16x32_bf16 v[68:71], v[196:199], v[212:215], v[68:71]
    ds_read_b64_tr_b16 v[150:151], v1 offset:608
    v_mfma_f32_16x16x32_bf16 v[64:67], v[192:195], v[212:215], v[64:67]
    ds_read_b64_tr_b16 v[152:153], v2 offset:0
    v_mfma_f32_16x16x32_bf16 v[60:63], v[188:191], v[212:215], v[60:63]
    ds_read_b64_tr_b16 v[154:155], v2 offset:432
    v_mfma_f32_16x16x32_bf16 v[56:59], v[184:187], v[212:215], v[56:59]
    ds_read_b64_tr_b16 v[156:157], v1 offset:288
    v_mfma_f32_16x16x32_bf16 v[52:55], v[180:183], v[212:215], v[52:55]
    ds_read_b64_tr_b16 v[158:159], v1 offset:720
    v_mfma_f32_16x16x32_bf16 v[80:83], v[180:183], v[216:219], v[80:83]
    ds_read_b64_tr_b16 v[160:161], v1 offset:320
    v_mfma_f32_16x16x32_bf16 v[84:87], v[184:187], v[216:219], v[84:87]
    ds_read_b64_tr_b16 v[162:163], v1 offset:752
    v_mfma_f32_16x16x32_bf16 v[88:91], v[188:191], v[216:219], v[88:91]
    ds_read_b64_tr_b16 v[168:169], v3 offset:1024
    v_mfma_f32_16x16x32_bf16 v[92:95], v[192:195], v[216:219], v[92:95]
    ds_read_b64_tr_b16 v[170:171], v4 offset:1024
    v_mfma_f32_16x16x32_bf16 v[96:99], v[196:199], v[216:219], v[96:99]
    ds_read_b64_tr_b16 v[172:173], v3 offset:2048
    v_mfma_f32_16x16x32_bf16 v[100:103], v[200:203], v[216:219], v[100:103]
    ds_read_b64_tr_b16 v[174:175], v4 offset:2048
    v_mfma_f32_16x16x32_bf16 v[104:107], v[204:207], v[216:219], v[104:107]
    ds_read_b64_tr_b16 v[176:177], v3 offset:3072
    v_mfma_f32_16x16x32_bf16 v[132:135], v[204:207], v[220:223], v[132:135]
    ds_read_b64_tr_b16 v[178:179], v4 offset:3072
    v_mfma_f32_16x16x32_bf16 v[128:131], v[200:203], v[220:223], v[128:131]
    v_add_u32 v1, 30720, v224
    v_mfma_f32_16x16x32_bf16 v[124:127], v[196:199], v[220:223], v[124:127]
    v_add_u32 v2, 30720, v225
    v_mfma_f32_16x16x32_bf16 v[120:123], v[192:195], v[220:223], v[120:123]
    v_add_u32 v3, 30720, v226
    v_mfma_f32_16x16x32_bf16 v[116:119], v[188:191], v[220:223], v[116:119]
    v_add_u32 v4, 30720, v227
    v_mfma_f32_16x16x32_bf16 v[112:115], v[184:187], v[220:223], v[112:115]
    v_mfma_f32_16x16x32_bf16 v[108:111], v[180:183], v[220:223], v[108:111]
    s_waitcnt vmcnt(4) lgkmcnt(6)
    s_barrier
    s_add_u32 m0, s99, 92160
    s_nop 0
    buffer_load_dwordx4 v228, s[12:15], s28 offen offset:0 lds
    buffer_load_dwordx4 v229, s[12:15], s28 offen offset:1024 lds
    buffer_load_dwordx4 v230, s[12:15], s28 offen offset:2048 lds
    s_mov_b64 exec, 0xffffff
    buffer_load_dwordx4 v231, s[12:15], s28 offen offset:3072 lds
    s_mov_b64 exec, -1
    s_add_u32 s28, s28, 110592
    v_lshl_or_b32 v21, v19, 16, v17
    ds_write_b32 v15, v21 offset:8192
    ds_read_u16 v17, v254 offset:32
    ds_read_u16 v19, v254 offset:68
    v_add_lshl_u32 v11, v11, v12, 4
    v_lshl_add_u32 v13, v14, 1, v8
    v_cmp_gt_u32 vcc, 2, v12
    s_mul_i32 s41, s4, 4608
    v_mul_u32_u24 v13, 576, v13
    v_add3_u32 v247, v13, v11, s41
    v_mov_b32 v13, 40960
    v_cndmask_b32 v248, v13, v247, vcc
    s_lshl_b32 s37, s96, 2
    s_add_u32 s37, s37, s97
    v_mfma_f32_16x16x32_bf16 v[24:27], v[136:139], v[164:167], v[24:27]
    ds_read_b64_tr_b16 v[208:209], v3 offset:0
    v_mfma_f32_16x16x32_bf16 v[28:31], v[140:143], v[164:167], v[28:31]
    ds_read_b64_tr_b16 v[210:211], v4 offset:0
    v_mfma_f32_16x16x32_bf16 v[32:35], v[144:147], v[164:167], v[32:35]
    ds_read_b64_tr_b16 v[180:181], v1 offset:0
    v_mfma_f32_16x16x32_bf16 v[36:39], v[148:151], v[164:167], v[36:39]
    ds_read_b64_tr_b16 v[182:183], v1 offset:432
    v_mfma_f32_16x16x32_bf16 v[40:43], v[152:155], v[164:167], v[40:43]
    ds_read_b64_tr_b16 v[184:185], v1 offset:32
    v_mfma_f32_16x16x32_bf16 v[44:47], v[156:159], v[164:167], v[44:47]
    ds_read_b64_tr_b16 v[186:187], v1 offset:464
    v_mfma_f32_16x16x32_bf16 v[48:51], v[160:163], v[164:167], v[48:51]
    ds_read_b64_tr_b16 v[188:189], v1 offset:144
    s_waitcnt lgkmcnt(7)
    v_mfma_f32_16x16x32_bf16 v[76:79], v[160:163], v[168:171], v[76:79]
    ds_read_b64_tr_b16 v[190:191], v1 offset:576
    v_mfma_f32_16x16x32_bf16 v[72:75], v[156:159], v[168:171], v[72:75]
    ds_read_b64_tr_b16 v[192:193], v1 offset:176
    v_mfma_f32_16x16x32_bf16 v[68:71], v[152:155], v[168:171], v[68:71]
    ds_read_b64_tr_b16 v[194:195], v1 offset:608
    v_mfma_f32_16x16x32_bf16 v[64:67], v[148:151], v[168:171], v[64:67]
    ds_read_b64_tr_b16 v[196:197], v2 offset:0
    v_mfma_f32_16x16x32_bf16 v[60:63], v[144:147], v[168:171], v[60:63]
    ds_read_b64_tr_b16 v[198:199], v2 offset:432
    v_mfma_f32_16x16x32_bf16 v[56:59], v[140:143], v[168:171], v[56:59]
    ds_read_b64_tr_b16 v[200:201], v1 offset:288
    v_mfma_f32_16x16x32_bf16 v[52:55], v[136:139], v[168:171], v[52:55]
    ds_read_b64_tr_b16 v[202:203], v1 offset:720
    v_mfma_f32_16x16x32_bf16 v[80:83], v[136:139], v[172:175], v[80:83]
    ds_read_b64_tr_b16 v[204:205], v1 offset:320
    v_mfma_f32_16x16x32_bf16 v[84:87], v[140:143], v[172:175], v[84:87]
    ds_read_b64_tr_b16 v[206:207], v1 offset:752
    v_mfma_f32_16x16x32_bf16 v[88:91], v[144:147], v[172:175], v[88:91]
    ds_read_b64_tr_b16 v[212:213], v3 offset:1024
    v_mfma_f32_16x16x32_bf16 v[92:95], v[148:151], v[172:175], v[92:95]
    ds_read_b64_tr_b16 v[214:215], v4 offset:1024
    v_mfma_f32_16x16x32_bf16 v[96:99], v[152:155], v[172:175], v[96:99]
    ds_read_b64_tr_b16 v[216:217], v3 offset:2048
    v_mfma_f32_16x16x32_bf16 v[100:103], v[156:159], v[172:175], v[100:103]
    ds_read_b64_tr_b16 v[218:219], v4 offset:2048
    v_mfma_f32_16x16x32_bf16 v[104:107], v[160:163], v[172:175], v[104:107]
    ds_read_b64_tr_b16 v[220:221], v3 offset:3072
    v_mfma_f32_16x16x32_bf16 v[132:135], v[160:163], v[176:179], v[132:135]
    ds_read_b64_tr_b16 v[222:223], v4 offset:3072
    v_mfma_f32_16x16x32_bf16 v[128:131], v[156:159], v[176:179], v[128:131]
    v_add_u32 v1, 61440, v224
    v_mfma_f32_16x16x32_bf16 v[124:127], v[152:155], v[176:179], v[124:127]
    v_add_u32 v2, 61440, v225
    v_mfma_f32_16x16x32_bf16 v[120:123], v[148:151], v[176:179], v[120:123]
    v_add_u32 v3, 61440, v226
    v_mfma_f32_16x16x32_bf16 v[116:119], v[144:147], v[176:179], v[116:119]
    v_add_u32 v4, 61440, v227
    v_mfma_f32_16x16x32_bf16 v[112:115], v[140:143], v[176:179], v[112:115]
    v_mfma_f32_16x16x32_bf16 v[108:111], v[136:139], v[176:179], v[108:111]
    s_waitcnt vmcnt(4) lgkmcnt(6)
    s_barrier
    s_add_u32 m0, s99, 0
    s_nop 0
    buffer_load_dwordx4 v228, s[12:15], s28 offen offset:0 lds
    buffer_load_dwordx4 v229, s[12:15], s28 offen offset:1024 lds
    buffer_load_dwordx4 v230, s[12:15], s28 offen offset:2048 lds
    s_mov_b64 exec, 0xffffff
    buffer_load_dwordx4 v231, s[12:15], s28 offen offset:3072 lds
    s_mov_b64 exec, -1
    s_add_u32 s28, s28, 110592
    v_lshl_or_b32 v21, v19, 16, v17
    ds_write_b32 v15, v21 offset:9216
    s_mul_i32 s37, s37, 73728
    s_mul_i32 s41, s5, 1152
    s_add_u32 s37, s37, s41
    s_mul_i32 s41, s98, 576
    s_add_u32 s37, s37, s41
    s_add_u32 s37, s37, 10485760
    v_mfma_f32_16x16x32_bf16 v[24:27], v[180:183], v[208:211], v[24:27]
    ds_read_b64_tr_b16 v[164:165], v3 offset:0
    v_mfma_f32_16x16x32_bf16 v[28:31], v[184:187], v[208:211], v[28:31]
    ds_read_b64_tr_b16 v[166:167], v4 offset:0
    v_mfma_f32_16x16x32_bf16 v[32:35], v[188:191], v[208:211], v[32:35]
    ds_read_b64_tr_b16 v[136:137], v1 offset:0
    v_mfma_f32_16x16x32_bf16 v[36:39], v[192:195], v[208:211], v[36:39]
    ds_read_b64_tr_b16 v[138:139], v1 offset:432
    v_mfma_f32_16x16x32_bf16 v[40:43], v[196:199], v[208:211], v[40:43]
    ds_read_b64_tr_b16 v[140:141], v1 offset:32
    v_mfma_f32_16x16x32_bf16 v[44:47], v[200:203], v[208:211], v[44:47]
    ds_read_b64_tr_b16 v[142:143], v1 offset:464
    v_mfma_f32_16x16x32_bf16 v[48:51], v[204:207], v[208:211], v[48:51]
    ds_read_b64_tr_b16 v[144:145], v1 offset:144
    s_waitcnt lgkmcnt(7)
    v_mfma_f32_16x16x32_bf16 v[76:79], v[204:207], v[212:215], v[76:79]
    ds_read_b64_tr_b16 v[146:147], v1 offset:576
    v_mfma_f32_16x16x32_bf16 v[72:75], v[200:203], v[212:215], v[72:75]
    ds_read_b64_tr_b16 v[148:149], v1 offset:176
    v_mfma_f32_16x16x32_bf16 v[68:71], v[196:199], v[212:215], v[68:71]
    ds_read_b64_tr_b16 v[150:151], v1 offset:608
    v_mfma_f32_16x16x32_bf16 v[64:67], v[192:195], v[212:215], v[64:67]
    ds_read_b64_tr_b16 v[152:153], v2 offset:0
    v_mfma_f32_16x16x32_bf16 v[60:63], v[188:191], v[212:215], v[60:63]
    ds_read_b64_tr_b16 v[154:155], v2 offset:432
    v_mfma_f32_16x16x32_bf16 v[56:59], v[184:187], v[212:215], v[56:59]
    ds_read_b64_tr_b16 v[156:157], v1 offset:288
    v_mfma_f32_16x16x32_bf16 v[52:55], v[180:183], v[212:215], v[52:55]
    ds_read_b64_tr_b16 v[158:159], v1 offset:720
    v_mfma_f32_16x16x32_bf16 v[80:83], v[180:183], v[216:219], v[80:83]
    ds_read_b64_tr_b16 v[160:161], v1 offset:320
    v_mfma_f32_16x16x32_bf16 v[84:87], v[184:187], v[216:219], v[84:87]
    ds_read_b64_tr_b16 v[162:163], v1 offset:752
    v_mfma_f32_16x16x32_bf16 v[88:91], v[188:191], v[216:219], v[88:91]
    ds_read_b64_tr_b16 v[168:169], v3 offset:1024
    v_mfma_f32_16x16x32_bf16 v[92:95], v[192:195], v[216:219], v[92:95]
    ds_read_b64_tr_b16 v[170:171], v4 offset:1024
    v_mfma_f32_16x16x32_bf16 v[96:99], v[196:199], v[216:219], v[96:99]
    ds_read_b64_tr_b16 v[172:173], v3 offset:2048
    v_mfma_f32_16x16x32_bf16 v[100:103], v[200:203], v[216:219], v[100:103]
    ds_read_b64_tr_b16 v[174:175], v4 offset:2048
    v_mfma_f32_16x16x32_bf16 v[104:107], v[204:207], v[216:219], v[104:107]
    ds_read_b64_tr_b16 v[176:177], v3 offset:3072
    v_mfma_f32_16x16x32_bf16 v[132:135], v[204:207], v[220:223], v[132:135]
    ds_read_b64_tr_b16 v[178:179], v4 offset:3072
    v_mfma_f32_16x16x32_bf16 v[128:131], v[200:203], v[220:223], v[128:131]
    v_add_u32 v1, 92160, v224
    v_mfma_f32_16x16x32_bf16 v[124:127], v[196:199], v[220:223], v[124:127]
    v_add_u32 v2, 92160, v225
    v_mfma_f32_16x16x32_bf16 v[120:123], v[192:195], v[220:223], v[120:123]
    v_add_u32 v3, 92160, v226
    v_mfma_f32_16x16x32_bf16 v[116:119], v[188:191], v[220:223], v[116:119]
    v_add_u32 v4, 92160, v227
    v_mfma_f32_16x16x32_bf16 v[112:115], v[184:187], v[220:223], v[112:115]
    v_mfma_f32_16x16x32_bf16 v[108:111], v[180:183], v[220:223], v[108:111]
    s_waitcnt vmcnt(4) lgkmcnt(6)
    s_barrier
    s_add_u32 m0, s99, 30720
    s_nop 0
    buffer_load_dwordx4 v228, s[12:15], s28 offen offset:0 lds
    buffer_load_dwordx4 v229, s[12:15], s28 offen offset:1024 lds
    buffer_load_dwordx4 v230, s[12:15], s28 offen offset:2048 lds
    s_mov_b64 exec, 0xffffff
    buffer_load_dwordx4 v231, s[12:15], s28 offen offset:3072 lds
    s_mov_b64 exec, -1
    s_add_u32 s28, s28, 110592
    v_mfma_f32_16x16x32_bf16 v[24:27], v[136:139], v[164:167], v[24:27]
    ds_read_b64_tr_b16 v[208:209], v3 offset:0
    v_mfma_f32_16x16x32_bf16 v[28:31], v[140:143], v[164:167], v[28:31]
    ds_read_b64_tr_b16 v[210:211], v4 offset:0
    v_mfma_f32_16x16x32_bf16 v[32:35], v[144:147], v[164:167], v[32:35]
    ds_read_b64_tr_b16 v[180:181], v1 offset:0
    v_mfma_f32_16x16x32_bf16 v[36:39], v[148:151], v[164:167], v[36:39]
    ds_read_b64_tr_b16 v[182:183], v1 offset:432
    v_mfma_f32_16x16x32_bf16 v[40:43], v[152:155], v[164:167], v[40:43]
    ds_read_b64_tr_b16 v[184:185], v1 offset:32
    v_mfma_f32_16x16x32_bf16 v[44:47], v[156:159], v[164:167], v[44:47]
    ds_read_b64_tr_b16 v[186:187], v1 offset:464
    v_mfma_f32_16x16x32_bf16 v[48:51], v[160:163], v[164:167], v[48:51]
    ds_read_b64_tr_b16 v[188:189], v1 offset:144
    s_waitcnt lgkmcnt(7)
    v_mfma_f32_16x16x32_bf16 v[76:79], v[160:163], v[168:171], v[76:79]
    ds_read_b64_tr_b16 v[190:191], v1 offset:576
    v_mfma_f32_16x16x32_bf16 v[72:75], v[156:159], v[168:171], v[72:75]
    ds_read_b64_tr_b16 v[192:193], v1 offset:176
    v_mfma_f32_16x16x32_bf16 v[68:71], v[152:155], v[168:171], v[68:71]
    ds_read_b64_tr_b16 v[194:195], v1 offset:608
    v_mfma_f32_16x16x32_bf16 v[64:67], v[148:151], v[168:171], v[64:67]
    ds_read_b64_tr_b16 v[196:197], v2 offset:0
    v_mfma_f32_16x16x32_bf16 v[60:63], v[144:147], v[168:171], v[60:63]
    ds_read_b64_tr_b16 v[198:199], v2 offset:432
    v_mfma_f32_16x16x32_bf16 v[56:59], v[140:143], v[168:171], v[56:59]
    ds_read_b64_tr_b16 v[200:201], v1 offset:288
    v_mfma_f32_16x16x32_bf16 v[52:55], v[136:139], v[168:171], v[52:55]
    ds_read_b64_tr_b16 v[202:203], v1 offset:720
    v_mfma_f32_16x16x32_bf16 v[80:83], v[136:139], v[172:175], v[80:83]
    ds_read_b64_tr_b16 v[204:205], v1 offset:320
    v_mfma_f32_16x16x32_bf16 v[84:87], v[140:143], v[172:175], v[84:87]
    ds_read_b64_tr_b16 v[206:207], v1 offset:752
    v_mfma_f32_16x16x32_bf16 v[88:91], v[144:147], v[172:175], v[88:91]
    ds_read_b64_tr_b16 v[212:213], v3 offset:1024
    v_mfma_f32_16x16x32_bf16 v[92:95], v[148:151], v[172:175], v[92:95]
    ds_read_b64_tr_b16 v[214:215], v4 offset:1024
    v_mfma_f32_16x16x32_bf16 v[96:99], v[152:155], v[172:175], v[96:99]
    ds_read_b64_tr_b16 v[216:217], v3 offset:2048
    v_mfma_f32_16x16x32_bf16 v[100:103], v[156:159], v[172:175], v[100:103]
    ds_read_b64_tr_b16 v[218:219], v4 offset:2048
    v_mfma_f32_16x16x32_bf16 v[104:107], v[160:163], v[172:175], v[104:107]
    ds_read_b64_tr_b16 v[220:221], v3 offset:3072
    v_mfma_f32_16x16x32_bf16 v[132:135], v[160:163], v[176:179], v[132:135]
    ds_read_b64_tr_b16 v[222:223], v4 offset:3072
    v_mfma_f32_16x16x32_bf16 v[128:131], v[156:159], v[176:179], v[128:131]
    v_add_u32 v1, 0, v224
    v_mfma_f32_16x16x32_bf16 v[124:127], v[152:155], v[176:179], v[124:127]
    v_add_u32 v2, 0, v225
    v_mfma_f32_16x16x32_bf16 v[120:123], v[148:151], v[176:179], v[120:123]
    v_add_u32 v3, 0, v226
    v_mfma_f32_16x16x32_bf16 v[116:119], v[144:147], v[176:179], v[116:119]
    v_add_u32 v4, 0, v227
    v_mfma_f32_16x16x32_bf16 v[112:115], v[140:143], v[176:179], v[112:115]
    v_mfma_f32_16x16x32_bf16 v[108:111], v[136:139], v[176:179], v[108:111]
    s_waitcnt vmcnt(4) lgkmcnt(6)
    s_barrier
    v_mfma_f32_16x16x32_bf16 v[24:27], v[180:183], v[208:211], v[24:27]
    ds_read_b64_tr_b16 v[164:165], v3 offset:0
    v_mfma_f32_16x16x32_bf16 v[28:31], v[184:187], v[208:211], v[28:31]
    ds_read_b64_tr_b16 v[166:167], v4 offset:0
    v_mfma_f32_16x16x32_bf16 v[32:35], v[188:191], v[208:211], v[32:35]
    ds_read_b64_tr_b16 v[136:137], v1 offset:0
    v_mfma_f32_16x16x32_bf16 v[36:39], v[192:195], v[208:211], v[36:39]
    ds_read_b64_tr_b16 v[138:139], v1 offset:432
    v_mfma_f32_16x16x32_bf16 v[40:43], v[196:199], v[208:211], v[40:43]
    ds_read_b64_tr_b16 v[140:141], v1 offset:32
    v_mfma_f32_16x16x32_bf16 v[44:47], v[200:203], v[208:211], v[44:47]
    ds_read_b64_tr_b16 v[142:143], v1 offset:464
    v_mfma_f32_16x16x32_bf16 v[48:51], v[204:207], v[208:211], v[48:51]
    ds_read_b64_tr_b16 v[144:145], v1 offset:144
    s_waitcnt lgkmcnt(7)
    v_mfma_f32_16x16x32_bf16 v[76:79], v[204:207], v[212:215], v[76:79]
    ds_read_b64_tr_b16 v[146:147], v1 offset:576
    v_mfma_f32_16x16x32_bf16 v[72:75], v[200:203], v[212:215], v[72:75]
    ds_read_b64_tr_b16 v[148:149], v1 offset:176
    v_mfma_f32_16x16x32_bf16 v[68:71], v[196:199], v[212:215], v[68:71]
    ds_read_b64_tr_b16 v[150:151], v1 offset:608
    v_mfma_f32_16x16x32_bf16 v[64:67], v[192:195], v[212:215], v[64:67]
    ds_read_b64_tr_b16 v[152:153], v2 offset:0
    v_mfma_f32_16x16x32_bf16 v[60:63], v[188:191], v[212:215], v[60:63]
    ds_read_b64_tr_b16 v[154:155], v2 offset:432
    v_mfma_f32_16x16x32_bf16 v[56:59], v[184:187], v[212:215], v[56:59]
    ds_read_b64_tr_b16 v[156:157], v1 offset:288
    v_mfma_f32_16x16x32_bf16 v[52:55], v[180:183], v[212:215], v[52:55]
    ds_read_b64_tr_b16 v[158:159], v1 offset:720
    v_mfma_f32_16x16x32_bf16 v[80:83], v[180:183], v[216:219], v[80:83]
    ds_read_b64_tr_b16 v[160:161], v1 offset:320
    v_mfma_f32_16x16x32_bf16 v[84:87], v[184:187], v[216:219], v[84:87]
    ds_read_b64_tr_b16 v[162:163], v1 offset:752
    v_mfma_f32_16x16x32_bf16 v[88:91], v[188:191], v[216:219], v[88:91]
    ds_read_b64_tr_b16 v[168:169], v3 offset:1024
    v_mfma_f32_16x16x32_bf16 v[92:95], v[192:195], v[216:219], v[92:95]
    ds_read_b64_tr_b16 v[170:171], v4 offset:1024
    v_mfma_f32_16x16x32_bf16 v[96:99], v[196:199], v[216:219], v[96:99]
    ds_read_b64_tr_b16 v[172:173], v3 offset:2048
    v_mfma_f32_16x16x32_bf16 v[100:103], v[200:203], v[216:219], v[100:103]
    ds_read_b64_tr_b16 v[174:175], v4 offset:2048
    v_mfma_f32_16x16x32_bf16 v[104:107], v[204:207], v[216:219], v[104:107]
    ds_read_b64_tr_b16 v[176:177], v3 offset:3072
    v_mfma_f32_16x16x32_bf16 v[132:135], v[204:207], v[220:223], v[132:135]
    ds_read_b64_tr_b16 v[178:179], v4 offset:3072
    v_mfma_f32_16x16x32_bf16 v[128:131], v[200:203], v[220:223], v[128:131]
    v_add_u32 v1, 30720, v224
    v_mfma_f32_16x16x32_bf16 v[124:127], v[196:199], v[220:223], v[124:127]
    v_add_u32 v2, 30720, v225
    v_mfma_f32_16x16x32_bf16 v[120:123], v[192:195], v[220:223], v[120:123]
    v_add_u32 v3, 30720, v226
    v_mfma_f32_16x16x32_bf16 v[116:119], v[188:191], v[220:223], v[116:119]
    v_add_u32 v4, 30720, v227
    v_mfma_f32_16x16x32_bf16 v[112:115], v[184:187], v[220:223], v[112:115]
    v_mfma_f32_16x16x32_bf16 v[108:111], v[180:183], v[220:223], v[108:111]
    s_waitcnt vmcnt(0) lgkmcnt(6)
    s_barrier
    v_mfma_f32_16x16x32_bf16 v[24:27], v[136:139], v[164:167], v[24:27]
    ds_read_b64_tr_b16 v[208:209], v3 offset:0
    v_mfma_f32_16x16x32_bf16 v[28:31], v[140:143], v[164:167], v[28:31]
    ds_read_b64_tr_b16 v[210:211], v4 offset:0
    v_mfma_f32_16x16x32_bf16 v[32:35], v[144:147], v[164:167], v[32:35]
    ds_read_b64_tr_b16 v[180:181], v1 offset:0
    v_mfma_f32_16x16x32_bf16 v[36:39], v[148:151], v[164:167], v[36:39]
    ds_read_b64_tr_b16 v[182:183], v1 offset:432
    v_mfma_f32_16x16x32_bf16 v[40:43], v[152:155], v[164:167], v[40:43]
    ds_read_b64_tr_b16 v[184:185], v1 offset:32
    v_mfma_f32_16x16x32_bf16 v[44:47], v[156:159], v[164:167], v[44:47]
    ds_read_b64_tr_b16 v[186:187], v1 offset:464
    v_mfma_f32_16x16x32_bf16 v[48:51], v[160:163], v[164:167], v[48:51]
    ds_read_b64_tr_b16 v[188:189], v1 offset:144
    s_waitcnt lgkmcnt(7)
    v_mfma_f32_16x16x32_bf16 v[76:79], v[160:163], v[168:171], v[76:79]
    ds_read_b64_tr_b16 v[190:191], v1 offset:576
    v_mfma_f32_16x16x32_bf16 v[72:75], v[156:159], v[168:171], v[72:75]
    ds_read_b64_tr_b16 v[192:193], v1 offset:176
    v_mfma_f32_16x16x32_bf16 v[68:71], v[152:155], v[168:171], v[68:71]
    ds_read_b64_tr_b16 v[194:195], v1 offset:608
    v_mfma_f32_16x16x32_bf16 v[64:67], v[148:151], v[168:171], v[64:67]
    ds_read_b64_tr_b16 v[196:197], v2 offset:0
    v_mfma_f32_16x16x32_bf16 v[60:63], v[144:147], v[168:171], v[60:63]
    ds_read_b64_tr_b16 v[198:199], v2 offset:432
    v_mfma_f32_16x16x32_bf16 v[56:59], v[140:143], v[168:171], v[56:59]
    ds_read_b64_tr_b16 v[200:201], v1 offset:288
    v_mfma_f32_16x16x32_bf16 v[52:55], v[136:139], v[168:171], v[52:55]
    ds_read_b64_tr_b16 v[202:203], v1 offset:720
    v_mfma_f32_16x16x32_bf16 v[80:83], v[136:139], v[172:175], v[80:83]
    ds_read_b64_tr_b16 v[204:205], v1 offset:320
    v_mfma_f32_16x16x32_bf16 v[84:87], v[140:143], v[172:175], v[84:87]
    ds_read_b64_tr_b16 v[206:207], v1 offset:752
    v_mfma_f32_16x16x32_bf16 v[88:91], v[144:147], v[172:175], v[88:91]
    ds_read_b64_tr_b16 v[212:213], v3 offset:1024
    v_mfma_f32_16x16x32_bf16 v[92:95], v[148:151], v[172:175], v[92:95]
    ds_read_b64_tr_b16 v[214:215], v4 offset:1024
    v_mfma_f32_16x16x32_bf16 v[96:99], v[152:155], v[172:175], v[96:99]
    ds_read_b64_tr_b16 v[216:217], v3 offset:2048
    v_mfma_f32_16x16x32_bf16 v[100:103], v[156:159], v[172:175], v[100:103]
    ds_read_b64_tr_b16 v[218:219], v4 offset:2048
    v_mfma_f32_16x16x32_bf16 v[104:107], v[160:163], v[172:175], v[104:107]
    ds_read_b64_tr_b16 v[220:221], v3 offset:3072
    v_mfma_f32_16x16x32_bf16 v[132:135], v[160:163], v[176:179], v[132:135]
    ds_read_b64_tr_b16 v[222:223], v4 offset:3072
    v_mfma_f32_16x16x32_bf16 v[128:131], v[156:159], v[176:179], v[128:131]
    v_mfma_f32_16x16x32_bf16 v[124:127], v[152:155], v[176:179], v[124:127]
    v_mfma_f32_16x16x32_bf16 v[120:123], v[148:151], v[176:179], v[120:123]
    v_mfma_f32_16x16x32_bf16 v[116:119], v[144:147], v[176:179], v[116:119]
    v_mfma_f32_16x16x32_bf16 v[112:115], v[140:143], v[176:179], v[112:115]
    v_mfma_f32_16x16x32_bf16 v[108:111], v[136:139], v[176:179], v[108:111]
L_att_z:
    s_waitcnt lgkmcnt(0)
    s_barrier
    s_cmp_lg_u32 s98, 1
    s_cbranch_scc1 on_45
    s_add_u32 s43, s63, 384
    s_mul_i32 s3, s43, 683
    s_lshr_b32 s3, s3, 16
    s_lshl_b32 s48, s3, 2
    s_lshr_b64 s[48:49], s[100:101], s48
    s_and_b32 s48, s48, 15
    s_sub_i32 s3, s48, s3
    s_mul_i32 s3, s3, 96
    s_add_i32 s3, s3, s43
    s_lshl_b32 s3, s3, 12
    s_add_u32 s3, s3, s42
    buffer_load_dword v255, v251, s[32:35], s3 offen
on_45:
    s_mov_b32 vcc_lo, 0
    s_mov_b32 vcc_hi, 0xffff0000
    v_mov_b32 v3, 0x3f803f80
    v_mfma_f32_16x16x32_bf16 v[24:27], v[180:183], v[208:211], v[24:27]
    v_mfma_f32_16x16x32_bf16 v[28:31], v[184:187], v[208:211], v[28:31]
    v_mfma_f32_16x16x32_bf16 v[32:35], v[188:191], v[208:211], v[32:35]
    v_mfma_f32_16x16x32_bf16 v[36:39], v[192:195], v[208:211], v[36:39]
    v_mfma_f32_16x16x32_bf16 v[40:43], v[196:199], v[208:211], v[40:43]
    v_mfma_f32_16x16x32_bf16 v[44:47], v[200:203], v[208:211], v[44:47]
    v_mfma_f32_16x16x32_bf16 v[48:51], v[204:207], v[208:211], v[48:51]
    v_mfma_f32_16x16x32_bf16 v[76:79], v[204:207], v[212:215], v[76:79]
    v_mfma_f32_16x16x32_bf16 v[72:75], v[200:203], v[212:215], v[72:75]
    v_mfma_f32_16x16x32_bf16 v[68:71], v[196:199], v[212:215], v[68:71]
    v_mfma_f32_16x16x32_bf16 v[64:67], v[192:195], v[212:215], v[64:67]
    v_mfma_f32_16x16x32_bf16 v[60:63], v[188:191], v[212:215], v[60:63]
    v_mfma_f32_16x16x32_bf16 v[56:59], v[184:187], v[212:215], v[56:59]
    v_mfma_f32_16x16x32_bf16 v[52:55], v[180:183], v[212:215], v[52:55]
    v_mfma_f32_16x16x32_bf16 v[80:83], v[180:183], v[216:219], v[80:83]
    v_mfma_f32_16x16x32_bf16 v[84:87], v[184:187], v[216:219], v[84:87]
    v_cvt_pk_bf16_f32 v152, v32, v33
    v_cvt_pk_bf16_f32 v153, v34, v35
    v_mfma_f32_16x16x32_bf16 v[88:91], v[188:191], v[216:219], v[88:91]
    v_cvt_pk_bf16_f32 v154, v36, v37
    v_cvt_pk_bf16_f32 v155, v38, v39
    v_mfma_f32_16x16x32_bf16 v[92:95], v[192:195], v[216:219], v[92:95]
    v_cvt_pk_bf16_f32 v168, v40, v41
    v_cvt_pk_bf16_f32 v169, v42, v43
    v_mfma_f32_16x16x32_bf16 v[96:99], v[196:199], v[216:219], v[96:99]
    v_cvt_pk_bf16_f32 v136, v24, v25
    v_cvt_pk_bf16_f32 v137, v26, v27
    v_mfma_f32_16x16x32_bf16 v[100:103], v[200:203], v[216:219], v[100:103]
    v_cvt_pk_bf16_f32 v138, v28, v29
    v_cvt_pk_bf16_f32 v139, v30, v31
    v_mfma_f32_16x16x32_bf16 v[104:107], v[204:207], v[216:219], v[104:107]
    v_pk_mul_f32 v[40:41], v[40:41], v[16:17] op_sel_hi:[1,0]
    v_pk_mul_f32 v[42:43], v[42:43], v[16:17] op_sel_hi:[1,0]
    v_mfma_f32_16x16x32_bf16 v[132:135], v[204:207], v[220:223], v[132:135]
    v_pk_mul_f32 v[44:45], v[44:45], v[16:17] op_sel_hi:[1,0]
    v_pk_mul_f32 v[46:47], v[46:47], v[16:17] op_sel_hi:[1,0]
    v_mfma_f32_16x16x32_bf16 v[128:131], v[200:203], v[220:223], v[128:131]
    v_pk_mul_f32 v[48:49], v[48:49], v[16:17] op_sel_hi:[1,0]
    v_pk_mul_f32 v[50:51], v[50:51], v[16:17] op_sel_hi:[1,0]
    v_mfma_f32_16x16x32_bf16 v[124:127], v[196:199], v[220:223], v[124:127]
    v_cvt_pk_bf16_f32 v4, v40, v41
    v_cvt_pk_bf16_f32 v5, v42, v43
    v_mfma_f32_16x16x32_bf16 v[120:123], v[192:195], v[220:223], v[120:123]
    v_cvt_pk_bf16_f32 v6, v44, v45
    v_cvt_pk_bf16_f32 v7, v46, v47
    v_mfma_f32_16x16x32_bf16 v[116:119], v[188:191], v[220:223], v[116:119]
    v_cvt_pk_bf16_f32 v8, v48, v49
    v_cvt_pk_bf16_f32 v9, v50, v51
    v_mfma_f32_16x16x32_bf16 v[112:115], v[184:187], v[220:223], v[112:115]
    v_cndmask_b32 v4, v4, v3, vcc
    v_cndmask_b32 v5, v5, v3, vcc
    v_mfma_f32_16x16x32_bf16 v[108:111], v[180:183], v[220:223], v[108:111]
    ds_write_b64 v232, v[6:7] offset:0
    ds_write_b64 v232, v[8:9] offset:32
    s_mov_b32 exec_lo, 0
    ds_write_b64 v233, v[4:5] offset:0
    s_mov_b32 exec_lo, -1
    v_xor_b32 v1, 128, v250
    v_xor_b32 v2, 256, v250
    ds_read_b128 v[180:183], v250 offset:0
    ds_read_b128 v[184:187], v250 offset:1024
    ds_read_b128 v[188:191], v250 offset:2048
    ds_read_b128 v[192:195], v250 offset:3072
    ds_read_b128 v[196:199], v250 offset:4096
    ds_read_b128 v[200:203], v1 offset:0
    ds_read_b128 v[204:207], v1 offset:1024
    ds_read_b128 v[208:211], v1 offset:2048
    ds_read_b128 v[212:215], v1 offset:3072
    ds_read_b128 v[216:219], v1 offset:4096
    ds_read_b128 v[24:27], v250 offset:5120
    ds_read_b128 v[28:31], v250 offset:6144
    ds_read_b128 v[32:35], v250 offset:7168
    ds_read_b128 v[36:39], v250 offset:8192
    ds_read_b128 v[40:43], v250 offset:9216
    v_cvt_pk_bf16_f32 v156, v60, v61
    v_cvt_pk_bf16_f32 v157, v62, v63
    v_cvt_pk_bf16_f32 v158, v64, v65
    v_cvt_pk_bf16_f32 v159, v66, v67
    v_cvt_pk_bf16_f32 v170, v68, v69
    v_cvt_pk_bf16_f32 v171, v70, v71
    v_cvt_pk_bf16_f32 v140, v52, v53
    v_cvt_pk_bf16_f32 v141, v54, v55
    v_cvt_pk_bf16_f32 v142, v56, v57
    v_cvt_pk_bf16_f32 v143, v58, v59
    v_pk_mul_f32 v[68:69], v[68:69], v[18:19] op_sel_hi:[1,0]
    v_pk_mul_f32 v[70:71], v[70:71], v[18:19] op_sel_hi:[1,0]
    v_pk_mul_f32 v[72:73], v[72:73], v[18:19] op_sel_hi:[1,0]
    v_pk_mul_f32 v[74:75], v[74:75], v[18:19] op_sel_hi:[1,0]
    v_pk_mul_f32 v[76:77], v[76:77], v[18:19] op_sel_hi:[1,0]
    v_pk_mul_f32 v[78:79], v[78:79], v[18:19] op_sel_hi:[1,0]
    v_cvt_pk_bf16_f32 v10, v68, v69
    v_cvt_pk_bf16_f32 v11, v70, v71
    v_cvt_pk_bf16_f32 v12, v72, v73
    v_cvt_pk_bf16_f32 v13, v74, v75
    v_cvt_pk_bf16_f32 v14, v76, v77
    v_cvt_pk_bf16_f32 v15, v78, v79
    v_cndmask_b32 v10, v10, v3, vcc
    v_cndmask_b32 v11, v11, v3, vcc
    ds_write_b64 v232, v[12:13] offset:7552
    ds_write_b64 v232, v[14:15] offset:7584
    s_mov_b32 exec_lo, 0
    ds_write_b64 v233, v[10:11] offset:7552
    s_mov_b32 exec_lo, -1
    s_waitcnt lgkmcnt(3)
    v_cvt_pk_bf16_f32 v160, v88, v89
    v_mfma_f32_16x16x32_bf16 v[44:47], v[180:183], v[152:155], 0
    v_cvt_pk_bf16_f32 v161, v90, v91
    v_cvt_pk_bf16_f32 v162, v92, v93
    v_cvt_pk_bf16_f32 v163, v94, v95
    v_mfma_f32_16x16x32_bf16 v[48:51], v[184:187], v[152:155], 0
    v_cvt_pk_bf16_f32 v172, v96, v97
    v_cvt_pk_bf16_f32 v173, v98, v99
    v_cvt_pk_bf16_f32 v144, v80, v81
    v_mfma_f32_16x16x32_bf16 v[52:55], v[188:191], v[152:155], 0
    v_cvt_pk_bf16_f32 v145, v82, v83
    v_cvt_pk_bf16_f32 v146, v84, v85
    v_cvt_pk_bf16_f32 v147, v86, v87
    v_mfma_f32_16x16x32_bf16 v[56:59], v[192:195], v[152:155], 0
    v_pk_mul_f32 v[96:97], v[96:97], v[20:21] op_sel_hi:[1,0]
    v_pk_mul_f32 v[98:99], v[98:99], v[20:21] op_sel_hi:[1,0]
    v_pk_mul_f32 v[100:101], v[100:101], v[20:21] op_sel_hi:[1,0]
    v_mfma_f32_16x16x32_bf16 v[60:63], v[196:199], v[152:155], 0
    v_pk_mul_f32 v[102:103], v[102:103], v[20:21] op_sel_hi:[1,0]
    v_pk_mul_f32 v[104:105], v[104:105], v[20:21] op_sel_hi:[1,0]
    v_pk_mul_f32 v[106:107], v[106:107], v[20:21] op_sel_hi:[1,0]
    v_mfma_f32_16x16x32_bf16 v[44:47], v[200:203], v[156:159], v[44:47]
    v_cvt_pk_bf16_f32 v4, v96, v97
    v_cvt_pk_bf16_f32 v5, v98, v99
    v_cvt_pk_bf16_f32 v6, v100, v101
    v_mfma_f32_16x16x32_bf16 v[48:51], v[204:207], v[156:159], v[48:51]
    v_cvt_pk_bf16_f32 v7, v102, v103
    v_cvt_pk_bf16_f32 v8, v104, v105
    v_cvt_pk_bf16_f32 v9, v106, v107
    v_mfma_f32_16x16x32_bf16 v[52:55], v[208:211], v[156:159], v[52:55]
    v_cndmask_b32 v4, v4, v3, vcc
    v_cndmask_b32 v5, v5, v3, vcc
    ds_write_b64 v232, v[6:7] offset:15104
    v_mfma_f32_16x16x32_bf16 v[56:59], v[212:215], v[156:159], v[56:59]
    ds_write_b64 v232, v[8:9] offset:15136
    s_mov_b32 exec_lo, 0
    ds_write_b64 v233, v[4:5] offset:15104
    s_mov_b32 exec_lo, -1
    v_cvt_pk_bf16_f32 v164, v116, v117
    v_mfma_f32_16x16x32_bf16 v[60:63], v[216:219], v[156:159], v[60:63]
    v_cvt_pk_bf16_f32 v165, v118, v119
    v_cvt_pk_bf16_f32 v166, v120, v121
    v_cvt_pk_bf16_f32 v167, v122, v123
    v_mfma_f32_16x16x32_bf16 v[44:47], v[24:27], v[168:171], v[44:47]
    v_cvt_pk_bf16_f32 v174, v124, v125
    v_cvt_pk_bf16_f32 v175, v126, v127
    v_cvt_pk_bf16_f32 v148, v108, v109
    v_mfma_f32_16x16x32_bf16 v[48:51], v[28:31], v[168:171], v[48:51]
    v_cvt_pk_bf16_f32 v149, v110, v111
    v_cvt_pk_bf16_f32 v150, v112, v113
    v_cvt_pk_bf16_f32 v151, v114, v115
    v_mfma_f32_16x16x32_bf16 v[52:55], v[32:35], v[168:171], v[52:55]
    v_pk_mul_f32 v[124:125], v[124:125], v[22:23] op_sel_hi:[1,0]
    v_pk_mul_f32 v[126:127], v[126:127], v[22:23] op_sel_hi:[1,0]
    v_pk_mul_f32 v[128:129], v[128:129], v[22:23] op_sel_hi:[1,0]
    v_mfma_f32_16x16x32_bf16 v[56:59], v[36:39], v[168:171], v[56:59]
    v_pk_mul_f32 v[130:131], v[130:131], v[22:23] op_sel_hi:[1,0]
    v_pk_mul_f32 v[132:133], v[132:133], v[22:23] op_sel_hi:[1,0]
    v_pk_mul_f32 v[134:135], v[134:135], v[22:23] op_sel_hi:[1,0]
    v_mfma_f32_16x16x32_bf16 v[60:63], v[40:43], v[168:171], v[60:63]
    v_cvt_pk_bf16_f32 v10, v124, v125
    v_cvt_pk_bf16_f32 v11, v126, v127
    v_cvt_pk_bf16_f32 v12, v128, v129
    v_cvt_pk_bf16_f32 v13, v130, v131
    v_cvt_pk_bf16_f32 v14, v132, v133
    v_cvt_pk_bf16_f32 v15, v134, v135
    v_cndmask_b32 v10, v10, v3, vcc
    v_cndmask_b32 v11, v11, v3, vcc
    ds_write_b64 v232, v[12:13] offset:22656
    ds_write_b64 v232, v[14:15] offset:22688
    s_mov_b32 exec_lo, 0
    ds_write_b64 v233, v[10:11] offset:22656
    s_mov_b32 exec_lo, -1
    s_mov_b32 vcc_lo, -1
    s_mov_b32 vcc_hi, 0
    s_mov_b32 s3, 0x3fb8aa3b
    v_cndmask_b32 v120, v18, v16, vcc
    v_cndmask_b32 v122, v22, v20, vcc
    v_mul_f32 v120, s3, v120
    v_mul_f32 v122, s3, v122
    s_cmp_lg_u32 s98, 1
    s_cbranch_scc1 on_46
    s_add_u32 s43, s63, 512
    s_mul_i32 s3, s43, 683
    s_lshr_b32 s3, s3, 16
    s_lshl_b32 s48, s3, 2
    s_lshr_b64 s[48:49], s[100:101], s48
    s_and_b32 s48, s48, 15
    s_sub_i32 s3, s48, s3
    s_mul_i32 s3, s3, 96
    s_add_i32 s3, s3, s43
    s_lshl_b32 s3, s3, 12
    s_add_u32 s3, s3, s42
    buffer_load_dword v255, v251, s[32:35], s3 offen
    s_barrier
on_46:
.p2align 3
    v_max_f32 v4, v44, v45
    v_min_f32 v6, v44, v45
    v_max3_f32 v4, v4, v46, v47
    v_min3_f32 v6, v6, v46, v47
    v_max3_f32 v4, v4, v48, v49
    v_min3_f32 v6, v6, v48, v49
    v_max3_f32 v4, v4, v50, v51
    v_min3_f32 v6, v6, v50, v51
    v_max3_f32 v4, v4, v52, v53
    v_min3_f32 v6, v6, v52, v53
    v_max3_f32 v4, v4, v54, v55
    v_min3_f32 v6, v6, v54, v55
    v_max3_f32 v4, v4, v56, v57
    v_min3_f32 v6, v6, v56, v57
    v_max3_f32 v4, v4, v58, v59
    v_min3_f32 v6, v6, v58, v59
    v_max3_f32 v4, v4, v60, v61
    v_min3_f32 v6, v6, v60, v61
    v_mul_f32 v4, v120, v4
    v_mul_f32 v6, v120, v6
    v_pk_fma_f32 v[84:85], v[44:45], v[120:121], v[4:5] op_sel_hi:[1,0,0] neg_lo:[0,0,1] neg_hi:[0,0,1]
    v_pk_fma_f32 v[86:87], v[46:47], v[120:121], v[4:5] op_sel_hi:[1,0,0] neg_lo:[0,0,1] neg_hi:[0,0,1]
    v_pk_fma_f32 v[88:89], v[48:49], v[120:121], v[4:5] op_sel_hi:[1,0,0] neg_lo:[0,0,1] neg_hi:[0,0,1]
    v_pk_fma_f32 v[90:91], v[50:51], v[120:121], v[4:5] op_sel_hi:[1,0,0] neg_lo:[0,0,1] neg_hi:[0,0,1]
    v_pk_fma_f32 v[92:93], v[52:53], v[120:121], v[4:5] op_sel_hi:[1,0,0] neg_lo:[0,0,1] neg_hi:[0,0,1]
    v_pk_fma_f32 v[94:95], v[54:55], v[120:121], v[4:5] op_sel_hi:[1,0,0] neg_lo:[0,0,1] neg_hi:[0,0,1]
    v_pk_fma_f32 v[96:97], v[56:57], v[120:121], v[4:5] op_sel_hi:[1,0,0] neg_lo:[0,0,1] neg_hi:[0,0,1]
    v_pk_fma_f32 v[98:99], v[58:59], v[120:121], v[4:5] op_sel_hi:[1,0,0] neg_lo:[0,0,1] neg_hi:[0,0,1]
    v_pk_fma_f32 v[100:101], v[60:61], v[120:121], v[4:5] op_sel_hi:[1,0,0] neg_lo:[0,0,1] neg_hi:[0,0,1]
    v_pk_fma_f32 v[102:103], v[44:45], v[120:121], v[6:7] op_sel_hi:[1,0,0] neg_lo:[1,0,0] neg_hi:[1,0,0]
    v_pk_fma_f32 v[104:105], v[46:47], v[120:121], v[6:7] op_sel_hi:[1,0,0] neg_lo:[1,0,0] neg_hi:[1,0,0]
    v_pk_fma_f32 v[106:107], v[48:49], v[120:121], v[6:7] op_sel_hi:[1,0,0] neg_lo:[1,0,0] neg_hi:[1,0,0]
    v_pk_fma_f32 v[108:109], v[50:51], v[120:121], v[6:7] op_sel_hi:[1,0,0] neg_lo:[1,0,0] neg_hi:[1,0,0]
    v_pk_fma_f32 v[110:111], v[52:53], v[120:121], v[6:7] op_sel_hi:[1,0,0] neg_lo:[1,0,0] neg_hi:[1,0,0]
    v_pk_fma_f32 v[112:113], v[54:55], v[120:121], v[6:7] op_sel_hi:[1,0,0] neg_lo:[1,0,0] neg_hi:[1,0,0]
    v_pk_fma_f32 v[114:115], v[56:57], v[120:121], v[6:7] op_sel_hi:[1,0,0] neg_lo:[1,0,0] neg_hi:[1,0,0]
    v_pk_fma_f32 v[116:117], v[58:59], v[120:121], v[6:7] op_sel_hi:[1,0,0] neg_lo:[1,0,0] neg_hi:[1,0,0]
    v_pk_fma_f32 v[118:119], v[60:61], v[120:121], v[6:7] op_sel_hi:[1,0,0] neg_lo:[1,0,0] neg_hi:[1,0,0]
    v_exp_f32 v84, v84
    v_mfma_f32_16x16x32_bf16 v[64:67], v[180:183], v[160:163], 0
    v_exp_f32 v85, v85
    v_exp_f32 v86, v86
    v_mfma_f32_16x16x32_bf16 v[68:71], v[184:187], v[160:163], 0
    v_exp_f32 v87, v87
    v_exp_f32 v88, v88
    v_mfma_f32_16x16x32_bf16 v[72:75], v[188:191], v[160:163], 0
    v_exp_f32 v89, v89
    v_exp_f32 v90, v90
    v_mfma_f32_16x16x32_bf16 v[76:79], v[192:195], v[160:163], 0
    v_exp_f32 v91, v91
    v_exp_f32 v92, v92
    v_mfma_f32_16x16x32_bf16 v[80:83], v[196:199], v[160:163], 0
    v_exp_f32 v93, v93
    v_exp_f32 v94, v94
    v_mfma_f32_16x16x32_bf16 v[64:67], v[200:203], v[164:167], v[64:67]
    v_exp_f32 v95, v95
    v_exp_f32 v96, v96
    v_mfma_f32_16x16x32_bf16 v[68:71], v[204:207], v[164:167], v[68:71]
    v_exp_f32 v97, v97
    v_exp_f32 v98, v98
    v_mfma_f32_16x16x32_bf16 v[72:75], v[208:211], v[164:167], v[72:75]
    v_exp_f32 v99, v99
    v_exp_f32 v100, v100
    v_mfma_f32_16x16x32_bf16 v[76:79], v[212:215], v[164:167], v[76:79]
    v_exp_f32 v101, v101
    v_exp_f32 v102, v102
    v_mfma_f32_16x16x32_bf16 v[80:83], v[216:219], v[164:167], v[80:83]
    v_exp_f32 v103, v103
    v_exp_f32 v104, v104
    v_mfma_f32_16x16x32_bf16 v[64:67], v[24:27], v[172:175], v[64:67]
    v_exp_f32 v105, v105
    v_exp_f32 v106, v106
    v_mfma_f32_16x16x32_bf16 v[68:71], v[28:31], v[172:175], v[68:71]
    v_exp_f32 v107, v107
    v_exp_f32 v108, v108
    v_mfma_f32_16x16x32_bf16 v[72:75], v[32:35], v[172:175], v[72:75]
    v_exp_f32 v109, v109
    v_exp_f32 v110, v110
    v_mfma_f32_16x16x32_bf16 v[76:79], v[36:39], v[172:175], v[76:79]
    v_exp_f32 v111, v111
    v_exp_f32 v112, v112
    v_mfma_f32_16x16x32_bf16 v[80:83], v[40:43], v[172:175], v[80:83]
    v_exp_f32 v113, v113
    v_exp_f32 v114, v114
    v_exp_f32 v115, v115
    v_exp_f32 v116, v116
    v_exp_f32 v117, v117
    v_exp_f32 v118, v118
    v_exp_f32 v119, v119
    v_pk_add_f32 v[4:5], v[84:85], v[86:87]
    v_pk_add_f32 v[6:7], v[102:103], v[104:105]
    v_pk_add_f32 v[4:5], v[4:5], v[88:89]
    v_pk_add_f32 v[6:7], v[6:7], v[106:107]
    v_pk_add_f32 v[4:5], v[4:5], v[90:91]
    v_pk_add_f32 v[6:7], v[6:7], v[108:109]
    v_pk_add_f32 v[4:5], v[4:5], v[92:93]
    v_pk_add_f32 v[6:7], v[6:7], v[110:111]
    v_pk_add_f32 v[4:5], v[4:5], v[94:95]
    v_pk_add_f32 v[6:7], v[6:7], v[112:113]
    v_pk_add_f32 v[4:5], v[4:5], v[96:97]
    v_pk_add_f32 v[6:7], v[6:7], v[114:115]
    v_pk_add_f32 v[4:5], v[4:5], v[98:99]
    v_pk_add_f32 v[6:7], v[6:7], v[116:117]
    v_pk_add_f32 v[4:5], v[4:5], v[100:101]
    v_pk_add_f32 v[6:7], v[6:7], v[118:119]
    v_add_f32 v4, v4, v5
    v_add_f32 v6, v6, v7
    v_rcp_f32 v4, v4
    v_rcp_f32 v6, v6
    v_pk_mul_f32 v[84:85], v[84:85], v[4:5] op_sel_hi:[1,0]
    v_pk_mul_f32 v[86:87], v[86:87], v[4:5] op_sel_hi:[1,0]
    v_pk_mul_f32 v[88:89], v[88:89], v[4:5] op_sel_hi:[1,0]
    v_pk_mul_f32 v[90:91], v[90:91], v[4:5] op_sel_hi:[1,0]
    v_pk_mul_f32 v[92:93], v[92:93], v[4:5] op_sel_hi:[1,0]
    v_pk_mul_f32 v[94:95], v[94:95], v[4:5] op_sel_hi:[1,0]
    v_pk_mul_f32 v[96:97], v[96:97], v[4:5] op_sel_hi:[1,0]
    v_pk_mul_f32 v[98:99], v[98:99], v[4:5] op_sel_hi:[1,0]
    v_pk_mul_f32 v[100:101], v[100:101], v[4:5] op_sel_hi:[1,0]
    v_pk_mul_f32 v[102:103], v[102:103], v[6:7] op_sel_hi:[1,0]
    v_pk_mul_f32 v[104:105], v[104:105], v[6:7] op_sel_hi:[1,0]
    v_pk_mul_f32 v[106:107], v[106:107], v[6:7] op_sel_hi:[1,0]
    v_pk_mul_f32 v[108:109], v[108:109], v[6:7] op_sel_hi:[1,0]
    v_pk_mul_f32 v[110:111], v[110:111], v[6:7] op_sel_hi:[1,0]
    v_pk_mul_f32 v[112:113], v[112:113], v[6:7] op_sel_hi:[1,0]
    v_pk_mul_f32 v[114:115], v[114:115], v[6:7] op_sel_hi:[1,0]
    v_pk_mul_f32 v[116:117], v[116:117], v[6:7] op_sel_hi:[1,0]
    v_pk_mul_f32 v[118:119], v[118:119], v[6:7] op_sel_hi:[1,0]
    v_cvt_pk_bf16_f32 v124, v84, v85
    v_cvt_pk_bf16_f32 v125, v86, v87
    v_cvt_pk_bf16_f32 v126, v88, v89
    v_cvt_pk_bf16_f32 v127, v90, v91
    v_cvt_pk_bf16_f32 v128, v92, v93
    v_cvt_pk_bf16_f32 v129, v94, v95
    v_cvt_pk_bf16_f32 v130, v96, v97
    v_cvt_pk_bf16_f32 v131, v98, v99
    v_cvt_pk_bf16_f32 v132, v100, v101
    v_cvt_pk_bf16_f32 v14, v102, v103
    v_cvt_pk_bf16_f32 v15, v104, v105
    v_cvt_pk_bf16_f32 v16, v106, v107
    v_cvt_pk_bf16_f32 v17, v108, v109
    v_cvt_pk_bf16_f32 v18, v110, v111
    v_cvt_pk_bf16_f32 v19, v112, v113
    v_cvt_pk_bf16_f32 v20, v114, v115
    v_cvt_pk_bf16_f32 v21, v116, v117
    v_cvt_pk_bf16_f32 v22, v118, v119
    ds_read_b128 v[24:27], v2 offset:5120
    ds_read_b128 v[28:31], v2 offset:6144
    ds_read_b128 v[32:35], v2 offset:7168
    ds_read_b128 v[36:39], v2 offset:8192
    ds_read_b128 v[40:43], v2 offset:9216
    ds_write_b64 v234, v[124:125] offset:0
    ds_write_b64 v234, v[126:127] offset:8
    ds_write_b64 v234, v[128:129] offset:16
    ds_write_b64 v234, v[130:131] offset:24
    ds_write_b32 v234, v132 offset:32
    ds_write_b64 v234, v[14:15] offset:40
    ds_write_b64 v234, v[16:17] offset:48
    ds_write_b64 v234, v[18:19] offset:56
    ds_write_b64 v234, v[20:21] offset:64
    ds_write_b32 v234, v22 offset:72
    s_lshl_b32 s43, s98, 7
    s_add_u32 s43, s43, s63
    s_add_u32 s43, s43, 640
    s_mul_i32 s3, s43, 683
    s_lshr_b32 s3, s3, 16
    s_lshl_b32 s48, s3, 2
    s_lshr_b64 s[48:49], s[100:101], s48
    s_and_b32 s48, s48, 15
    s_sub_i32 s3, s48, s3
    s_mul_i32 s3, s3, 96
    s_add_i32 s3, s3, s43
    s_lshl_b32 s3, s3, 12
    s_add_u32 s3, s3, s42
    buffer_load_dword v255, v251, s[32:35], s3 offen
.p2align 3
    v_max_f32 v4, v64, v65
    v_min_f32 v6, v64, v65
    v_max3_f32 v4, v4, v66, v67
    v_min3_f32 v6, v6, v66, v67
    v_max3_f32 v4, v4, v68, v69
    v_min3_f32 v6, v6, v68, v69
    v_max3_f32 v4, v4, v70, v71
    v_min3_f32 v6, v6, v70, v71
    v_max3_f32 v4, v4, v72, v73
    v_min3_f32 v6, v6, v72, v73
    v_max3_f32 v4, v4, v74, v75
    v_min3_f32 v6, v6, v74, v75
    v_max3_f32 v4, v4, v76, v77
    v_min3_f32 v6, v6, v76, v77
    v_max3_f32 v4, v4, v78, v79
    v_min3_f32 v6, v6, v78, v79
    v_max3_f32 v4, v4, v80, v81
    v_min3_f32 v6, v6, v80, v81
    v_mul_f32 v4, v122, v4
    v_mul_f32 v6, v122, v6
    v_pk_fma_f32 v[84:85], v[64:65], v[122:123], v[4:5] op_sel_hi:[1,0,0] neg_lo:[0,0,1] neg_hi:[0,0,1]
    v_pk_fma_f32 v[86:87], v[66:67], v[122:123], v[4:5] op_sel_hi:[1,0,0] neg_lo:[0,0,1] neg_hi:[0,0,1]
    v_pk_fma_f32 v[88:89], v[68:69], v[122:123], v[4:5] op_sel_hi:[1,0,0] neg_lo:[0,0,1] neg_hi:[0,0,1]
    v_pk_fma_f32 v[90:91], v[70:71], v[122:123], v[4:5] op_sel_hi:[1,0,0] neg_lo:[0,0,1] neg_hi:[0,0,1]
    v_pk_fma_f32 v[92:93], v[72:73], v[122:123], v[4:5] op_sel_hi:[1,0,0] neg_lo:[0,0,1] neg_hi:[0,0,1]
    v_pk_fma_f32 v[94:95], v[74:75], v[122:123], v[4:5] op_sel_hi:[1,0,0] neg_lo:[0,0,1] neg_hi:[0,0,1]
    v_pk_fma_f32 v[96:97], v[76:77], v[122:123], v[4:5] op_sel_hi:[1,0,0] neg_lo:[0,0,1] neg_hi:[0,0,1]
    v_pk_fma_f32 v[98:99], v[78:79], v[122:123], v[4:5] op_sel_hi:[1,0,0] neg_lo:[0,0,1] neg_hi:[0,0,1]
    v_pk_fma_f32 v[100:101], v[80:81], v[122:123], v[4:5] op_sel_hi:[1,0,0] neg_lo:[0,0,1] neg_hi:[0,0,1]
    v_pk_fma_f32 v[102:103], v[64:65], v[122:123], v[6:7] op_sel_hi:[1,0,0] neg_lo:[1,0,0] neg_hi:[1,0,0]
    v_pk_fma_f32 v[104:105], v[66:67], v[122:123], v[6:7] op_sel_hi:[1,0,0] neg_lo:[1,0,0] neg_hi:[1,0,0]
    v_pk_fma_f32 v[106:107], v[68:69], v[122:123], v[6:7] op_sel_hi:[1,0,0] neg_lo:[1,0,0] neg_hi:[1,0,0]
    v_pk_fma_f32 v[108:109], v[70:71], v[122:123], v[6:7] op_sel_hi:[1,0,0] neg_lo:[1,0,0] neg_hi:[1,0,0]
    v_pk_fma_f32 v[110:111], v[72:73], v[122:123], v[6:7] op_sel_hi:[1,0,0] neg_lo:[1,0,0] neg_hi:[1,0,0]
    v_pk_fma_f32 v[112:113], v[74:75], v[122:123], v[6:7] op_sel_hi:[1,0,0] neg_lo:[1,0,0] neg_hi:[1,0,0]
    v_pk_fma_f32 v[114:115], v[76:77], v[122:123], v[6:7] op_sel_hi:[1,0,0] neg_lo:[1,0,0] neg_hi:[1,0,0]
    v_pk_fma_f32 v[116:117], v[78:79], v[122:123], v[6:7] op_sel_hi:[1,0,0] neg_lo:[1,0,0] neg_hi:[1,0,0]
    v_pk_fma_f32 v[118:119], v[80:81], v[122:123], v[6:7] op_sel_hi:[1,0,0] neg_lo:[1,0,0] neg_hi:[1,0,0]
    v_exp_f32 v84, v84
    s_waitcnt lgkmcnt(0)
    v_exp_f32 v85, v85
    v_exp_f32 v86, v86
    v_mfma_f32_16x16x32_bf16 v[44:47], v[180:183], v[136:139], 0
    v_exp_f32 v87, v87
    v_exp_f32 v88, v88
    v_mfma_f32_16x16x32_bf16 v[48:51], v[184:187], v[136:139], 0
    v_exp_f32 v89, v89
    v_exp_f32 v90, v90
    v_mfma_f32_16x16x32_bf16 v[52:55], v[188:191], v[136:139], 0
    v_exp_f32 v91, v91
    v_exp_f32 v92, v92
    v_mfma_f32_16x16x32_bf16 v[56:59], v[192:195], v[136:139], 0
    v_exp_f32 v93, v93
    v_exp_f32 v94, v94
    v_mfma_f32_16x16x32_bf16 v[60:63], v[196:199], v[136:139], 0
    v_exp_f32 v95, v95
    v_exp_f32 v96, v96
    v_mfma_f32_16x16x32_bf16 v[44:47], v[200:203], v[140:143], v[44:47]
    v_exp_f32 v97, v97
    v_exp_f32 v98, v98
    v_mfma_f32_16x16x32_bf16 v[48:51], v[204:207], v[140:143], v[48:51]
    v_exp_f32 v99, v99
    v_exp_f32 v100, v100
    v_mfma_f32_16x16x32_bf16 v[52:55], v[208:211], v[140:143], v[52:55]
    v_exp_f32 v101, v101
    v_exp_f32 v102, v102
    v_mfma_f32_16x16x32_bf16 v[56:59], v[212:215], v[140:143], v[56:59]
    v_exp_f32 v103, v103
    v_exp_f32 v104, v104
    v_mfma_f32_16x16x32_bf16 v[60:63], v[216:219], v[140:143], v[60:63]
    v_exp_f32 v105, v105
    v_exp_f32 v106, v106
    v_mfma_f32_16x16x32_bf16 v[44:47], v[24:27], v[168:171], v[44:47]
    v_exp_f32 v107, v107
    v_exp_f32 v108, v108
    v_mfma_f32_16x16x32_bf16 v[48:51], v[28:31], v[168:171], v[48:51]
    v_exp_f32 v109, v109
    v_exp_f32 v110, v110
    v_mfma_f32_16x16x32_bf16 v[52:55], v[32:35], v[168:171], v[52:55]
    v_exp_f32 v111, v111
    v_exp_f32 v112, v112
    v_mfma_f32_16x16x32_bf16 v[56:59], v[36:39], v[168:171], v[56:59]
    v_exp_f32 v113, v113
    v_exp_f32 v114, v114
    v_mfma_f32_16x16x32_bf16 v[60:63], v[40:43], v[168:171], v[60:63]
    v_exp_f32 v115, v115
    v_exp_f32 v116, v116
    v_exp_f32 v117, v117
    v_exp_f32 v118, v118
    v_exp_f32 v119, v119
    v_pk_add_f32 v[4:5], v[84:85], v[86:87]
    v_pk_add_f32 v[6:7], v[102:103], v[104:105]
    v_pk_add_f32 v[4:5], v[4:5], v[88:89]
    v_pk_add_f32 v[6:7], v[6:7], v[106:107]
    v_pk_add_f32 v[4:5], v[4:5], v[90:91]
    v_pk_add_f32 v[6:7], v[6:7], v[108:109]
    v_pk_add_f32 v[4:5], v[4:5], v[92:93]
    v_pk_add_f32 v[6:7], v[6:7], v[110:111]
    v_pk_add_f32 v[4:5], v[4:5], v[94:95]
    v_pk_add_f32 v[6:7], v[6:7], v[112:113]
    v_pk_add_f32 v[4:5], v[4:5], v[96:97]
    v_pk_add_f32 v[6:7], v[6:7], v[114:115]
    v_pk_add_f32 v[4:5], v[4:5], v[98:99]
    v_pk_add_f32 v[6:7], v[6:7], v[116:117]
    v_pk_add_f32 v[4:5], v[4:5], v[100:101]
    v_pk_add_f32 v[6:7], v[6:7], v[118:119]
    v_add_f32 v4, v4, v5
    v_add_f32 v6, v6, v7
    v_rcp_f32 v4, v4
    v_rcp_f32 v6, v6
    v_pk_mul_f32 v[84:85], v[84:85], v[4:5] op_sel_hi:[1,0]
    v_pk_mul_f32 v[86:87], v[86:87], v[4:5] op_sel_hi:[1,0]
    v_pk_mul_f32 v[88:89], v[88:89], v[4:5] op_sel_hi:[1,0]
    v_pk_mul_f32 v[90:91], v[90:91], v[4:5] op_sel_hi:[1,0]
    v_pk_mul_f32 v[92:93], v[92:93], v[4:5] op_sel_hi:[1,0]
    v_pk_mul_f32 v[94:95], v[94:95], v[4:5] op_sel_hi:[1,0]
    v_pk_mul_f32 v[96:97], v[96:97], v[4:5] op_sel_hi:[1,0]
    v_pk_mul_f32 v[98:99], v[98:99], v[4:5] op_sel_hi:[1,0]
    v_pk_mul_f32 v[100:101], v[100:101], v[4:5] op_sel_hi:[1,0]
    v_pk_mul_f32 v[102:103], v[102:103], v[6:7] op_sel_hi:[1,0]
    v_pk_mul_f32 v[104:105], v[104:105], v[6:7] op_sel_hi:[1,0]
    v_pk_mul_f32 v[106:107], v[106:107], v[6:7] op_sel_hi:[1,0]
    v_pk_mul_f32 v[108:109], v[108:109], v[6:7] op_sel_hi:[1,0]
    v_pk_mul_f32 v[110:111], v[110:111], v[6:7] op_sel_hi:[1,0]
    v_pk_mul_f32 v[112:113], v[112:113], v[6:7] op_sel_hi:[1,0]
    v_pk_mul_f32 v[114:115], v[114:115], v[6:7] op_sel_hi:[1,0]
    v_pk_mul_f32 v[116:117], v[116:117], v[6:7] op_sel_hi:[1,0]
    v_pk_mul_f32 v[118:119], v[118:119], v[6:7] op_sel_hi:[1,0]
    v_cvt_pk_bf16_f32 v124, v84, v85
    v_cvt_pk_bf16_f32 v125, v86, v87
    v_cvt_pk_bf16_f32 v126, v88, v89
    v_cvt_pk_bf16_f32 v127, v90, v91
    v_cvt_pk_bf16_f32 v128, v92, v93
    v_cvt_pk_bf16_f32 v129, v94, v95
    v_cvt_pk_bf16_f32 v130, v96, v97
    v_cvt_pk_bf16_f32 v131, v98, v99
    v_cvt_pk_bf16_f32 v132, v100, v101
    v_cvt_pk_bf16_f32 v14, v102, v103
    v_cvt_pk_bf16_f32 v15, v104, v105
    v_cvt_pk_bf16_f32 v16, v106, v107
    v_cvt_pk_bf16_f32 v17, v108, v109
    v_cvt_pk_bf16_f32 v18, v110, v111
    v_cvt_pk_bf16_f32 v19, v112, v113
    v_cvt_pk_bf16_f32 v20, v114, v115
    v_cvt_pk_bf16_f32 v21, v116, v117
    v_cvt_pk_bf16_f32 v22, v118, v119
    ds_write_b64 v234, v[124:125] offset:15104
    ds_write_b64 v234, v[126:127] offset:15112
    ds_write_b64 v234, v[128:129] offset:15120
    ds_write_b64 v234, v[130:131] offset:15128
    ds_write_b32 v234, v132 offset:15136
    ds_write_b64 v234, v[14:15] offset:15144
    ds_write_b64 v234, v[16:17] offset:15152
    ds_write_b64 v234, v[18:19] offset:15160
    ds_write_b64 v234, v[20:21] offset:15168
    ds_write_b32 v234, v22 offset:15176
    v_add_u32 v1, 60416, v235
    v_add_u32 v2, 60416, v236
    s_waitcnt lgkmcnt(0)
    s_barrier
    s_setprio 1
    ds_read_b64_tr_b16 v[76:77], v236 offset:0
    ds_read_b64_tr_b16 v[78:79], v236 offset:472
    ds_read_b64_tr_b16 v[64:65], v235 offset:0
    ds_read_b64_tr_b16 v[66:67], v235 offset:472
    ds_read_b64_tr_b16 v[68:69], v235 offset:32
    ds_read_b64_tr_b16 v[70:71], v235 offset:504
    ds_read_b64_tr_b16 v[72:73], v235 offset:64
    ds_read_b64_tr_b16 v[74:75], v235 offset:536
    ds_read_b64_tr_b16 v[96:97], v236 offset:15104
    ds_read_b64_tr_b16 v[98:99], v236 offset:15576
    ds_read_b64_tr_b16 v[84:85], v235 offset:15104
    ds_read_b64_tr_b16 v[86:87], v235 offset:15576
    ds_read_b64_tr_b16 v[88:89], v235 offset:15136
    ds_read_b64_tr_b16 v[90:91], v235 offset:15608
    ds_read_b64_tr_b16 v[92:93], v235 offset:15168
    ds_read_b64_tr_b16 v[94:95], v235 offset:15640
    s_waitcnt lgkmcnt(8)
    v_mfma_f32_16x16x32_bf16 v[152:155], v[64:67], v[76:79], 0
    ds_read_b64_tr_b16 v[112:113], v236 offset:30208
    ds_read_b64_tr_b16 v[114:115], v236 offset:30680
    ds_read_b64_tr_b16 v[100:101], v235 offset:30208
    v_mfma_f32_16x16x32_bf16 v[156:159], v[68:71], v[76:79], 0
    ds_read_b64_tr_b16 v[102:103], v235 offset:30680
    ds_read_b64_tr_b16 v[104:105], v235 offset:30240
    ds_read_b64_tr_b16 v[106:107], v235 offset:30712
    v_mfma_f32_16x16x32_bf16 v[160:163], v[72:75], v[76:79], 0
    ds_read_b64_tr_b16 v[108:109], v235 offset:30272
    ds_read_b64_tr_b16 v[110:111], v235 offset:30744
    s_waitcnt lgkmcnt(8)
    v_mfma_f32_16x16x32_bf16 v[152:155], v[84:87], v[96:99], v[152:155]
    ds_read_b64_tr_b16 v[76:77], v236 offset:45312
    ds_read_b64_tr_b16 v[78:79], v236 offset:45784
    ds_read_b64_tr_b16 v[64:65], v235 offset:45312
    v_mfma_f32_16x16x32_bf16 v[156:159], v[88:91], v[96:99], v[156:159]
    ds_read_b64_tr_b16 v[66:67], v235 offset:45784
    ds_read_b64_tr_b16 v[68:69], v235 offset:45344
    ds_read_b64_tr_b16 v[70:71], v235 offset:45816
    v_mfma_f32_16x16x32_bf16 v[160:163], v[92:95], v[96:99], v[160:163]
    ds_read_b64_tr_b16 v[72:73], v235 offset:45376
    ds_read_b64_tr_b16 v[74:75], v235 offset:45848
    s_waitcnt lgkmcnt(8)
    v_mfma_f32_16x16x32_bf16 v[152:155], v[100:103], v[112:115], v[152:155]
    ds_read_b64_tr_b16 v[96:97], v2 offset:0
    ds_read_b64_tr_b16 v[98:99], v2 offset:472
    ds_read_b64_tr_b16 v[84:85], v1 offset:0
    v_mfma_f32_16x16x32_bf16 v[156:159], v[104:107], v[112:115], v[156:159]
    ds_read_b64_tr_b16 v[86:87], v1 offset:472
    ds_read_b64_tr_b16 v[88:89], v1 offset:32
    ds_read_b64_tr_b16 v[90:91], v1 offset:504
    v_mfma_f32_16x16x32_bf16 v[160:163], v[108:111], v[112:115], v[160:163]
    ds_read_b64_tr_b16 v[92:93], v1 offset:64
    ds_read_b64_tr_b16 v[94:95], v1 offset:536
    s_waitcnt lgkmcnt(8)
    v_mfma_f32_16x16x32_bf16 v[152:155], v[64:67], v[76:79], v[152:155]
    ds_read_b64_tr_b16 v[112:113], v2 offset:15104
    ds_read_b64_tr_b16 v[114:115], v2 offset:15576
    ds_read_b64_tr_b16 v[100:101], v1 offset:15104
    v_mfma_f32_16x16x32_bf16 v[156:159], v[68:71], v[76:79], v[156:159]
    ds_read_b64_tr_b16 v[102:103], v1 offset:15576
    ds_read_b64_tr_b16 v[104:105], v1 offset:15136
    ds_read_b64_tr_b16 v[106:107], v1 offset:15608
    v_mfma_f32_16x16x32_bf16 v[160:163], v[72:75], v[76:79], v[160:163]
    ds_read_b64_tr_b16 v[108:109], v1 offset:15168
    ds_read_b64_tr_b16 v[110:111], v1 offset:15640
    s_waitcnt lgkmcnt(8)
    v_mfma_f32_16x16x32_bf16 v[152:155], v[84:87], v[96:99], v[152:155]
    ds_read_b64_tr_b16 v[76:77], v2 offset:30208
    ds_read_b64_tr_b16 v[78:79], v2 offset:30680
    ds_read_b64_tr_b16 v[64:65], v1 offset:30208
    v_mfma_f32_16x16x32_bf16 v[156:159], v[88:91], v[96:99], v[156:159]
    ds_read_b64_tr_b16 v[66:67], v1 offset:30680
    ds_read_b64_tr_b16 v[68:69], v1 offset:30240
    ds_read_b64_tr_b16 v[70:71], v1 offset:30712
    v_mfma_f32_16x16x32_bf16 v[160:163], v[92:95], v[96:99], v[160:163]
    ds_read_b64_tr_b16 v[72:73], v1 offset:30272
    ds_read_b64_tr_b16 v[74:75], v1 offset:30744
    s_waitcnt lgkmcnt(8)
    v_mfma_f32_16x16x32_bf16 v[152:155], v[100:103], v[112:115], v[152:155]
    ds_read_b64_tr_b16 v[96:97], v2 offset:45312
    ds_read_b64_tr_b16 v[98:99], v2 offset:45784
    ds_read_b64_tr_b16 v[84:85], v1 offset:45312
    v_mfma_f32_16x16x32_bf16 v[156:159], v[104:107], v[112:115], v[156:159]
    ds_read_b64_tr_b16 v[86:87], v1 offset:45784
    ds_read_b64_tr_b16 v[88:89], v1 offset:45344
    ds_read_b64_tr_b16 v[90:91], v1 offset:45816
    v_mfma_f32_16x16x32_bf16 v[160:163], v[108:111], v[112:115], v[160:163]
    ds_read_b64_tr_b16 v[92:93], v1 offset:45376
    ds_read_b64_tr_b16 v[94:95], v1 offset:45848
    s_waitcnt lgkmcnt(8)
    v_mfma_f32_16x16x32_bf16 v[152:155], v[64:67], v[76:79], v[152:155]
    v_mfma_f32_16x16x32_bf16 v[156:159], v[68:71], v[76:79], v[156:159]
    v_mfma_f32_16x16x32_bf16 v[160:163], v[72:75], v[76:79], v[160:163]
    s_waitcnt lgkmcnt(0)
    v_mfma_f32_16x16x32_bf16 v[152:155], v[84:87], v[96:99], v[152:155]
    v_mfma_f32_16x16x32_bf16 v[156:159], v[88:91], v[96:99], v[156:159]
    v_mfma_f32_16x16x32_bf16 v[160:163], v[92:95], v[96:99], v[160:163]
    s_and_b32 s3, s4, 1
    s_mul_i32 s3, s3, 2560
    s_add_u32 s3, s3, s30
    s_nop 4
    buffer_store_dwordx4 v[152:155], v237, s[44:47], s3 offen sc1
    s_add_u32 s3, s3, s40
    buffer_store_dwordx4 v[156:159], v237, s[44:47], s3 offen sc1
    s_add_u32 s3, s3, s40
    buffer_store_dwordx4 v[160:163], v238, s[44:47], s3 offen sc1
    s_add_u32 s3, s3, s40
    s_waitcnt vmcnt(0)
    v_mov_b32 v8, s7
    s_mov_b32 exec_lo, 0xff
    s_mov_b32 exec_hi, 0
    buffer_store_dword v8, v249, s[44:47], s31 offen sc1
    s_mov_b64 exec, -1
    s_setprio 0
    s_cmp_lg_u32 s98, 0
    s_cbranch_scc1 on_47
    s_barrier
on_47:
.p2align 3
    v_max_f32 v4, v44, v45
    v_min_f32 v6, v44, v45
    v_max3_f32 v4, v4, v46, v47
    v_min3_f32 v6, v6, v46, v47
    v_max3_f32 v4, v4, v48, v49
    v_min3_f32 v6, v6, v48, v49
    v_max3_f32 v4, v4, v50, v51
    v_min3_f32 v6, v6, v50, v51
    v_max3_f32 v4, v4, v52, v53
    v_min3_f32 v6, v6, v52, v53
    v_max3_f32 v4, v4, v54, v55
    v_min3_f32 v6, v6, v54, v55
    v_max3_f32 v4, v4, v56, v57
    v_min3_f32 v6, v6, v56, v57
    v_max3_f32 v4, v4, v58, v59
    v_min3_f32 v6, v6, v58, v59
    v_max3_f32 v4, v4, v60, v61
    v_min3_f32 v6, v6, v60, v61
    v_mul_f32 v4, v120, v4
    v_mul_f32 v6, v120, v6
    v_pk_fma_f32 v[84:85], v[44:45], v[120:121], v[4:5] op_sel_hi:[1,0,0] neg_lo:[0,0,1] neg_hi:[0,0,1]
    v_pk_fma_f32 v[86:87], v[46:47], v[120:121], v[4:5] op_sel_hi:[1,0,0] neg_lo:[0,0,1] neg_hi:[0,0,1]
    v_pk_fma_f32 v[88:89], v[48:49], v[120:121], v[4:5] op_sel_hi:[1,0,0] neg_lo:[0,0,1] neg_hi:[0,0,1]
    v_pk_fma_f32 v[90:91], v[50:51], v[120:121], v[4:5] op_sel_hi:[1,0,0] neg_lo:[0,0,1] neg_hi:[0,0,1]
    v_pk_fma_f32 v[92:93], v[52:53], v[120:121], v[4:5] op_sel_hi:[1,0,0] neg_lo:[0,0,1] neg_hi:[0,0,1]
    v_pk_fma_f32 v[94:95], v[54:55], v[120:121], v[4:5] op_sel_hi:[1,0,0] neg_lo:[0,0,1] neg_hi:[0,0,1]
    v_pk_fma_f32 v[96:97], v[56:57], v[120:121], v[4:5] op_sel_hi:[1,0,0] neg_lo:[0,0,1] neg_hi:[0,0,1]
    v_pk_fma_f32 v[98:99], v[58:59], v[120:121], v[4:5] op_sel_hi:[1,0,0] neg_lo:[0,0,1] neg_hi:[0,0,1]
    v_pk_fma_f32 v[100:101], v[60:61], v[120:121], v[4:5] op_sel_hi:[1,0,0] neg_lo:[0,0,1] neg_hi:[0,0,1]
    v_pk_fma_f32 v[102:103], v[44:45], v[120:121], v[6:7] op_sel_hi:[1,0,0] neg_lo:[1,0,0] neg_hi:[1,0,0]
    v_pk_fma_f32 v[104:105], v[46:47], v[120:121], v[6:7] op_sel_hi:[1,0,0] neg_lo:[1,0,0] neg_hi:[1,0,0]
    v_pk_fma_f32 v[106:107], v[48:49], v[120:121], v[6:7] op_sel_hi:[1,0,0] neg_lo:[1,0,0] neg_hi:[1,0,0]
    v_pk_fma_f32 v[108:109], v[50:51], v[120:121], v[6:7] op_sel_hi:[1,0,0] neg_lo:[1,0,0] neg_hi:[1,0,0]
    v_pk_fma_f32 v[110:111], v[52:53], v[120:121], v[6:7] op_sel_hi:[1,0,0] neg_lo:[1,0,0] neg_hi:[1,0,0]
    v_pk_fma_f32 v[112:113], v[54:55], v[120:121], v[6:7] op_sel_hi:[1,0,0] neg_lo:[1,0,0] neg_hi:[1,0,0]
    v_pk_fma_f32 v[114:115], v[56:57], v[120:121], v[6:7] op_sel_hi:[1,0,0] neg_lo:[1,0,0] neg_hi:[1,0,0]
    v_pk_fma_f32 v[116:117], v[58:59], v[120:121], v[6:7] op_sel_hi:[1,0,0] neg_lo:[1,0,0] neg_hi:[1,0,0]
    v_pk_fma_f32 v[118:119], v[60:61], v[120:121], v[6:7] op_sel_hi:[1,0,0] neg_lo:[1,0,0] neg_hi:[1,0,0]
    v_exp_f32 v84, v84
    v_mfma_f32_16x16x32_bf16 v[64:67], v[180:183], v[144:147], 0
    v_exp_f32 v85, v85
    v_exp_f32 v86, v86
    v_mfma_f32_16x16x32_bf16 v[68:71], v[184:187], v[144:147], 0
    v_exp_f32 v87, v87
    v_exp_f32 v88, v88
    v_mfma_f32_16x16x32_bf16 v[72:75], v[188:191], v[144:147], 0
    v_exp_f32 v89, v89
    v_exp_f32 v90, v90
    v_mfma_f32_16x16x32_bf16 v[76:79], v[192:195], v[144:147], 0
    v_exp_f32 v91, v91
    v_exp_f32 v92, v92
    v_mfma_f32_16x16x32_bf16 v[80:83], v[196:199], v[144:147], 0
    v_exp_f32 v93, v93
    v_exp_f32 v94, v94
    v_mfma_f32_16x16x32_bf16 v[64:67], v[200:203], v[148:151], v[64:67]
    v_exp_f32 v95, v95
    v_exp_f32 v96, v96
    v_mfma_f32_16x16x32_bf16 v[68:71], v[204:207], v[148:151], v[68:71]
    v_exp_f32 v97, v97
    v_exp_f32 v98, v98
    v_mfma_f32_16x16x32_bf16 v[72:75], v[208:211], v[148:151], v[72:75]
    v_exp_f32 v99, v99
    v_exp_f32 v100, v100
    v_mfma_f32_16x16x32_bf16 v[76:79], v[212:215], v[148:151], v[76:79]
    v_exp_f32 v101, v101
    v_exp_f32 v102, v102
    v_mfma_f32_16x16x32_bf16 v[80:83], v[216:219], v[148:151], v[80:83]
    v_exp_f32 v103, v103
    v_exp_f32 v104, v104
    v_mfma_f32_16x16x32_bf16 v[64:67], v[24:27], v[172:175], v[64:67]
    v_exp_f32 v105, v105
    v_exp_f32 v106, v106
    v_mfma_f32_16x16x32_bf16 v[68:71], v[28:31], v[172:175], v[68:71]
    v_exp_f32 v107, v107
    v_exp_f32 v108, v108
    v_mfma_f32_16x16x32_bf16 v[72:75], v[32:35], v[172:175], v[72:75]
    v_exp_f32 v109, v109
    v_exp_f32 v110, v110
    v_mfma_f32_16x16x32_bf16 v[76:79], v[36:39], v[172:175], v[76:79]
    v_exp_f32 v111, v111
    v_exp_f32 v112, v112
    v_mfma_f32_16x16x32_bf16 v[80:83], v[40:43], v[172:175], v[80:83]
    v_exp_f32 v113, v113
    v_exp_f32 v114, v114
    v_exp_f32 v115, v115
    v_exp_f32 v116, v116
    v_exp_f32 v117, v117
    v_exp_f32 v118, v118
    v_exp_f32 v119, v119
    v_pk_add_f32 v[4:5], v[84:85], v[86:87]
    v_pk_add_f32 v[6:7], v[102:103], v[104:105]
    v_pk_add_f32 v[4:5], v[4:5], v[88:89]
    v_pk_add_f32 v[6:7], v[6:7], v[106:107]
    v_pk_add_f32 v[4:5], v[4:5], v[90:91]
    v_pk_add_f32 v[6:7], v[6:7], v[108:109]
    v_pk_add_f32 v[4:5], v[4:5], v[92:93]
    v_pk_add_f32 v[6:7], v[6:7], v[110:111]
    v_pk_add_f32 v[4:5], v[4:5], v[94:95]
    v_pk_add_f32 v[6:7], v[6:7], v[112:113]
    v_pk_add_f32 v[4:5], v[4:5], v[96:97]
    v_pk_add_f32 v[6:7], v[6:7], v[114:115]
    v_pk_add_f32 v[4:5], v[4:5], v[98:99]
    v_pk_add_f32 v[6:7], v[6:7], v[116:117]
    v_pk_add_f32 v[4:5], v[4:5], v[100:101]
    v_pk_add_f32 v[6:7], v[6:7], v[118:119]
    v_add_f32 v4, v4, v5
    v_add_f32 v6, v6, v7
    v_rcp_f32 v4, v4
    v_rcp_f32 v6, v6
    v_pk_mul_f32 v[84:85], v[84:85], v[4:5] op_sel_hi:[1,0]
    v_pk_mul_f32 v[86:87], v[86:87], v[4:5] op_sel_hi:[1,0]
    v_pk_mul_f32 v[88:89], v[88:89], v[4:5] op_sel_hi:[1,0]
    v_pk_mul_f32 v[90:91], v[90:91], v[4:5] op_sel_hi:[1,0]
    v_pk_mul_f32 v[92:93], v[92:93], v[4:5] op_sel_hi:[1,0]
    v_pk_mul_f32 v[94:95], v[94:95], v[4:5] op_sel_hi:[1,0]
    v_pk_mul_f32 v[96:97], v[96:97], v[4:5] op_sel_hi:[1,0]
    v_pk_mul_f32 v[98:99], v[98:99], v[4:5] op_sel_hi:[1,0]
    v_pk_mul_f32 v[100:101], v[100:101], v[4:5] op_sel_hi:[1,0]
    v_pk_mul_f32 v[102:103], v[102:103], v[6:7] op_sel_hi:[1,0]
    v_pk_mul_f32 v[104:105], v[104:105], v[6:7] op_sel_hi:[1,0]
    v_pk_mul_f32 v[106:107], v[106:107], v[6:7] op_sel_hi:[1,0]
    v_pk_mul_f32 v[108:109], v[108:109], v[6:7] op_sel_hi:[1,0]
    v_pk_mul_f32 v[110:111], v[110:111], v[6:7] op_sel_hi:[1,0]
    v_pk_mul_f32 v[112:113], v[112:113], v[6:7] op_sel_hi:[1,0]
    v_pk_mul_f32 v[114:115], v[114:115], v[6:7] op_sel_hi:[1,0]
    v_pk_mul_f32 v[116:117], v[116:117], v[6:7] op_sel_hi:[1,0]
    v_pk_mul_f32 v[118:119], v[118:119], v[6:7] op_sel_hi:[1,0]
    v_cvt_pk_bf16_f32 v124, v84, v85
    v_cvt_pk_bf16_f32 v125, v86, v87
    v_cvt_pk_bf16_f32 v126, v88, v89
    v_cvt_pk_bf16_f32 v127, v90, v91
    v_cvt_pk_bf16_f32 v128, v92, v93
    v_cvt_pk_bf16_f32 v129, v94, v95
    v_cvt_pk_bf16_f32 v130, v96, v97
    v_cvt_pk_bf16_f32 v131, v98, v99
    v_cvt_pk_bf16_f32 v132, v100, v101
    v_cvt_pk_bf16_f32 v14, v102, v103
    v_cvt_pk_bf16_f32 v15, v104, v105
    v_cvt_pk_bf16_f32 v16, v106, v107
    v_cvt_pk_bf16_f32 v17, v108, v109
    v_cvt_pk_bf16_f32 v18, v110, v111
    v_cvt_pk_bf16_f32 v19, v112, v113
    v_cvt_pk_bf16_f32 v20, v114, v115
    v_cvt_pk_bf16_f32 v21, v116, v117
    v_cvt_pk_bf16_f32 v22, v118, v119
    s_add_u32 s50, s44, s36
    s_addc_u32 s51, s45, 0
    s_load_dwordx16 s[64:79], s[50:51], 0 glc
    v_mov_b32 v133, 0
    v_mov_b32 v23, 0
    v_permlane32_swap_b32 v124, v14
    v_permlane32_swap_b32 v125, v15
    v_permlane32_swap_b32 v126, v16
    v_permlane32_swap_b32 v127, v17
    v_permlane32_swap_b32 v128, v18
    v_permlane32_swap_b32 v129, v19
    v_permlane32_swap_b32 v130, v20
    v_permlane32_swap_b32 v131, v21
    v_permlane32_swap_b32 v132, v22
    s_mov_b32 s48, 65536
poll_48:
    s_waitcnt lgkmcnt(0)
    s_cmp_lg_u64 s[64:65], s[0:1]
    s_cselect_b32 s49, 1, 0
    s_cmp_lg_u64 s[66:67], s[0:1]
    s_cselect_b32 s49, 1, s49
    s_cmp_lg_u64 s[68:69], s[0:1]
    s_cselect_b32 s49, 1, s49
    s_cmp_lg_u64 s[70:71], s[0:1]
    s_cselect_b32 s49, 1, s49
    s_cmp_lg_u64 s[72:73], s[0:1]
    s_cselect_b32 s49, 1, s49
    s_cmp_lg_u64 s[74:75], s[0:1]
    s_cselect_b32 s49, 1, s49
    s_cmp_lg_u64 s[76:77], s[0:1]
    s_cselect_b32 s49, 1, s49
    s_cmp_lg_u64 s[78:79], s[0:1]
    s_cselect_b32 s49, 1, s49
    s_cmp_eq_u32 s49, 0
    s_cbranch_scc1 polld_49
    s_sub_u32 s48, s48, 1
    s_cmp_eq_u32 s48, 0
    s_cbranch_scc1 polld_49
    s_load_dwordx16 s[64:79], s[50:51], 0 glc
    s_branch poll_48
polld_49:
    s_mul_i32 s3, s96, 15360
    s_sub_u32 s3, s30, s3
    buffer_load_dwordx4 v[180:183], v239, s[44:47], s3 offen sc1
    buffer_load_dwordx4 v[24:27], v240, s[44:47], s3 offen sc1
    s_add_u32 s3, s3, 15360
    buffer_load_dwordx4 v[184:187], v239, s[44:47], s3 offen sc1
    buffer_load_dwordx4 v[28:31], v240, s[44:47], s3 offen sc1
    s_add_u32 s3, s3, 15360
    buffer_load_dwordx4 v[188:191], v239, s[44:47], s3 offen sc1
    buffer_load_dwordx4 v[32:35], v240, s[44:47], s3 offen sc1
    s_add_u32 s3, s3, 15360
    buffer_load_dwordx4 v[192:195], v239, s[44:47], s3 offen sc1
    buffer_load_dwordx4 v[36:39], v240, s[44:47], s3 offen sc1
    s_add_u32 s3, s3, 15360
    buffer_load_dwordx4 v[196:199], v239, s[44:47], s3 offen sc1
    buffer_load_dwordx4 v[40:43], v240, s[44:47], s3 offen sc1
    s_add_u32 s3, s3, 15360
    buffer_load_dwordx4 v[200:203], v239, s[44:47], s3 offen sc1
    buffer_load_dwordx4 v[44:47], v240, s[44:47], s3 offen sc1
    s_add_u32 s3, s3, 15360
    buffer_load_dwordx4 v[204:207], v239, s[44:47], s3 offen sc1
    buffer_load_dwordx4 v[48:51], v240, s[44:47], s3 offen sc1
    s_add_u32 s3, s3, 15360
    buffer_load_dwordx4 v[208:211], v239, s[44:47], s3 offen sc1
    buffer_load_dwordx4 v[52:55], v240, s[44:47], s3 offen sc1
    s_add_u32 s3, s3, 15360
.p2align 3
    v_max_f32 v4, v64, v65
    v_min_f32 v6, v64, v65
    v_max3_f32 v4, v4, v66, v67
    v_min3_f32 v6, v6, v66, v67
    v_max3_f32 v4, v4, v68, v69
    v_min3_f32 v6, v6, v68, v69
    v_max3_f32 v4, v4, v70, v71
    v_min3_f32 v6, v6, v70, v71
    v_max3_f32 v4, v4, v72, v73
    v_min3_f32 v6, v6, v72, v73
    v_max3_f32 v4, v4, v74, v75
    v_min3_f32 v6, v6, v74, v75
    v_max3_f32 v4, v4, v76, v77
    v_min3_f32 v6, v6, v76, v77
    v_max3_f32 v4, v4, v78, v79
    v_min3_f32 v6, v6, v78, v79
    v_max3_f32 v4, v4, v80, v81
    v_min3_f32 v6, v6, v80, v81
    v_mul_f32 v4, v122, v4
    v_mul_f32 v6, v122, v6
    v_pk_fma_f32 v[84:85], v[64:65], v[122:123], v[4:5] op_sel_hi:[1,0,0] neg_lo:[0,0,1] neg_hi:[0,0,1]
    v_pk_fma_f32 v[86:87], v[66:67], v[122:123], v[4:5] op_sel_hi:[1,0,0] neg_lo:[0,0,1] neg_hi:[0,0,1]
    v_pk_fma_f32 v[88:89], v[68:69], v[122:123], v[4:5] op_sel_hi:[1,0,0] neg_lo:[0,0,1] neg_hi:[0,0,1]
    v_pk_fma_f32 v[90:91], v[70:71], v[122:123], v[4:5] op_sel_hi:[1,0,0] neg_lo:[0,0,1] neg_hi:[0,0,1]
    v_pk_fma_f32 v[92:93], v[72:73], v[122:123], v[4:5] op_sel_hi:[1,0,0] neg_lo:[0,0,1] neg_hi:[0,0,1]
    v_pk_fma_f32 v[94:95], v[74:75], v[122:123], v[4:5] op_sel_hi:[1,0,0] neg_lo:[0,0,1] neg_hi:[0,0,1]
    v_pk_fma_f32 v[96:97], v[76:77], v[122:123], v[4:5] op_sel_hi:[1,0,0] neg_lo:[0,0,1] neg_hi:[0,0,1]
    v_pk_fma_f32 v[98:99], v[78:79], v[122:123], v[4:5] op_sel_hi:[1,0,0] neg_lo:[0,0,1] neg_hi:[0,0,1]
    v_pk_fma_f32 v[100:101], v[80:81], v[122:123], v[4:5] op_sel_hi:[1,0,0] neg_lo:[0,0,1] neg_hi:[0,0,1]
    v_pk_fma_f32 v[102:103], v[64:65], v[122:123], v[6:7] op_sel_hi:[1,0,0] neg_lo:[1,0,0] neg_hi:[1,0,0]
    v_pk_fma_f32 v[104:105], v[66:67], v[122:123], v[6:7] op_sel_hi:[1,0,0] neg_lo:[1,0,0] neg_hi:[1,0,0]
    v_pk_fma_f32 v[106:107], v[68:69], v[122:123], v[6:7] op_sel_hi:[1,0,0] neg_lo:[1,0,0] neg_hi:[1,0,0]
    v_pk_fma_f32 v[108:109], v[70:71], v[122:123], v[6:7] op_sel_hi:[1,0,0] neg_lo:[1,0,0] neg_hi:[1,0,0]
    v_pk_fma_f32 v[110:111], v[72:73], v[122:123], v[6:7] op_sel_hi:[1,0,0] neg_lo:[1,0,0] neg_hi:[1,0,0]
    v_pk_fma_f32 v[112:113], v[74:75], v[122:123], v[6:7] op_sel_hi:[1,0,0] neg_lo:[1,0,0] neg_hi:[1,0,0]
    v_pk_fma_f32 v[114:115], v[76:77], v[122:123], v[6:7] op_sel_hi:[1,0,0] neg_lo:[1,0,0] neg_hi:[1,0,0]
    v_pk_fma_f32 v[116:117], v[78:79], v[122:123], v[6:7] op_sel_hi:[1,0,0] neg_lo:[1,0,0] neg_hi:[1,0,0]
    v_pk_fma_f32 v[118:119], v[80:81], v[122:123], v[6:7] op_sel_hi:[1,0,0] neg_lo:[1,0,0] neg_hi:[1,0,0]
    v_exp_f32 v84, v84
    v_exp_f32 v85, v85
    v_exp_f32 v86, v86
    v_exp_f32 v87, v87
    v_exp_f32 v88, v88
    v_exp_f32 v89, v89
    v_exp_f32 v90, v90
    v_exp_f32 v91, v91
    v_exp_f32 v92, v92
    v_exp_f32 v93, v93
    v_exp_f32 v94, v94
    v_exp_f32 v95, v95
    v_exp_f32 v96, v96
    v_exp_f32 v97, v97
    v_exp_f32 v98, v98
    v_exp_f32 v99, v99
    v_exp_f32 v100, v100
    v_exp_f32 v101, v101
    v_exp_f32 v102, v102
    v_exp_f32 v103, v103
    v_exp_f32 v104, v104
    v_exp_f32 v105, v105
    v_exp_f32 v106, v106
    v_exp_f32 v107, v107
    v_exp_f32 v108, v108
    v_exp_f32 v109, v109
    v_exp_f32 v110, v110
    v_exp_f32 v111, v111
    v_exp_f32 v112, v112
    v_exp_f32 v113, v113
    v_exp_f32 v114, v114
    v_exp_f32 v115, v115
    v_exp_f32 v116, v116
    v_exp_f32 v117, v117
    v_exp_f32 v118, v118
    v_exp_f32 v119, v119
    v_pk_add_f32 v[4:5], v[84:85], v[86:87]
    v_pk_add_f32 v[6:7], v[102:103], v[104:105]
    v_pk_add_f32 v[4:5], v[4:5], v[88:89]
    v_pk_add_f32 v[6:7], v[6:7], v[106:107]
    v_pk_add_f32 v[4:5], v[4:5], v[90:91]
    v_pk_add_f32 v[6:7], v[6:7], v[108:109]
    v_pk_add_f32 v[4:5], v[4:5], v[92:93]
    v_pk_add_f32 v[6:7], v[6:7], v[110:111]
    v_pk_add_f32 v[4:5], v[4:5], v[94:95]
    v_pk_add_f32 v[6:7], v[6:7], v[112:113]
    v_pk_add_f32 v[4:5], v[4:5], v[96:97]
    v_pk_add_f32 v[6:7], v[6:7], v[114:115]
    v_pk_add_f32 v[4:5], v[4:5], v[98:99]
    v_pk_add_f32 v[6:7], v[6:7], v[116:117]
    v_pk_add_f32 v[4:5], v[4:5], v[100:101]
    v_pk_add_f32 v[6:7], v[6:7], v[118:119]
    v_add_f32 v4, v4, v5
    v_add_f32 v6, v6, v7
    v_rcp_f32 v4, v4
    v_rcp_f32 v6, v6
    v_pk_mul_f32 v[84:85], v[84:85], v[4:5] op_sel_hi:[1,0]
    v_pk_mul_f32 v[86:87], v[86:87], v[4:5] op_sel_hi:[1,0]
    v_pk_mul_f32 v[88:89], v[88:89], v[4:5] op_sel_hi:[1,0]
    v_pk_mul_f32 v[90:91], v[90:91], v[4:5] op_sel_hi:[1,0]
    v_pk_mul_f32 v[92:93], v[92:93], v[4:5] op_sel_hi:[1,0]
    v_pk_mul_f32 v[94:95], v[94:95], v[4:5] op_sel_hi:[1,0]
    v_pk_mul_f32 v[96:97], v[96:97], v[4:5] op_sel_hi:[1,0]
    v_pk_mul_f32 v[98:99], v[98:99], v[4:5] op_sel_hi:[1,0]
    v_pk_mul_f32 v[100:101], v[100:101], v[4:5] op_sel_hi:[1,0]
    v_pk_mul_f32 v[102:103], v[102:103], v[6:7] op_sel_hi:[1,0]
    v_pk_mul_f32 v[104:105], v[104:105], v[6:7] op_sel_hi:[1,0]
    v_pk_mul_f32 v[106:107], v[106:107], v[6:7] op_sel_hi:[1,0]
    v_pk_mul_f32 v[108:109], v[108:109], v[6:7] op_sel_hi:[1,0]
    v_pk_mul_f32 v[110:111], v[110:111], v[6:7] op_sel_hi:[1,0]
    v_pk_mul_f32 v[112:113], v[112:113], v[6:7] op_sel_hi:[1,0]
    v_pk_mul_f32 v[114:115], v[114:115], v[6:7] op_sel_hi:[1,0]
    v_pk_mul_f32 v[116:117], v[116:117], v[6:7] op_sel_hi:[1,0]
    v_pk_mul_f32 v[118:119], v[118:119], v[6:7] op_sel_hi:[1,0]
    v_cvt_pk_bf16_f32 v152, v84, v85
    v_cvt_pk_bf16_f32 v153, v86, v87
    v_cvt_pk_bf16_f32 v154, v88, v89
    v_cvt_pk_bf16_f32 v155, v90, v91
    v_cvt_pk_bf16_f32 v156, v92, v93
    v_cvt_pk_bf16_f32 v157, v94, v95
    v_cvt_pk_bf16_f32 v158, v96, v97
    v_cvt_pk_bf16_f32 v159, v98, v99
    v_cvt_pk_bf16_f32 v160, v100, v101
    v_cvt_pk_bf16_f32 v164, v102, v103
    v_cvt_pk_bf16_f32 v165, v104, v105
    v_cvt_pk_bf16_f32 v166, v106, v107
    v_cvt_pk_bf16_f32 v167, v108, v109
    v_cvt_pk_bf16_f32 v168, v110, v111
    v_cvt_pk_bf16_f32 v169, v112, v113
    v_cvt_pk_bf16_f32 v170, v114, v115
    v_cvt_pk_bf16_f32 v171, v116, v117
    v_cvt_pk_bf16_f32 v172, v118, v119
    v_mov_b32 v161, 0
    v_mov_b32 v173, 0
    v_permlane32_swap_b32 v152, v164
    v_permlane32_swap_b32 v153, v165
    v_permlane32_swap_b32 v154, v166
    v_permlane32_swap_b32 v155, v167
    v_permlane32_swap_b32 v156, v168
    v_permlane32_swap_b32 v157, v169
    v_permlane32_swap_b32 v158, v170
    v_permlane32_swap_b32 v159, v171
    v_permlane32_swap_b32 v160, v172
    s_mul_i32 s3, s4, 4608
    v_lshl_add_u32 v1, v0, 4, s3
    s_waitcnt vmcnt(12)
    v_pk_add_f32 v[180:181], v[180:181], v[184:185]
    v_pk_add_f32 v[182:183], v[182:183], v[186:187]
    v_pk_add_f32 v[24:25], v[24:25], v[28:29]
    v_pk_add_f32 v[26:27], v[26:27], v[30:31]
    s_waitcnt vmcnt(10)
    v_pk_add_f32 v[180:181], v[180:181], v[188:189]
    v_pk_add_f32 v[182:183], v[182:183], v[190:191]
    v_pk_add_f32 v[24:25], v[24:25], v[32:33]
    v_pk_add_f32 v[26:27], v[26:27], v[34:35]
    s_waitcnt vmcnt(8)
    v_pk_add_f32 v[180:181], v[180:181], v[192:193]
    v_pk_add_f32 v[182:183], v[182:183], v[194:195]
    v_pk_add_f32 v[24:25], v[24:25], v[36:37]
    v_pk_add_f32 v[26:27], v[26:27], v[38:39]
    s_waitcnt vmcnt(6)
    v_pk_add_f32 v[180:181], v[180:181], v[196:197]
    v_pk_add_f32 v[182:183], v[182:183], v[198:199]
    v_pk_add_f32 v[24:25], v[24:25], v[40:41]
    v_pk_add_f32 v[26:27], v[26:27], v[42:43]
    s_waitcnt vmcnt(4)
    v_pk_add_f32 v[180:181], v[180:181], v[200:201]
    v_pk_add_f32 v[182:183], v[182:183], v[202:203]
    v_pk_add_f32 v[24:25], v[24:25], v[44:45]
    v_pk_add_f32 v[26:27], v[26:27], v[46:47]
    s_waitcnt vmcnt(2)
    v_pk_add_f32 v[180:181], v[180:181], v[204:205]
    v_pk_add_f32 v[182:183], v[182:183], v[206:207]
    v_pk_add_f32 v[24:25], v[24:25], v[48:49]
    v_pk_add_f32 v[26:27], v[26:27], v[50:51]
    s_waitcnt vmcnt(0)
    v_pk_add_f32 v[180:181], v[180:181], v[208:209]
    v_pk_add_f32 v[182:183], v[182:183], v[210:211]
    v_pk_add_f32 v[24:25], v[24:25], v[52:53]
    v_pk_add_f32 v[26:27], v[26:27], v[54:55]
    v_cvt_pk_bf16_f32 v180, v180, v181
    v_cvt_pk_bf16_f32 v181, v182, v183
    ds_write_b64 v241, v[180:181]
    v_cvt_pk_bf16_f32 v24, v24, v25
    v_cvt_pk_bf16_f32 v25, v26, v27
    ds_write_b64 v242, v[24:25]
    s_waitcnt lgkmcnt(0)
    s_barrier
    s_lshl_b32 s43, s98, 7
    s_add_u32 s43, s43, s63
    s_add_u32 s43, s43, 896
    s_mul_i32 s3, s43, 683
    s_lshr_b32 s3, s3, 16
    s_lshl_b32 s48, s3, 2
    s_lshr_b64 s[48:49], s[100:101], s48
    s_and_b32 s48, s48, 15
    s_sub_i32 s3, s48, s3
    s_mul_i32 s3, s3, 96
    s_add_i32 s3, s3, s43
    s_lshl_b32 s3, s3, 12
    s_add_u32 s3, s3, s42
    buffer_load_dword v255, v251, s[32:35], s3 offen
    s_cmp_lg_u32 s98, 1
    s_cbranch_scc1 on_50
    s_mul_i32 s3, s63, 1312
    s_lshr_b32 s49, s5, 1
    s_mul_i32 s49, s49, 165888
    s_add_u32 s3, s3, s49
    v_min_u32 v10, 40, v0
    v_lshlrev_b32 v10, 7, v10
    v_add_u32 v10, s3, v10
    buffer_load_dword v255, v10, s[20:23], 0 offen
on_50:
    s_mov_b32 s48, 0x358637bd
    ds_read2_b64 v[136:139], v246 offset0:0 offset1:1
    ds_read2_b64 v[140:143], v246 offset0:2 offset1:3
    ds_read_b32 v144, v246 offset:32
    v_mov_b32 v145, 0
    ds_read2_b64 v[88:91], v243 offset0:0 offset1:1
    ds_read2_b64 v[92:95], v243 offset0:2 offset1:3
    ds_read_b32 v96, v243 offset:32
    v_mov_b32 v97, 0
    ds_read2_b64 v[100:103], v244 offset0:0 offset1:1
    ds_read2_b64 v[104:107], v244 offset0:2 offset1:3
    ds_read_b32 v108, v244 offset:32
    v_mov_b32 v109, 0
    ds_read2_b64 v[112:115], v245 offset0:0 offset1:1
    ds_read2_b64 v[116:119], v245 offset0:2 offset1:3
    ds_read_b32 v120, v245 offset:32
    v_mov_b32 v121, 0
    v_add_u32 v2, 0, v0
    v_mul_u32_u24 v3, 1821, v2
    v_lshrrev_b32 v3, 16, v3
    v_mul_u32_u24 v3, 8640, v3
    v_lshl_add_u32 v204, v2, 4, v3
    v_add_u32 v2, 64, v0
    v_mul_u32_u24 v3, 1821, v2
    v_lshrrev_b32 v3, 16, v3
    v_mul_u32_u24 v3, 8640, v3
    v_lshl_add_u32 v205, v2, 4, v3
    v_add_u32 v2, 128, v0
    v_mul_u32_u24 v3, 1821, v2
    v_lshrrev_b32 v3, 16, v3
    v_mul_u32_u24 v3, 8640, v3
    v_lshl_add_u32 v206, v2, 4, v3
    v_add_u32 v2, 192, v0
    v_mul_u32_u24 v3, 1821, v2
    v_lshrrev_b32 v3, 16, v3
    v_mul_u32_u24 v3, 8640, v3
    v_lshl_add_u32 v207, v2, 4, v3
    v_add_u32 v2, 256, v0
    v_mul_u32_u24 v3, 1821, v2
    v_lshrrev_b32 v3, 16, v3
    v_mul_u32_u24 v3, 8640, v3
    v_lshl_add_u32 v208, v2, 4, v3
    s_waitcnt lgkmcnt(0)
    v_mfma_f32_16x16x32_bf16 v[36:39], v[124:127], v[136:139], 0
    v_mfma_f32_16x16x32_bf16 v[24:27], v[124:127], v[88:91], 0
    v_mfma_f32_16x16x32_bf16 v[28:31], v[124:127], v[100:103], 0
    v_mfma_f32_16x16x32_bf16 v[32:35], v[124:127], v[112:115], 0
    v_mfma_f32_16x16x32_bf16 v[52:55], v[14:17], v[136:139], 0
    v_mfma_f32_16x16x32_bf16 v[40:43], v[14:17], v[88:91], 0
    v_mfma_f32_16x16x32_bf16 v[44:47], v[14:17], v[100:103], 0
    v_mfma_f32_16x16x32_bf16 v[48:51], v[14:17], v[112:115], 0
    v_mfma_f32_16x16x32_bf16 v[36:39], v[128:131], v[140:143], v[36:39]
    v_mfma_f32_16x16x32_bf16 v[24:27], v[128:131], v[92:95], v[24:27]
    v_mfma_f32_16x16x32_bf16 v[28:31], v[128:131], v[104:107], v[28:31]
    v_mfma_f32_16x16x32_bf16 v[32:35], v[128:131], v[116:119], v[32:35]
    v_mfma_f32_16x16x32_bf16 v[52:55], v[18:21], v[140:143], v[52:55]
    v_mfma_f32_16x16x32_bf16 v[40:43], v[18:21], v[92:95], v[40:43]
    v_mfma_f32_16x16x32_bf16 v[44:47], v[18:21], v[104:107], v[44:47]
    v_mfma_f32_16x16x32_bf16 v[48:51], v[18:21], v[116:119], v[48:51]
    v_mfma_f32_16x16x16_bf16 v[36:39], v[132:133], v[144:145], v[36:39]
    v_mfma_f32_16x16x16_bf16 v[24:27], v[132:133], v[96:97], v[24:27]
    v_mfma_f32_16x16x16_bf16 v[28:31], v[132:133], v[108:109], v[28:31]
    v_mfma_f32_16x16x16_bf16 v[32:35], v[132:133], v[120:121], v[32:35]
    v_mfma_f32_16x16x16_bf16 v[52:55], v[22:23], v[144:145], v[52:55]
    v_mfma_f32_16x16x16_bf16 v[40:43], v[22:23], v[96:97], v[40:43]
    v_mfma_f32_16x16x16_bf16 v[44:47], v[22:23], v[108:109], v[44:47]
    v_mfma_f32_16x16x16_bf16 v[48:51], v[22:23], v[120:121], v[48:51]
    v_mfma_f32_16x16x32_bf16 v[68:71], v[152:155], v[136:139], 0
    v_add_f32 v36, s48, v36
    v_mfma_f32_16x16x32_bf16 v[56:59], v[152:155], v[88:91], 0
    v_add_f32 v37, s48, v37
    v_add_f32 v38, s48, v38
    v_mfma_f32_16x16x32_bf16 v[60:63], v[152:155], v[100:103], 0
    v_add_f32 v39, s48, v39
    v_rcp_f32 v36, v36
    v_mfma_f32_16x16x32_bf16 v[64:67], v[152:155], v[112:115], 0
    v_rcp_f32 v37, v37
    v_rcp_f32 v38, v38
    v_mfma_f32_16x16x32_bf16 v[84:87], v[164:167], v[136:139], 0
    v_rcp_f32 v39, v39
    v_add_f32 v52, s48, v52
    v_mfma_f32_16x16x32_bf16 v[72:75], v[164:167], v[88:91], 0
    v_add_f32 v53, s48, v53
    v_add_f32 v54, s48, v54
    v_mfma_f32_16x16x32_bf16 v[76:79], v[164:167], v[100:103], 0
    v_add_f32 v55, s48, v55
    v_rcp_f32 v52, v52
    v_mfma_f32_16x16x32_bf16 v[80:83], v[164:167], v[112:115], 0
    v_rcp_f32 v53, v53
    v_rcp_f32 v54, v54
    v_mfma_f32_16x16x32_bf16 v[68:71], v[156:159], v[140:143], v[68:71]
    v_rcp_f32 v55, v55
    v_pk_mul_f32 v[24:25], v[24:25], v[36:37]
    v_mfma_f32_16x16x32_bf16 v[56:59], v[156:159], v[92:95], v[56:59]
    v_pk_mul_f32 v[26:27], v[26:27], v[38:39]
    v_pk_mul_f32 v[28:29], v[28:29], v[36:37]
    v_mfma_f32_16x16x32_bf16 v[60:63], v[156:159], v[104:107], v[60:63]
    v_pk_mul_f32 v[30:31], v[30:31], v[38:39]
    v_pk_mul_f32 v[32:33], v[32:33], v[36:37]
    v_mfma_f32_16x16x32_bf16 v[64:67], v[156:159], v[116:119], v[64:67]
    v_pk_mul_f32 v[34:35], v[34:35], v[38:39]
    v_cvt_pk_bf16_f32 v180, v24, v25
    v_mfma_f32_16x16x32_bf16 v[84:87], v[168:171], v[140:143], v[84:87]
    v_cvt_pk_bf16_f32 v181, v26, v27
    v_cvt_pk_bf16_f32 v184, v28, v29
    v_mfma_f32_16x16x32_bf16 v[72:75], v[168:171], v[92:95], v[72:75]
    v_cvt_pk_bf16_f32 v185, v30, v31
    v_cvt_pk_bf16_f32 v188, v32, v33
    v_mfma_f32_16x16x32_bf16 v[76:79], v[168:171], v[104:107], v[76:79]
    v_cvt_pk_bf16_f32 v189, v34, v35
    v_pk_mul_f32 v[40:41], v[40:41], v[52:53]
    v_mfma_f32_16x16x32_bf16 v[80:83], v[168:171], v[116:119], v[80:83]
    v_pk_mul_f32 v[42:43], v[42:43], v[54:55]
    v_pk_mul_f32 v[44:45], v[44:45], v[52:53]
    v_mfma_f32_16x16x16_bf16 v[68:71], v[160:161], v[144:145], v[68:71]
    v_pk_mul_f32 v[46:47], v[46:47], v[54:55]
    v_pk_mul_f32 v[48:49], v[48:49], v[52:53]
    v_mfma_f32_16x16x16_bf16 v[56:59], v[160:161], v[96:97], v[56:59]
    v_pk_mul_f32 v[50:51], v[50:51], v[54:55]
    v_cvt_pk_bf16_f32 v182, v40, v41
    v_mfma_f32_16x16x16_bf16 v[60:63], v[160:161], v[108:109], v[60:63]
    v_cvt_pk_bf16_f32 v183, v42, v43
    v_cvt_pk_bf16_f32 v186, v44, v45
    v_mfma_f32_16x16x16_bf16 v[64:67], v[160:161], v[120:121], v[64:67]
    v_cvt_pk_bf16_f32 v187, v46, v47
    v_cvt_pk_bf16_f32 v190, v48, v49
    v_mfma_f32_16x16x16_bf16 v[84:87], v[172:173], v[144:145], v[84:87]
    v_cvt_pk_bf16_f32 v191, v50, v51
    v_permlane16_swap_b32 v180, v182
    v_mfma_f32_16x16x16_bf16 v[72:75], v[172:173], v[96:97], v[72:75]
    v_permlane16_swap_b32 v181, v183
    v_permlane16_swap_b32 v184, v186
    v_mfma_f32_16x16x16_bf16 v[76:79], v[172:173], v[108:109], v[76:79]
    v_permlane16_swap_b32 v185, v187
    v_permlane16_swap_b32 v188, v190
    v_mfma_f32_16x16x16_bf16 v[80:83], v[172:173], v[120:121], v[80:83]
    v_permlane16_swap_b32 v189, v191
    ds_write_b128 v247, v[180:183] offset:0
    ds_write_b128 v247, v[184:187] offset:128
    ds_write_b128 v248, v[188:191] offset:256
    s_nop 3
    v_add_f32 v68, s48, v68
    v_add_f32 v69, s48, v69
    v_add_f32 v70, s48, v70
    v_add_f32 v71, s48, v71
    v_rcp_f32 v68, v68
    v_rcp_f32 v69, v69
    v_rcp_f32 v70, v70
    v_rcp_f32 v71, v71
    v_add_f32 v84, s48, v84
    v_add_f32 v85, s48, v85
    v_add_f32 v86, s48, v86
    v_add_f32 v87, s48, v87
    v_rcp_f32 v84, v84
    v_rcp_f32 v85, v85
    v_rcp_f32 v86, v86
    v_rcp_f32 v87, v87
    v_pk_mul_f32 v[56:57], v[56:57], v[68:69]
    v_pk_mul_f32 v[58:59], v[58:59], v[70:71]
    v_pk_mul_f32 v[60:61], v[60:61], v[68:69]
    v_pk_mul_f32 v[62:63], v[62:63], v[70:71]
    v_pk_mul_f32 v[64:65], v[64:65], v[68:69]
    v_pk_mul_f32 v[66:67], v[66:67], v[70:71]
    v_cvt_pk_bf16_f32 v192, v56, v57
    v_cvt_pk_bf16_f32 v193, v58, v59
    v_cvt_pk_bf16_f32 v196, v60, v61
    v_cvt_pk_bf16_f32 v197, v62, v63
    v_cvt_pk_bf16_f32 v200, v64, v65
    v_cvt_pk_bf16_f32 v201, v66, v67
    v_pk_mul_f32 v[72:73], v[72:73], v[84:85]
    v_pk_mul_f32 v[74:75], v[74:75], v[86:87]
    v_pk_mul_f32 v[76:77], v[76:77], v[84:85]
    v_pk_mul_f32 v[78:79], v[78:79], v[86:87]
    v_pk_mul_f32 v[80:81], v[80:81], v[84:85]
    v_pk_mul_f32 v[82:83], v[82:83], v[86:87]
    v_cvt_pk_bf16_f32 v194, v72, v73
    v_cvt_pk_bf16_f32 v195, v74, v75
    v_cvt_pk_bf16_f32 v198, v76, v77
    v_cvt_pk_bf16_f32 v199, v78, v79
    v_cvt_pk_bf16_f32 v202, v80, v81
    v_cvt_pk_bf16_f32 v203, v82, v83
    v_permlane16_swap_b32 v192, v194
    v_permlane16_swap_b32 v193, v195
    v_permlane16_swap_b32 v196, v198
    v_permlane16_swap_b32 v197, v199
    v_permlane16_swap_b32 v200, v202
    v_permlane16_swap_b32 v201, v203
    ds_write_b128 v247, v[192:195] offset:2304
    ds_write_b128 v247, v[196:199] offset:2432
    ds_write_b128 v248, v[200:203] offset:2560
    ds_read_b128 v[24:27], v1 offset:0
    ds_read_b128 v[28:31], v1 offset:1024
    ds_read_b128 v[32:35], v1 offset:2048
    ds_read_b128 v[36:39], v1 offset:3072
    ds_read_b128 v[40:43], v1 offset:4096
    s_waitcnt lgkmcnt(4)
    buffer_store_dwordx4 v[24:27], v204, s[44:47], s37 offen sc1
    s_waitcnt lgkmcnt(3)
    buffer_store_dwordx4 v[28:31], v205, s[44:47], s37 offen sc1
    s_waitcnt lgkmcnt(2)
    buffer_store_dwordx4 v[32:35], v206, s[44:47], s37 offen sc1
    s_waitcnt lgkmcnt(1)
    buffer_store_dwordx4 v[36:39], v207, s[44:47], s37 offen sc1
    s_mov_b32 exec_hi, 0
    s_waitcnt lgkmcnt(0)
    buffer_store_dwordx4 v[40:43], v208, s[44:47], s37 offen sc1
    s_mov_b32 exec_hi, -1
    s_lshl_b32 s3, s96, 1
    s_lshr_b32 s48, s97, 1
    s_add_u32 s3, s3, s48
    s_lshl_b32 s3, s3, 2
    s_lshr_b32 s48, s5, 1
    s_add_u32 s3, s3, s48
    s_lshl_b32 s3, s3, 7
    s_and_b32 s48, s5, 1
    s_lshl_b32 s48, s48, 1
    s_add_u32 s48, s48, s98
    s_lshl_b32 s48, s48, 1
    s_and_b32 s49, s97, 1
    s_add_u32 s48, s48, s49
    s_lshl_b32 s48, s48, 2
    s_add_u32 s3, s3, s48
    s_add_u32 s3, s3, 32768
    s_waitcnt vmcnt(0)
    v_mov_b32 v4, s7
    s_mov_b64 exec, 1
    buffer_store_dword v4, off, s[44:47], s3 sc1
    s_mov_b64 exec, -1
L_fin:
L_end:
    s_endpgm
.p2align 6
.type order_table,@object
order_table:
.long 2844148496, 31525
.long 1125165446, 9595
.long 2844218418, 46608
.long 1412606343, 4278
.long 2557882896, 43860
.long 839948406, 21675
.long 3128312336, 38965
.long 1108392566, 13720
.size order_table, 64
L_code_end:
.section .rodata,"a"
.p2align 6
.amdhsa_kernel parallel_sum__linear_kernel_hedgehog__mixer_token_mlp__prompt_kernel
  .amdhsa_next_free_vgpr 256
  .amdhsa_next_free_sgpr 102
  .amdhsa_accum_offset 256
  .amdhsa_group_segment_fixed_size 0
  .amdhsa_kernarg_size 96
  .amdhsa_user_sgpr_count 2
  .amdhsa_user_sgpr_kernarg_segment_ptr 1
  .amdhsa_system_sgpr_workgroup_id_x 1
.end_amdhsa_kernel
```
